```python
import torch

def _softmax(x, axis=-1):
    return torch.softmax(x, dim=axis)
def _gelu(x):
    return torch.nn.functional.gelu(x, approximate="tanh")
def _silu(x):
    return torch.nn.functional.silu(x)
def _sigmoid(x):
    return torch.sigmoid(x)
def _layernorm(x, axis=-1, eps=1e-5):
    m = x.mean(dim=axis, keepdim=True)
    v = x.var(dim=axis, keepdim=True, unbiased=False)
    return (x - m) / torch.sqrt(v + eps)
def _scatter_add(tgt, idx, src, axis=0):
    return tgt.clone().index_add_(axis, idx, src)
def _segment_sum(src, seg, n):
    out = torch.zeros((n,) + src.shape[1:], dtype=src.dtype)
    return out.index_add_(0, seg, src)
def _pad(x, pw):
    flat = tuple(v for pair in reversed(pw) for v in pair)
    return torch.nn.functional.pad(x, flat)

kernel_name = 'standalone__gqa_softmax__near_ridge'

def setup_inputs():

    _w = (lambda a: (lambda t: t.to(torch.bfloat16) if t.is_floating_point() else t)(torch.as_tensor(a)))
    B, Hq, Hkv, Sq, Sk, D = 8, 32, 32, 288, 512, 192
    return {
        "q": _w((lambda *s: torch.randn(*s, dtype=torch.bfloat16) * 0.8)(B, Hq, Sq, D)),
        "k": _w((lambda *s: torch.randn(*s, dtype=torch.bfloat16) * 0.8)(B, Hkv, Sk, D)),
        "v": _w((lambda *s: torch.randn(*s, dtype=torch.bfloat16) * 0.05)(B, Hkv, Sk, D)),
    }

def reference(q, k, v):
    B, Hq, Sq, D = q.shape
    Hkv = k.shape[1]
    rep = Hq // Hkv
    k = (lambda x, n, axis: torch.repeat_interleave(x, n, dim=axis))(k, rep, axis=1)
    v = (lambda x, n, axis: torch.repeat_interleave(x, n, dim=axis))(v, rep, axis=1)
    scale = D ** -0.5
    scores = torch.einsum("bhqd,bhkd->bhqk", q, k) * scale
    p = _softmax(scores, axis=-1)
    return torch.einsum("bhqk,bhkd->bhqd", p, v)
```

```asm
; @launch grid=(256,1,1) block=(256,1,1) lds=163840
.amdgcn_target "amdgcn-amd-amdhsa--gfx950"
.text
.globl standalone__gqa_softmax__near_ridge_kernel
.p2align 8
.type standalone__gqa_softmax__near_ridge_kernel,@function
standalone__gqa_softmax__near_ridge_kernel:
    s_cmp_ge_u32 s2, 0x100
    s_cbranch_scc1 L_end
    s_load_dwordx4 s[4:7], s[0:1], 0
    s_load_dwordx4 s[8:11], s[0:1], 16
    s_getpc_b64 s[48:49]
L_pc:
    v_lshlrev_b32_e64 v33, 7, v0
    v_min_u32 v33, L_end-L_pc, v33
    v_mov_b32 v53, s49
    v_add_co_u32 v52, vcc, s48, v33
    s_nop 1
    v_addc_co_u32 v53, vcc, 0, v53, vcc
    global_load_dword v254, v[52:53], off
    v_lshrrev_b32 v34, 6, v0
    v_and_b32 v32, 63, v0
    v_readfirstlane_b32 s32, v34
    s_mul_i32 s40, s2, 0x1b000
    s_mul_i32 s41, s2, 0x30000
    v_lshrrev_b32 v35, 3, v32
    v_and_b32 v36, 7, v32
    v_lshrrev_b32 v37, 4, v32
    v_mul_u32_u24 v39, 0x180, v35
    v_xor_b32_e64 v38, v36, v37
    v_lshl_add_u32 v38, v38, 4, v39
    s_mul_i32 s44, s32, 0xc00
    s_and_b32 s45, s32, 1
    s_lshl_b32 s42, s45, 6
    v_xor_b32 v243, s42, v38
    v_add_u32 v243, s44, v243
    v_xor_b32 v40, 64, v38
    v_lshlrev_b32 v41, 1, v37
    v_xor_b32_e64 v41, v41, v36
    v_lshl_add_u32 v244, v41, 4, v39
    v_add_u32_e64 v244, s44, v244
    s_mul_i32 s43, s32, 0x6000
    s_lshr_b32 s42, s32, 1
    s_mul_i32 s42, s42, 0x1800
    s_waitcnt lgkmcnt(0)
    s_add_u32 s16, s6, s41
    s_addc_u32 s17, s7, 0
    s_mov_b32 s18, 0x30000
    s_mov_b32 s19, 0x20000
    s_add_u32 s12, s4, s40
    s_addc_u32 s13, s5, 0
    s_mov_b32 s14, 0x1b000
    s_mov_b32 s15, 0x20000
    s_add_u32 s20, s8, s41
    s_addc_u32 s21, s9, 0
    s_mov_b32 s22, 0x30000
    s_mov_b32 s23, 0x20000
    s_add_u32 s24, s10, s40
    s_addc_u32 s25, s11, 0
    s_mov_b32 s26, 0x1b000
    s_mov_b32 s27, 0x20000
    s_add_u32 m0, s44, 0
    s_mov_b32 s35, 0
    buffer_load_dwordx4 v243, s[16:19], s35 offen nt lds
    s_add_u32 m0, s44, 0x380
    s_nop 0
    buffer_load_dwordx4 v243, s[16:19], s35 offen offset:128 nt lds
    s_add_u32 m0, s44, 0x700
    s_nop 0
    buffer_load_dwordx4 v243, s[16:19], s35 offen offset:256 nt lds
    s_add_u32 m0, s44, 0x24000
    s_mov_b32 s35, 0x18000
    buffer_load_dwordx4 v243, s[12:15], s35 offen nt lds
    s_add_u32 m0, s44, 0x24380
    s_nop 0
    buffer_load_dwordx4 v243, s[12:15], s35 offen offset:128 nt lds
    s_add_u32 m0, s44, 0x24700
    s_nop 0
    buffer_load_dwordx4 v243, s[12:15], s35 offen offset:256 nt lds
    s_add_u32 m0, s44, 0x6000
    s_add_u32 s35, s43, 0
    buffer_load_dwordx4 v38, s[12:15], s35 offen nt lds
    s_add_u32 m0, s44, 0x6380
    s_nop 0
    buffer_load_dwordx4 v38, s[12:15], s35 offen offset:128 nt lds
    s_add_u32 m0, s44, 0x6700
    s_nop 0
    buffer_load_dwordx4 v38, s[12:15], s35 offen offset:256 nt lds
    s_add_u32 m0, s44, 0x18000
    s_add_u32 s35, s43, 0xc00
    buffer_load_dwordx4 v40, s[12:15], s35 offen nt lds
    s_add_u32 m0, s44, 0x18380
    s_nop 0
    buffer_load_dwordx4 v40, s[12:15], s35 offen offset:128 nt lds
    s_add_u32 m0, s44, 0x18700
    s_nop 0
    buffer_load_dwordx4 v40, s[12:15], s35 offen offset:256 nt lds
    s_mov_b32 s46, 0x3dd53b95
    s_mov_b32 s47, 0x3dd53b95
    s_mov_b32 s33, 0x4b800000
    s_mov_b32 s53, 0x3f803f80
    s_mov_b32 s39, 0x3000
    s_mov_b32 s37, 0x3000
    s_mov_b32 s34, 0
    s_add_u32 s36, s44, 0x9000
    v_and_b32 v42, 15, v32
    v_lshrrev_b32 v43, 4, v32
    v_and_b32 v44, 7, v42
    v_lshlrev_b32 v44, 7, v44
    v_lshrrev_b32 v45, 1, v42
    v_xor_b32 v45, v45, v43
    v_lshl_add_u32 v44, v45, 4, v44
    v_lshrrev_b32_e64 v45, 3, v42
    v_mul_u32_u24 v237, 0xc00, v45
    v_add_u32 v237, v237, v44
    v_xor_b32 v238, 64, v237
    v_mul_u32_u24 v46, 0x12000, v45
    v_add_u32_e64 v46, v46, v44
    s_add_u32 s40, s44, 0x6000
    v_add_u32 v46, s40, v46
    v_xor_b32 v47, 64, v46
    s_add_u32 s40, s42, 0x24000
    v_add_u32 v48, s40, v237
    v_add_u32 v49, s40, v238
    v_bfe_u32 v44, v32, 2, 3
    v_lshlrev_b32 v45, 7, v44
    v_lshrrev_b32 v44, 1, v44
    v_lshl_add_u32 v45, v44, 5, v45
    v_and_b32_e64 v44, 3, v32
    v_lshl_add_u32 v45, v44, 3, v45
    v_lshrrev_b32_e64 v44, 5, v32
    v_mul_u32_u24 v44, 0xc00, v44
    v_add_u32_e64 v45, v45, v44
    v_add_u32 v239, 0x15000, v45
    v_xor_b32 v240, 32, v239
    v_xor_b32 v241, 64, v239
    v_xor_b32 v242, 0x60, v239
    v_mov_b32 v248, 0
    v_mov_b32 v249, 0
    v_mov_b32 v250, 0
    v_mov_b32 v251, 0
    v_mov_b32 v232, 0
    v_mov_b32 v233, 0
    v_mov_b32 v234, 0
    v_mov_b32 v235, 0
    v_mov_b32 v236, 0
    s_waitcnt vmcnt(6)
    s_barrier
    ds_read_b128 v[0:3], v48
    ds_read_b128 v[4:7], v49
    ds_read_b128 v[8:11], v48 offset:1024
    ds_read_b128 v[12:15], v49 offset:1024
    ds_read_b128 v[16:19], v48 offset:2048
    ds_read_b128 v[20:23], v49 offset:2048
    ds_read_b128 v[152:155], v237
    ds_read_b128 v[156:159], v238
    ds_read_b128 v[160:163], v237 offset:1024
    ds_read_b128 v[164:167], v238 offset:1024
    ds_read_b128 v[192:195], v237 offset:2048
    ds_read_b128 v[196:199], v238 offset:2048
    ds_read_b128 v[200:203], v237 offset:6144
    ds_read_b128 v[204:207], v238 offset:6144
    ds_read_b128 a[240:243], v237 offset:7168
    ds_read_b128 a[244:247], v238 offset:7168
    ds_read_b128 a[248:251], v237 offset:8192
    ds_read_b128 a[252:255], v238 offset:8192
    v_add_u32 v237, s39, v237
    v_add_u32_e64 v238, s39, v238
    s_add_u32 m0, s44, 0x9000
    s_add_u32 s35, s43, 0x1800
    buffer_load_dwordx4 v38, s[12:15], s35 offen nt lds
    s_add_u32 m0, s44, 0x9380
    s_nop 0
    buffer_load_dwordx4 v38, s[12:15], s35 offen offset:128 nt lds
    s_add_u32 m0, s44, 0x9700
    s_nop 0
    buffer_load_dwordx4 v38, s[12:15], s35 offen offset:256 nt lds
    s_waitcnt lgkmcnt(15)
    v_lshlrev_b32 v24, 16, v0
    v_and_b32 v25, 0xffff0000, v0
    v_lshlrev_b32_e64 v26, 16, v1
    v_and_b32 v27, 0xffff0000, v1
    v_lshlrev_b32_e64 v28, 16, v2
    v_and_b32 v29, 0xffff0000, v2
    v_lshlrev_b32_e64 v30, 16, v3
    v_and_b32 v31, 0xffff0000, v3
    v_pk_mul_f32 v[24:25], v[24:25], s[46:47]
    v_pk_mul_f32 v[26:27], v[26:27], s[46:47]
    v_pk_mul_f32 v[28:29], v[28:29], s[46:47]
    v_pk_mul_f32 v[30:31], v[30:31], s[46:47]
    v_cvt_pk_bf16_f32 v24, v24, v25
    v_cvt_pk_bf16_f32 v26, v26, v27
    v_cvt_pk_bf16_f32 v28, v28, v29
    v_cvt_pk_bf16_f32 v30, v30, v31
    v_accvgpr_write_b32 a96, v24
    v_accvgpr_write_b32 a97, v26
    v_accvgpr_write_b32 a98, v28
    v_accvgpr_write_b32 a99, v30
    v_lshlrev_b32_e64 v24, 16, v4
    v_and_b32 v25, 0xffff0000, v4
    v_lshlrev_b32_e64 v26, 16, v5
    v_and_b32 v27, 0xffff0000, v5
    v_lshlrev_b32_e64 v28, 16, v6
    v_and_b32 v29, 0xffff0000, v6
    v_lshlrev_b32_e64 v30, 16, v7
    v_and_b32 v31, 0xffff0000, v7
    v_pk_mul_f32 v[24:25], v[24:25], s[46:47]
    v_pk_mul_f32 v[26:27], v[26:27], s[46:47]
    v_pk_mul_f32 v[28:29], v[28:29], s[46:47]
    v_pk_mul_f32 v[30:31], v[30:31], s[46:47]
    v_cvt_pk_bf16_f32 v24, v24, v25
    v_cvt_pk_bf16_f32 v26, v26, v27
    v_cvt_pk_bf16_f32 v28, v28, v29
    v_cvt_pk_bf16_f32 v30, v30, v31
    v_accvgpr_write_b32 a100, v24
    v_accvgpr_write_b32 a101, v26
    v_accvgpr_write_b32 a102, v28
    v_accvgpr_write_b32 a103, v30
    s_waitcnt lgkmcnt(11)
    v_mfma_f32_16x16x32_bf16 v[144:147], v[152:155], a[96:99], 0
    s_waitcnt lgkmcnt(5)
    v_mfma_f32_16x16x32_bf16 v[148:151], v[200:203], a[96:99], 0
    v_lshlrev_b32_e64 v24, 16, v8
    v_and_b32 v25, 0xffff0000, v8
    v_lshlrev_b32_e64 v26, 16, v9
    v_and_b32 v27, 0xffff0000, v9
    v_lshlrev_b32_e64 v28, 16, v10
    v_and_b32 v29, 0xffff0000, v10
    v_lshlrev_b32_e64 v30, 16, v11
    v_and_b32 v31, 0xffff0000, v11
    v_pk_mul_f32 v[24:25], v[24:25], s[46:47]
    v_pk_mul_f32 v[26:27], v[26:27], s[46:47]
    v_pk_mul_f32 v[28:29], v[28:29], s[46:47]
    v_pk_mul_f32 v[30:31], v[30:31], s[46:47]
    v_cvt_pk_bf16_f32 v24, v24, v25
    v_cvt_pk_bf16_f32 v26, v26, v27
    v_cvt_pk_bf16_f32 v28, v28, v29
    v_cvt_pk_bf16_f32 v30, v30, v31
    v_accvgpr_write_b32 a104, v24
    v_accvgpr_write_b32 a105, v26
    v_accvgpr_write_b32 a106, v28
    v_accvgpr_write_b32 a107, v30
    v_mfma_f32_16x16x32_bf16 v[144:147], v[156:159], a[100:103], v[144:147]
    s_waitcnt lgkmcnt(4)
    v_mfma_f32_16x16x32_bf16 v[148:151], v[204:207], a[100:103], v[148:151]
    v_lshlrev_b32 v24, 16, v12
    v_and_b32 v25, 0xffff0000, v12
    v_lshlrev_b32_e64 v26, 16, v13
    v_and_b32 v27, 0xffff0000, v13
    v_lshlrev_b32_e64 v28, 16, v14
    v_and_b32 v29, 0xffff0000, v14
    v_lshlrev_b32_e64 v30, 16, v15
    v_and_b32 v31, 0xffff0000, v15
    v_pk_mul_f32 v[24:25], v[24:25], s[46:47]
    v_pk_mul_f32 v[26:27], v[26:27], s[46:47]
    v_pk_mul_f32 v[28:29], v[28:29], s[46:47]
    v_pk_mul_f32 v[30:31], v[30:31], s[46:47]
    v_cvt_pk_bf16_f32 v24, v24, v25
    v_cvt_pk_bf16_f32 v26, v26, v27
    v_cvt_pk_bf16_f32 v28, v28, v29
    v_cvt_pk_bf16_f32 v30, v30, v31
    v_accvgpr_write_b32 a108, v24
    v_accvgpr_write_b32 a109, v26
    v_accvgpr_write_b32 a110, v28
    v_accvgpr_write_b32 a111, v30
    v_mfma_f32_16x16x32_bf16 v[144:147], v[160:163], a[104:107], v[144:147]
    s_waitcnt lgkmcnt(3)
    v_mfma_f32_16x16x32_bf16 v[148:151], a[240:243], a[104:107], v[148:151]
    v_lshlrev_b32 v24, 16, v16
    v_and_b32 v25, 0xffff0000, v16
    v_lshlrev_b32_e64 v26, 16, v17
    v_and_b32 v27, 0xffff0000, v17
    v_lshlrev_b32_e64 v28, 16, v18
    v_and_b32 v29, 0xffff0000, v18
    v_lshlrev_b32_e64 v30, 16, v19
    v_and_b32 v31, 0xffff0000, v19
    v_pk_mul_f32 v[24:25], v[24:25], s[46:47]
    v_pk_mul_f32 v[26:27], v[26:27], s[46:47]
    v_pk_mul_f32 v[28:29], v[28:29], s[46:47]
    v_pk_mul_f32 v[30:31], v[30:31], s[46:47]
    v_cvt_pk_bf16_f32 v24, v24, v25
    v_cvt_pk_bf16_f32 v26, v26, v27
    v_cvt_pk_bf16_f32 v28, v28, v29
    v_cvt_pk_bf16_f32 v30, v30, v31
    v_accvgpr_write_b32 a112, v24
    v_accvgpr_write_b32 a113, v26
    v_accvgpr_write_b32 a114, v28
    v_accvgpr_write_b32 a115, v30
    v_mfma_f32_16x16x32_bf16 v[144:147], v[164:167], a[108:111], v[144:147]
    s_waitcnt lgkmcnt(2)
    v_mfma_f32_16x16x32_bf16 v[148:151], a[244:247], a[108:111], v[148:151]
    v_lshlrev_b32 v24, 16, v20
    v_and_b32 v25, 0xffff0000, v20
    v_lshlrev_b32_e64 v26, 16, v21
    v_and_b32 v27, 0xffff0000, v21
    v_lshlrev_b32_e64 v28, 16, v22
    v_and_b32 v29, 0xffff0000, v22
    v_lshlrev_b32_e64 v30, 16, v23
    v_and_b32 v31, 0xffff0000, v23
    v_pk_mul_f32 v[24:25], v[24:25], s[46:47]
    v_pk_mul_f32 v[26:27], v[26:27], s[46:47]
    v_pk_mul_f32 v[28:29], v[28:29], s[46:47]
    v_pk_mul_f32 v[30:31], v[30:31], s[46:47]
    v_cvt_pk_bf16_f32 v24, v24, v25
    v_cvt_pk_bf16_f32 v26, v26, v27
    v_cvt_pk_bf16_f32 v28, v28, v29
    v_cvt_pk_bf16_f32 v30, v30, v31
    v_accvgpr_write_b32 a116, v24
    v_accvgpr_write_b32 a117, v26
    v_accvgpr_write_b32 a118, v28
    v_accvgpr_write_b32 a119, v30
    v_mfma_f32_16x16x32_bf16 v[144:147], v[192:195], a[112:115], v[144:147]
    s_waitcnt lgkmcnt(1)
    v_mfma_f32_16x16x32_bf16 v[148:151], a[248:251], a[112:115], v[148:151]
    v_mfma_f32_16x16x32_bf16 v[144:147], v[196:199], a[116:119], v[144:147]
    s_waitcnt lgkmcnt(0)
    v_mfma_f32_16x16x32_bf16 v[148:151], a[252:255], a[116:119], v[148:151]
    s_add_u32 m0, s44, 0x1b000
    s_add_u32 s35, s43, 0x2400
    buffer_load_dwordx4 v40, s[12:15], s35 offen nt lds
    s_add_u32 m0, s44, 0x1b380
    s_nop 0
    buffer_load_dwordx4 v40, s[12:15], s35 offen offset:128 nt lds
    s_add_u32 m0, s44, 0x1b700
    s_nop 0
    buffer_load_dwordx4 v40, s[12:15], s35 offen offset:256 nt lds
    v_max3_f32 v252, v144, v145, v146
    v_max3_f32 v253, v147, v148, v149
    v_max3_f32 v252, v252, v150, v151
    v_max_f32 v252, v252, v253
    v_mov_b32 v253, v252
    s_nop 1
    v_permlane16_swap_b32 v252, v253
    v_max_f32 v252, v252, v253
    v_mov_b32 v253, v252
    s_nop 1
    v_permlane32_swap_b32 v252, v253
    v_max_f32 v252, v252, v253
    v_sub_f32 v144, v144, v252
    v_sub_f32 v145, v145, v252
    v_sub_f32 v146, v146, v252
    v_sub_f32 v147, v147, v252
    v_sub_f32 v148, v148, v252
    v_sub_f32 v149, v149, v252
    v_sub_f32 v150, v150, v252
    v_sub_f32 v151, v151, v252
    v_sub_f32 v228, 0, v252
    v_sub_f32 v229, 0, v252
    v_sub_f32 v230, 0, v252
    v_sub_f32 v231, 0, v252
    v_exp_f32 v248, v144
    v_exp_f32 v249, v145
    s_nop 0
    v_add_f32_e64 v247, v248, v249
    v_cvt_pk_bf16_f32 v208, v248, v249
    v_exp_f32 v250, v146
    v_exp_f32 v251, v147
    v_add_f32 v247, v247, v250
    v_add_f32 v247, v247, v251
    v_cvt_pk_bf16_f32 v209, v250, v251
    s_waitcnt vmcnt(6)
    ds_read_b128 v[0:3], v46
    ds_read_b128 v[4:7], v47
    ds_read_b128 v[8:11], v46 offset:1024
    ds_read_b128 v[12:15], v47 offset:1024
    ds_read_b128 v[16:19], v46 offset:2048
    ds_read_b128 v[20:23], v47 offset:2048
    s_add_u32 m0, s44, 0xc000
    s_add_u32 s35, s43, 0x3000
    buffer_load_dwordx4 v38, s[12:15], s35 offen nt lds
    s_add_u32 m0, s44, 0xc380
    s_nop 0
    buffer_load_dwordx4 v38, s[12:15], s35 offen offset:128 nt lds
    s_add_u32 m0, s44, 0xc700
    s_nop 0
    buffer_load_dwordx4 v38, s[12:15], s35 offen offset:256 nt lds
    s_waitcnt lgkmcnt(5)
    v_lshlrev_b32_e64 v24, 16, v0
    v_and_b32 v25, 0xffff0000, v0
    v_lshlrev_b32_e64 v26, 16, v1
    v_and_b32 v27, 0xffff0000, v1
    v_lshlrev_b32_e64 v28, 16, v2
    v_and_b32 v29, 0xffff0000, v2
    v_lshlrev_b32_e64 v30, 16, v3
    v_and_b32 v31, 0xffff0000, v3
    v_pk_mul_f32 v[24:25], v[24:25], s[46:47]
    v_pk_mul_f32 v[26:27], v[26:27], s[46:47]
    v_pk_mul_f32 v[28:29], v[28:29], s[46:47]
    v_pk_mul_f32 v[30:31], v[30:31], s[46:47]
    v_cvt_pk_bf16_f32 v24, v24, v25
    v_cvt_pk_bf16_f32 v26, v26, v27
    v_cvt_pk_bf16_f32 v28, v28, v29
    v_cvt_pk_bf16_f32 v30, v30, v31
    v_accvgpr_write_b32 a0, v24
    v_accvgpr_write_b32 a1, v26
    v_accvgpr_write_b32 a2, v28
    v_accvgpr_write_b32 a3, v30
    s_waitcnt lgkmcnt(4)
    v_lshlrev_b32 v24, 16, v4
    v_and_b32 v25, 0xffff0000, v4
    v_lshlrev_b32_e64 v26, 16, v5
    v_and_b32 v27, 0xffff0000, v5
    v_lshlrev_b32_e64 v28, 16, v6
    v_and_b32 v29, 0xffff0000, v6
    v_lshlrev_b32_e64 v30, 16, v7
    v_and_b32 v31, 0xffff0000, v7
    v_pk_mul_f32 v[24:25], v[24:25], s[46:47]
    v_pk_mul_f32 v[26:27], v[26:27], s[46:47]
    v_pk_mul_f32 v[28:29], v[28:29], s[46:47]
    v_pk_mul_f32 v[30:31], v[30:31], s[46:47]
    v_cvt_pk_bf16_f32 v24, v24, v25
    v_cvt_pk_bf16_f32 v26, v26, v27
    v_cvt_pk_bf16_f32 v28, v28, v29
    v_cvt_pk_bf16_f32 v30, v30, v31
    v_accvgpr_write_b32 a4, v24
    v_accvgpr_write_b32 a5, v26
    v_accvgpr_write_b32 a6, v28
    v_accvgpr_write_b32 a7, v30
    v_mfma_f32_16x16x32_bf16 v[128:131], v[152:155], a[0:3], 0
    v_mfma_f32_16x16x32_bf16 v[132:135], v[200:203], a[0:3], 0
    s_waitcnt lgkmcnt(3)
    v_lshlrev_b32 v24, 16, v8
    v_and_b32 v25, 0xffff0000, v8
    v_lshlrev_b32_e64 v26, 16, v9
    v_and_b32 v27, 0xffff0000, v9
    v_lshlrev_b32_e64 v28, 16, v10
    v_and_b32 v29, 0xffff0000, v10
    v_lshlrev_b32_e64 v30, 16, v11
    v_and_b32 v31, 0xffff0000, v11
    v_pk_mul_f32 v[24:25], v[24:25], s[46:47]
    v_pk_mul_f32 v[26:27], v[26:27], s[46:47]
    v_pk_mul_f32 v[28:29], v[28:29], s[46:47]
    v_pk_mul_f32 v[30:31], v[30:31], s[46:47]
    v_cvt_pk_bf16_f32 v24, v24, v25
    v_cvt_pk_bf16_f32 v26, v26, v27
    v_cvt_pk_bf16_f32 v28, v28, v29
    v_cvt_pk_bf16_f32 v30, v30, v31
    v_accvgpr_write_b32 a8, v24
    v_accvgpr_write_b32 a9, v26
    v_accvgpr_write_b32 a10, v28
    v_accvgpr_write_b32 a11, v30
    v_mfma_f32_16x16x32_bf16 v[128:131], v[156:159], a[4:7], v[128:131]
    v_mfma_f32_16x16x32_bf16 v[132:135], v[204:207], a[4:7], v[132:135]
    s_waitcnt lgkmcnt(2)
    v_lshlrev_b32 v24, 16, v12
    v_and_b32 v25, 0xffff0000, v12
    v_lshlrev_b32_e64 v26, 16, v13
    v_and_b32 v27, 0xffff0000, v13
    v_lshlrev_b32_e64 v28, 16, v14
    v_and_b32 v29, 0xffff0000, v14
    v_lshlrev_b32_e64 v30, 16, v15
    v_and_b32 v31, 0xffff0000, v15
    v_pk_mul_f32 v[24:25], v[24:25], s[46:47]
    v_pk_mul_f32 v[26:27], v[26:27], s[46:47]
    v_pk_mul_f32 v[28:29], v[28:29], s[46:47]
    v_pk_mul_f32 v[30:31], v[30:31], s[46:47]
    v_cvt_pk_bf16_f32 v24, v24, v25
    v_cvt_pk_bf16_f32 v26, v26, v27
    v_cvt_pk_bf16_f32 v28, v28, v29
    v_cvt_pk_bf16_f32 v30, v30, v31
    v_accvgpr_write_b32 a12, v24
    v_accvgpr_write_b32 a13, v26
    v_accvgpr_write_b32 a14, v28
    v_accvgpr_write_b32 a15, v30
    v_mfma_f32_16x16x32_bf16 v[128:131], v[160:163], a[8:11], v[128:131]
    v_mfma_f32_16x16x32_bf16 v[132:135], a[240:243], a[8:11], v[132:135]
    s_waitcnt lgkmcnt(1)
    v_lshlrev_b32 v24, 16, v16
    v_and_b32 v25, 0xffff0000, v16
    v_lshlrev_b32_e64 v26, 16, v17
    v_and_b32 v27, 0xffff0000, v17
    v_lshlrev_b32_e64 v28, 16, v18
    v_and_b32 v29, 0xffff0000, v18
    v_lshlrev_b32_e64 v30, 16, v19
    v_and_b32 v31, 0xffff0000, v19
    v_pk_mul_f32 v[24:25], v[24:25], s[46:47]
    v_pk_mul_f32 v[26:27], v[26:27], s[46:47]
    v_pk_mul_f32 v[28:29], v[28:29], s[46:47]
    v_pk_mul_f32 v[30:31], v[30:31], s[46:47]
    v_cvt_pk_bf16_f32 v24, v24, v25
    v_cvt_pk_bf16_f32 v26, v26, v27
    v_cvt_pk_bf16_f32 v28, v28, v29
    v_cvt_pk_bf16_f32 v30, v30, v31
    v_accvgpr_write_b32 a16, v24
    v_accvgpr_write_b32 a17, v26
    v_accvgpr_write_b32 a18, v28
    v_accvgpr_write_b32 a19, v30
    v_mfma_f32_16x16x32_bf16 v[128:131], v[164:167], a[12:15], v[128:131]
    v_mfma_f32_16x16x32_bf16 v[132:135], a[244:247], a[12:15], v[132:135]
    s_waitcnt lgkmcnt(0)
    v_lshlrev_b32 v24, 16, v20
    v_and_b32 v25, 0xffff0000, v20
    v_lshlrev_b32_e64 v26, 16, v21
    v_and_b32 v27, 0xffff0000, v21
    v_lshlrev_b32_e64 v28, 16, v22
    v_and_b32 v29, 0xffff0000, v22
    v_lshlrev_b32_e64 v30, 16, v23
    v_and_b32 v31, 0xffff0000, v23
    v_pk_mul_f32 v[24:25], v[24:25], s[46:47]
    v_pk_mul_f32 v[26:27], v[26:27], s[46:47]
    v_pk_mul_f32 v[28:29], v[28:29], s[46:47]
    v_pk_mul_f32 v[30:31], v[30:31], s[46:47]
    v_cvt_pk_bf16_f32 v24, v24, v25
    v_cvt_pk_bf16_f32 v26, v26, v27
    v_cvt_pk_bf16_f32 v28, v28, v29
    v_cvt_pk_bf16_f32 v30, v30, v31
    v_accvgpr_write_b32 a20, v24
    v_accvgpr_write_b32 a21, v26
    v_accvgpr_write_b32 a22, v28
    v_accvgpr_write_b32 a23, v30
    v_mfma_f32_16x16x32_bf16 v[128:131], v[192:195], a[16:19], v[128:131]
    v_mfma_f32_16x16x32_bf16 v[132:135], a[248:251], a[16:19], v[132:135]
    v_mfma_f32_16x16x32_bf16 v[128:131], v[196:199], a[20:23], v[128:131]
    v_mfma_f32_16x16x32_bf16 v[132:135], a[252:255], a[20:23], v[132:135]
    s_add_u32 m0, s44, 0x1e000
    s_add_u32 s35, s43, 0x3c00
    buffer_load_dwordx4 v40, s[12:15], s35 offen nt lds
    s_add_u32 m0, s44, 0x1e380
    s_nop 0
    buffer_load_dwordx4 v40, s[12:15], s35 offen offset:128 nt lds
    s_add_u32 m0, s44, 0x1e700
    s_nop 0
    buffer_load_dwordx4 v40, s[12:15], s35 offen offset:256 nt lds
    v_max3_f32 v252, v128, v129, v130
    v_max3_f32 v253, v131, v132, v133
    v_max3_f32 v252, v252, v134, v135
    v_max_f32 v252, v252, v253
    v_mov_b32 v253, v252
    s_nop 1
    v_permlane16_swap_b32 v252, v253
    v_max_f32 v252, v252, v253
    v_mov_b32 v253, v252
    s_nop 1
    v_permlane32_swap_b32 v252, v253
    v_max_f32 v252, v252, v253
    v_sub_f32 v128, v128, v252
    v_sub_f32 v129, v129, v252
    v_sub_f32 v130, v130, v252
    v_sub_f32 v131, v131, v252
    v_sub_f32 v132, v132, v252
    v_sub_f32 v133, v133, v252
    v_sub_f32 v134, v134, v252
    v_sub_f32 v135, v135, v252
    v_sub_f32 v212, 0, v252
    v_sub_f32 v213, 0, v252
    v_sub_f32 v214, 0, v252
    v_sub_f32 v215, 0, v252
    v_exp_f32 v252, v128
    v_exp_f32 v253, v129
    s_nop 0
    v_add_f32_e64 v232, v252, v253
    v_cvt_pk_bf16_f32 v184, v252, v253
    v_exp_f32 v248, v130
    v_exp_f32 v249, v131
    v_add_f32 v232, v232, v248
    v_add_f32 v232, v232, v249
    v_cvt_pk_bf16_f32 v185, v248, v249
    v_exp_f32 v250, v132
    v_exp_f32 v251, v133
    v_add_f32 v232, v232, v250
    v_add_f32 v232, v232, v251
    v_cvt_pk_bf16_f32 v186, v250, v251
    v_exp_f32 v252, v134
    v_exp_f32 v253, v135
    v_add_f32 v232, v232, v252
    v_add_f32 v232, v232, v253
    v_cvt_pk_bf16_f32 v187, v252, v253
    s_waitcnt vmcnt(6)
    ds_read_b128 v[0:3], v46 offset:12288
    ds_read_b128 v[4:7], v47 offset:12288
    ds_read_b128 v[8:11], v46 offset:13312
    ds_read_b128 v[12:15], v47 offset:13312
    ds_read_b128 v[16:19], v46 offset:14336
    ds_read_b128 v[20:23], v47 offset:14336
    s_add_u32 m0, s44, 0xf000
    s_add_u32 s35, s43, 0x4800
    buffer_load_dwordx4 v38, s[12:15], s35 offen nt lds
    s_add_u32 m0, s44, 0xf380
    s_nop 0
    buffer_load_dwordx4 v38, s[12:15], s35 offen offset:128 nt lds
    s_add_u32 m0, s44, 0xf700
    s_nop 0
    buffer_load_dwordx4 v38, s[12:15], s35 offen offset:256 nt lds
    s_waitcnt lgkmcnt(5)
    v_lshlrev_b32_e64 v24, 16, v0
    v_and_b32 v25, 0xffff0000, v0
    v_lshlrev_b32_e64 v26, 16, v1
    v_and_b32 v27, 0xffff0000, v1
    v_lshlrev_b32_e64 v28, 16, v2
    v_and_b32 v29, 0xffff0000, v2
    v_lshlrev_b32_e64 v30, 16, v3
    v_and_b32 v31, 0xffff0000, v3
    v_pk_mul_f32 v[24:25], v[24:25], s[46:47]
    v_pk_mul_f32 v[26:27], v[26:27], s[46:47]
    v_pk_mul_f32 v[28:29], v[28:29], s[46:47]
    v_pk_mul_f32 v[30:31], v[30:31], s[46:47]
    v_cvt_pk_bf16_f32 v24, v24, v25
    v_cvt_pk_bf16_f32 v26, v26, v27
    v_cvt_pk_bf16_f32 v28, v28, v29
    v_cvt_pk_bf16_f32 v30, v30, v31
    v_accvgpr_write_b32 a24, v24
    v_accvgpr_write_b32 a25, v26
    v_accvgpr_write_b32 a26, v28
    v_accvgpr_write_b32 a27, v30
    s_waitcnt lgkmcnt(4)
    v_lshlrev_b32 v24, 16, v4
    v_and_b32 v25, 0xffff0000, v4
    v_lshlrev_b32_e64 v26, 16, v5
    v_and_b32 v27, 0xffff0000, v5
    v_lshlrev_b32_e64 v28, 16, v6
    v_and_b32 v29, 0xffff0000, v6
    v_lshlrev_b32_e64 v30, 16, v7
    v_and_b32 v31, 0xffff0000, v7
    v_pk_mul_f32 v[24:25], v[24:25], s[46:47]
    v_pk_mul_f32 v[26:27], v[26:27], s[46:47]
    v_pk_mul_f32 v[28:29], v[28:29], s[46:47]
    v_pk_mul_f32 v[30:31], v[30:31], s[46:47]
    v_cvt_pk_bf16_f32 v24, v24, v25
    v_cvt_pk_bf16_f32 v26, v26, v27
    v_cvt_pk_bf16_f32 v28, v28, v29
    v_cvt_pk_bf16_f32 v30, v30, v31
    v_accvgpr_write_b32 a28, v24
    v_accvgpr_write_b32 a29, v26
    v_accvgpr_write_b32 a30, v28
    v_accvgpr_write_b32 a31, v30
    v_mfma_f32_16x16x32_bf16 v[136:139], v[152:155], a[24:27], 0
    v_mfma_f32_16x16x32_bf16 v[140:143], v[200:203], a[24:27], 0
    s_waitcnt lgkmcnt(3)
    v_lshlrev_b32 v24, 16, v8
    v_and_b32 v25, 0xffff0000, v8
    v_lshlrev_b32_e64 v26, 16, v9
    v_and_b32 v27, 0xffff0000, v9
    v_lshlrev_b32_e64 v28, 16, v10
    v_and_b32 v29, 0xffff0000, v10
    v_lshlrev_b32_e64 v30, 16, v11
    v_and_b32 v31, 0xffff0000, v11
    v_pk_mul_f32 v[24:25], v[24:25], s[46:47]
    v_pk_mul_f32 v[26:27], v[26:27], s[46:47]
    v_pk_mul_f32 v[28:29], v[28:29], s[46:47]
    v_pk_mul_f32 v[30:31], v[30:31], s[46:47]
    v_cvt_pk_bf16_f32 v24, v24, v25
    v_cvt_pk_bf16_f32 v26, v26, v27
    v_cvt_pk_bf16_f32 v28, v28, v29
    v_cvt_pk_bf16_f32 v30, v30, v31
    v_accvgpr_write_b32 a32, v24
    v_accvgpr_write_b32 a33, v26
    v_accvgpr_write_b32 a34, v28
    v_accvgpr_write_b32 a35, v30
    v_mfma_f32_16x16x32_bf16 v[136:139], v[156:159], a[28:31], v[136:139]
    v_mfma_f32_16x16x32_bf16 v[140:143], v[204:207], a[28:31], v[140:143]
    s_waitcnt lgkmcnt(2)
    v_lshlrev_b32 v24, 16, v12
    v_and_b32 v25, 0xffff0000, v12
    v_lshlrev_b32_e64 v26, 16, v13
    v_and_b32 v27, 0xffff0000, v13
    v_lshlrev_b32_e64 v28, 16, v14
    v_and_b32 v29, 0xffff0000, v14
    v_lshlrev_b32_e64 v30, 16, v15
    v_and_b32 v31, 0xffff0000, v15
    v_pk_mul_f32 v[24:25], v[24:25], s[46:47]
    v_pk_mul_f32 v[26:27], v[26:27], s[46:47]
    v_pk_mul_f32 v[28:29], v[28:29], s[46:47]
    v_pk_mul_f32 v[30:31], v[30:31], s[46:47]
    v_cvt_pk_bf16_f32 v24, v24, v25
    v_cvt_pk_bf16_f32 v26, v26, v27
    v_cvt_pk_bf16_f32 v28, v28, v29
    v_cvt_pk_bf16_f32 v30, v30, v31
    v_accvgpr_write_b32 a36, v24
    v_accvgpr_write_b32 a37, v26
    v_accvgpr_write_b32 a38, v28
    v_accvgpr_write_b32 a39, v30
    v_mfma_f32_16x16x32_bf16 v[136:139], v[160:163], a[32:35], v[136:139]
    v_mfma_f32_16x16x32_bf16 v[140:143], a[240:243], a[32:35], v[140:143]
    s_waitcnt lgkmcnt(1)
    v_lshlrev_b32 v24, 16, v16
    v_and_b32 v25, 0xffff0000, v16
    v_lshlrev_b32_e64 v26, 16, v17
    v_and_b32 v27, 0xffff0000, v17
    v_lshlrev_b32_e64 v28, 16, v18
    v_and_b32 v29, 0xffff0000, v18
    v_lshlrev_b32_e64 v30, 16, v19
    v_and_b32 v31, 0xffff0000, v19
    v_pk_mul_f32 v[24:25], v[24:25], s[46:47]
    v_pk_mul_f32 v[26:27], v[26:27], s[46:47]
    v_pk_mul_f32 v[28:29], v[28:29], s[46:47]
    v_pk_mul_f32 v[30:31], v[30:31], s[46:47]
    v_cvt_pk_bf16_f32 v24, v24, v25
    v_cvt_pk_bf16_f32 v26, v26, v27
    v_cvt_pk_bf16_f32 v28, v28, v29
    v_cvt_pk_bf16_f32 v30, v30, v31
    v_accvgpr_write_b32 a40, v24
    v_accvgpr_write_b32 a41, v26
    v_accvgpr_write_b32 a42, v28
    v_accvgpr_write_b32 a43, v30
    v_mfma_f32_16x16x32_bf16 v[136:139], v[164:167], a[36:39], v[136:139]
    v_mfma_f32_16x16x32_bf16 v[140:143], a[244:247], a[36:39], v[140:143]
    s_waitcnt lgkmcnt(0)
    v_lshlrev_b32 v24, 16, v20
    v_and_b32 v25, 0xffff0000, v20
    v_lshlrev_b32_e64 v26, 16, v21
    v_and_b32 v27, 0xffff0000, v21
    v_lshlrev_b32_e64 v28, 16, v22
    v_and_b32 v29, 0xffff0000, v22
    v_lshlrev_b32_e64 v30, 16, v23
    v_and_b32 v31, 0xffff0000, v23
    v_pk_mul_f32 v[24:25], v[24:25], s[46:47]
    v_pk_mul_f32 v[26:27], v[26:27], s[46:47]
    v_pk_mul_f32 v[28:29], v[28:29], s[46:47]
    v_pk_mul_f32 v[30:31], v[30:31], s[46:47]
    v_cvt_pk_bf16_f32 v24, v24, v25
    v_cvt_pk_bf16_f32 v26, v26, v27
    v_cvt_pk_bf16_f32 v28, v28, v29
    v_cvt_pk_bf16_f32 v30, v30, v31
    v_accvgpr_write_b32 a44, v24
    v_accvgpr_write_b32 a45, v26
    v_accvgpr_write_b32 a46, v28
    v_accvgpr_write_b32 a47, v30
    v_mfma_f32_16x16x32_bf16 v[136:139], v[192:195], a[40:43], v[136:139]
    v_mfma_f32_16x16x32_bf16 v[140:143], a[248:251], a[40:43], v[140:143]
    v_mfma_f32_16x16x32_bf16 v[136:139], v[196:199], a[44:47], v[136:139]
    v_mfma_f32_16x16x32_bf16 v[140:143], a[252:255], a[44:47], v[140:143]
    s_add_u32 m0, s44, 0x21000
    s_add_u32 s35, s43, 0x5400
    buffer_load_dwordx4 v40, s[12:15], s35 offen nt lds
    s_add_u32 m0, s44, 0x21380
    s_nop 0
    buffer_load_dwordx4 v40, s[12:15], s35 offen offset:128 nt lds
    s_add_u32 m0, s44, 0x21700
    s_nop 0
    buffer_load_dwordx4 v40, s[12:15], s35 offen offset:256 nt lds
    v_max3_f32 v252, v136, v137, v138
    v_max3_f32 v253, v139, v140, v141
    v_max3_f32 v252, v252, v142, v143
    v_max_f32 v252, v252, v253
    v_mov_b32 v253, v252
    s_nop 1
    v_permlane16_swap_b32 v252, v253
    v_max_f32 v252, v252, v253
    v_mov_b32 v253, v252
    s_nop 1
    v_permlane32_swap_b32 v252, v253
    v_max_f32 v252, v252, v253
    v_sub_f32 v136, v136, v252
    v_sub_f32 v137, v137, v252
    v_sub_f32 v138, v138, v252
    v_sub_f32 v139, v139, v252
    v_sub_f32 v140, v140, v252
    v_sub_f32 v141, v141, v252
    v_sub_f32 v142, v142, v252
    v_sub_f32 v143, v143, v252
    v_sub_f32 v216, 0, v252
    v_sub_f32 v217, 0, v252
    v_sub_f32 v218, 0, v252
    v_sub_f32 v219, 0, v252
    v_exp_f32 v248, v136
    v_exp_f32 v249, v137
    s_nop 0
    v_add_f32_e64 v233, v248, v249
    v_cvt_pk_bf16_f32 v188, v248, v249
    v_exp_f32 v250, v138
    v_exp_f32 v251, v139
    v_add_f32 v233, v233, v250
    v_add_f32 v233, v233, v251
    v_cvt_pk_bf16_f32 v189, v250, v251
    v_exp_f32 v252, v140
    v_exp_f32 v253, v141
    v_add_f32 v233, v233, v252
    v_add_f32 v233, v233, v253
    v_cvt_pk_bf16_f32 v190, v252, v253
    v_exp_f32 v248, v142
    v_exp_f32 v249, v143
    v_add_f32 v233, v233, v248
    v_add_f32 v233, v233, v249
    v_cvt_pk_bf16_f32 v191, v248, v249
    s_waitcnt vmcnt(6)
    ds_read_b128 v[0:3], v46 offset:24576
    ds_read_b128 v[4:7], v47 offset:24576
    ds_read_b128 v[8:11], v46 offset:25600
    ds_read_b128 v[12:15], v47 offset:25600
    ds_read_b128 v[16:19], v46 offset:26624
    ds_read_b128 v[20:23], v47 offset:26624
    s_add_u32 m0, s44, 0x3000
    s_mov_b32 s35, 0x3000
    buffer_load_dwordx4 v243, s[16:19], s35 offen nt lds
    s_add_u32 m0, s44, 0x3380
    s_nop 0
    buffer_load_dwordx4 v243, s[16:19], s35 offen offset:128 nt lds
    s_add_u32 m0, s44, 0x3700
    s_nop 0
    buffer_load_dwordx4 v243, s[16:19], s35 offen offset:256 nt lds
    s_waitcnt lgkmcnt(5)
    v_lshlrev_b32_e64 v24, 16, v0
    v_and_b32 v25, 0xffff0000, v0
    v_lshlrev_b32_e64 v26, 16, v1
    v_and_b32 v27, 0xffff0000, v1
    v_lshlrev_b32_e64 v28, 16, v2
    v_and_b32 v29, 0xffff0000, v2
    v_lshlrev_b32_e64 v30, 16, v3
    v_and_b32 v31, 0xffff0000, v3
    v_pk_mul_f32 v[24:25], v[24:25], s[46:47]
    v_pk_mul_f32 v[26:27], v[26:27], s[46:47]
    v_pk_mul_f32 v[28:29], v[28:29], s[46:47]
    v_pk_mul_f32 v[30:31], v[30:31], s[46:47]
    v_cvt_pk_bf16_f32 v24, v24, v25
    v_cvt_pk_bf16_f32 v26, v26, v27
    v_cvt_pk_bf16_f32 v28, v28, v29
    v_cvt_pk_bf16_f32 v30, v30, v31
    v_accvgpr_write_b32 a48, v24
    v_accvgpr_write_b32 a49, v26
    v_accvgpr_write_b32 a50, v28
    v_accvgpr_write_b32 a51, v30
    s_waitcnt lgkmcnt(4)
    v_lshlrev_b32 v24, 16, v4
    v_and_b32 v25, 0xffff0000, v4
    v_lshlrev_b32_e64 v26, 16, v5
    v_and_b32 v27, 0xffff0000, v5
    v_lshlrev_b32_e64 v28, 16, v6
    v_and_b32 v29, 0xffff0000, v6
    v_lshlrev_b32_e64 v30, 16, v7
    v_and_b32 v31, 0xffff0000, v7
    v_pk_mul_f32 v[24:25], v[24:25], s[46:47]
    v_pk_mul_f32 v[26:27], v[26:27], s[46:47]
    v_pk_mul_f32 v[28:29], v[28:29], s[46:47]
    v_pk_mul_f32 v[30:31], v[30:31], s[46:47]
    v_cvt_pk_bf16_f32 v24, v24, v25
    v_cvt_pk_bf16_f32 v26, v26, v27
    v_cvt_pk_bf16_f32 v28, v28, v29
    v_cvt_pk_bf16_f32 v30, v30, v31
    v_accvgpr_write_b32 a52, v24
    v_accvgpr_write_b32 a53, v26
    v_accvgpr_write_b32 a54, v28
    v_accvgpr_write_b32 a55, v30
    v_mfma_f32_16x16x32_bf16 v[168:171], v[152:155], a[48:51], 0
    v_mfma_f32_16x16x32_bf16 v[172:175], v[200:203], a[48:51], 0
    s_waitcnt lgkmcnt(3)
    v_lshlrev_b32 v24, 16, v8
    v_and_b32 v25, 0xffff0000, v8
    v_lshlrev_b32_e64 v26, 16, v9
    v_and_b32 v27, 0xffff0000, v9
    v_lshlrev_b32_e64 v28, 16, v10
    v_and_b32 v29, 0xffff0000, v10
    v_lshlrev_b32_e64 v30, 16, v11
    v_and_b32 v31, 0xffff0000, v11
    v_pk_mul_f32 v[24:25], v[24:25], s[46:47]
    v_pk_mul_f32 v[26:27], v[26:27], s[46:47]
    v_pk_mul_f32 v[28:29], v[28:29], s[46:47]
    v_pk_mul_f32 v[30:31], v[30:31], s[46:47]
    v_cvt_pk_bf16_f32 v24, v24, v25
    v_cvt_pk_bf16_f32 v26, v26, v27
    v_cvt_pk_bf16_f32 v28, v28, v29
    v_cvt_pk_bf16_f32 v30, v30, v31
    v_accvgpr_write_b32 a56, v24
    v_accvgpr_write_b32 a57, v26
    v_accvgpr_write_b32 a58, v28
    v_accvgpr_write_b32 a59, v30
    v_mfma_f32_16x16x32_bf16 v[168:171], v[156:159], a[52:55], v[168:171]
    v_mfma_f32_16x16x32_bf16 v[172:175], v[204:207], a[52:55], v[172:175]
    s_waitcnt lgkmcnt(2)
    v_lshlrev_b32 v24, 16, v12
    v_and_b32 v25, 0xffff0000, v12
    v_lshlrev_b32_e64 v26, 16, v13
    v_and_b32 v27, 0xffff0000, v13
    v_lshlrev_b32_e64 v28, 16, v14
    v_and_b32 v29, 0xffff0000, v14
    v_lshlrev_b32_e64 v30, 16, v15
    v_and_b32 v31, 0xffff0000, v15
    v_pk_mul_f32 v[24:25], v[24:25], s[46:47]
    v_pk_mul_f32 v[26:27], v[26:27], s[46:47]
    v_pk_mul_f32 v[28:29], v[28:29], s[46:47]
    v_pk_mul_f32 v[30:31], v[30:31], s[46:47]
    v_cvt_pk_bf16_f32 v24, v24, v25
    v_cvt_pk_bf16_f32 v26, v26, v27
    v_cvt_pk_bf16_f32 v28, v28, v29
    v_cvt_pk_bf16_f32 v30, v30, v31
    v_accvgpr_write_b32 a60, v24
    v_accvgpr_write_b32 a61, v26
    v_accvgpr_write_b32 a62, v28
    v_accvgpr_write_b32 a63, v30
    v_mfma_f32_16x16x32_bf16 v[168:171], v[160:163], a[56:59], v[168:171]
    v_mfma_f32_16x16x32_bf16 v[172:175], a[240:243], a[56:59], v[172:175]
    s_waitcnt lgkmcnt(1)
    v_lshlrev_b32 v24, 16, v16
    v_and_b32 v25, 0xffff0000, v16
    v_lshlrev_b32_e64 v26, 16, v17
    v_and_b32 v27, 0xffff0000, v17
    v_lshlrev_b32_e64 v28, 16, v18
    v_and_b32 v29, 0xffff0000, v18
    v_lshlrev_b32_e64 v30, 16, v19
    v_and_b32 v31, 0xffff0000, v19
    v_pk_mul_f32 v[24:25], v[24:25], s[46:47]
    v_pk_mul_f32 v[26:27], v[26:27], s[46:47]
    v_pk_mul_f32 v[28:29], v[28:29], s[46:47]
    v_pk_mul_f32 v[30:31], v[30:31], s[46:47]
    v_cvt_pk_bf16_f32 v24, v24, v25
    v_cvt_pk_bf16_f32 v26, v26, v27
    v_cvt_pk_bf16_f32 v28, v28, v29
    v_cvt_pk_bf16_f32 v30, v30, v31
    v_accvgpr_write_b32 a64, v24
    v_accvgpr_write_b32 a65, v26
    v_accvgpr_write_b32 a66, v28
    v_accvgpr_write_b32 a67, v30
    v_mfma_f32_16x16x32_bf16 v[168:171], v[164:167], a[60:63], v[168:171]
    v_mfma_f32_16x16x32_bf16 v[172:175], a[244:247], a[60:63], v[172:175]
    s_waitcnt lgkmcnt(0)
    v_lshlrev_b32 v24, 16, v20
    v_and_b32 v25, 0xffff0000, v20
    v_lshlrev_b32_e64 v26, 16, v21
    v_and_b32 v27, 0xffff0000, v21
    v_lshlrev_b32_e64 v28, 16, v22
    v_and_b32 v29, 0xffff0000, v22
    v_lshlrev_b32_e64 v30, 16, v23
    v_and_b32 v31, 0xffff0000, v23
    v_pk_mul_f32 v[24:25], v[24:25], s[46:47]
    v_pk_mul_f32 v[26:27], v[26:27], s[46:47]
    v_pk_mul_f32 v[28:29], v[28:29], s[46:47]
    v_pk_mul_f32 v[30:31], v[30:31], s[46:47]
    v_cvt_pk_bf16_f32 v24, v24, v25
    v_cvt_pk_bf16_f32 v26, v26, v27
    v_cvt_pk_bf16_f32 v28, v28, v29
    v_cvt_pk_bf16_f32 v30, v30, v31
    v_accvgpr_write_b32 a68, v24
    v_accvgpr_write_b32 a69, v26
    v_accvgpr_write_b32 a70, v28
    v_accvgpr_write_b32 a71, v30
    v_mfma_f32_16x16x32_bf16 v[168:171], v[192:195], a[64:67], v[168:171]
    v_mfma_f32_16x16x32_bf16 v[172:175], a[248:251], a[64:67], v[172:175]
    v_mfma_f32_16x16x32_bf16 v[168:171], v[196:199], a[68:71], v[168:171]
    v_mfma_f32_16x16x32_bf16 v[172:175], a[252:255], a[68:71], v[172:175]
    s_add_u32 m0, s44, 0x15000
    s_mov_b32 s35, 0
    buffer_load_dwordx4 v244, s[20:23], s35 offen nt lds
    s_add_u32 m0, s44, 0x15380
    s_nop 0
    buffer_load_dwordx4 v244, s[20:23], s35 offen offset:128 nt lds
    s_add_u32 m0, s44, 0x15700
    s_nop 0
    buffer_load_dwordx4 v244, s[20:23], s35 offen offset:256 nt lds
    v_max3_f32 v252, v168, v169, v170
    v_max3_f32 v253, v171, v172, v173
    v_max3_f32 v252, v252, v174, v175
    v_max_f32 v252, v252, v253
    v_mov_b32 v253, v252
    s_nop 1
    v_permlane16_swap_b32 v252, v253
    v_max_f32 v252, v252, v253
    v_mov_b32 v253, v252
    s_nop 1
    v_permlane32_swap_b32 v252, v253
    v_max_f32 v252, v252, v253
    v_sub_f32 v168, v168, v252
    v_sub_f32 v169, v169, v252
    v_sub_f32 v170, v170, v252
    v_sub_f32 v171, v171, v252
    v_sub_f32 v172, v172, v252
    v_sub_f32 v173, v173, v252
    v_sub_f32 v174, v174, v252
    v_sub_f32 v175, v175, v252
    v_sub_f32 v220, 0, v252
    v_sub_f32 v221, 0, v252
    v_sub_f32 v222, 0, v252
    v_sub_f32 v223, 0, v252
    s_waitcnt vmcnt(6)
    ds_read_b128 v[0:3], v46 offset:36864
    ds_read_b128 v[4:7], v47 offset:36864
    ds_read_b128 v[8:11], v46 offset:37888
    ds_read_b128 v[12:15], v47 offset:37888
    ds_read_b128 v[16:19], v46 offset:38912
    ds_read_b128 v[20:23], v47 offset:38912
    s_add_u32 m0, s44, 0x6000
    s_mov_b32 s35, 0x6000
    buffer_load_dwordx4 v243, s[16:19], s35 offen nt lds
    s_add_u32 m0, s44, 0x6380
    s_nop 0
    buffer_load_dwordx4 v243, s[16:19], s35 offen offset:128 nt lds
    s_add_u32 m0, s44, 0x6700
    s_nop 0
    buffer_load_dwordx4 v243, s[16:19], s35 offen offset:256 nt lds
    s_waitcnt lgkmcnt(5)
    v_lshlrev_b32_e64 v24, 16, v0
    v_and_b32 v25, 0xffff0000, v0
    v_lshlrev_b32_e64 v26, 16, v1
    v_and_b32 v27, 0xffff0000, v1
    v_lshlrev_b32_e64 v28, 16, v2
    v_and_b32 v29, 0xffff0000, v2
    v_lshlrev_b32_e64 v30, 16, v3
    v_and_b32 v31, 0xffff0000, v3
    v_pk_mul_f32 v[24:25], v[24:25], s[46:47]
    v_pk_mul_f32 v[26:27], v[26:27], s[46:47]
    v_pk_mul_f32 v[28:29], v[28:29], s[46:47]
    v_pk_mul_f32 v[30:31], v[30:31], s[46:47]
    v_cvt_pk_bf16_f32 v24, v24, v25
    v_cvt_pk_bf16_f32 v26, v26, v27
    v_cvt_pk_bf16_f32 v28, v28, v29
    v_cvt_pk_bf16_f32 v30, v30, v31
    v_accvgpr_write_b32 a72, v24
    v_accvgpr_write_b32 a73, v26
    v_accvgpr_write_b32 a74, v28
    v_accvgpr_write_b32 a75, v30
    s_waitcnt lgkmcnt(4)
    v_lshlrev_b32 v24, 16, v4
    v_and_b32 v25, 0xffff0000, v4
    v_lshlrev_b32_e64 v26, 16, v5
    v_and_b32 v27, 0xffff0000, v5
    v_lshlrev_b32_e64 v28, 16, v6
    v_and_b32 v29, 0xffff0000, v6
    v_lshlrev_b32_e64 v30, 16, v7
    v_and_b32 v31, 0xffff0000, v7
    v_pk_mul_f32 v[24:25], v[24:25], s[46:47]
    v_pk_mul_f32 v[26:27], v[26:27], s[46:47]
    v_pk_mul_f32 v[28:29], v[28:29], s[46:47]
    v_pk_mul_f32 v[30:31], v[30:31], s[46:47]
    v_cvt_pk_bf16_f32 v24, v24, v25
    v_cvt_pk_bf16_f32 v26, v26, v27
    v_cvt_pk_bf16_f32 v28, v28, v29
    v_cvt_pk_bf16_f32 v30, v30, v31
    v_accvgpr_write_b32 a76, v24
    v_accvgpr_write_b32 a77, v26
    v_accvgpr_write_b32 a78, v28
    v_accvgpr_write_b32 a79, v30
    v_mfma_f32_16x16x32_bf16 v[176:179], v[152:155], a[72:75], 0
    v_mfma_f32_16x16x32_bf16 v[180:183], v[200:203], a[72:75], 0
    s_waitcnt lgkmcnt(3)
    v_lshlrev_b32 v24, 16, v8
    v_and_b32 v25, 0xffff0000, v8
    v_lshlrev_b32_e64 v26, 16, v9
    v_and_b32 v27, 0xffff0000, v9
    v_lshlrev_b32_e64 v28, 16, v10
    v_and_b32 v29, 0xffff0000, v10
    v_lshlrev_b32_e64 v30, 16, v11
    v_and_b32 v31, 0xffff0000, v11
    v_pk_mul_f32 v[24:25], v[24:25], s[46:47]
    v_pk_mul_f32 v[26:27], v[26:27], s[46:47]
    v_pk_mul_f32 v[28:29], v[28:29], s[46:47]
    v_pk_mul_f32 v[30:31], v[30:31], s[46:47]
    v_cvt_pk_bf16_f32 v24, v24, v25
    v_cvt_pk_bf16_f32 v26, v26, v27
    v_cvt_pk_bf16_f32 v28, v28, v29
    v_cvt_pk_bf16_f32 v30, v30, v31
    v_accvgpr_write_b32 a80, v24
    v_accvgpr_write_b32 a81, v26
    v_accvgpr_write_b32 a82, v28
    v_accvgpr_write_b32 a83, v30
    v_mfma_f32_16x16x32_bf16 v[176:179], v[156:159], a[76:79], v[176:179]
    v_mfma_f32_16x16x32_bf16 v[180:183], v[204:207], a[76:79], v[180:183]
    s_waitcnt lgkmcnt(2)
    v_lshlrev_b32 v24, 16, v12
    v_and_b32 v25, 0xffff0000, v12
    v_lshlrev_b32_e64 v26, 16, v13
    v_and_b32 v27, 0xffff0000, v13
    v_lshlrev_b32_e64 v28, 16, v14
    v_and_b32 v29, 0xffff0000, v14
    v_lshlrev_b32_e64 v30, 16, v15
    v_and_b32 v31, 0xffff0000, v15
    v_pk_mul_f32 v[24:25], v[24:25], s[46:47]
    v_pk_mul_f32 v[26:27], v[26:27], s[46:47]
    v_pk_mul_f32 v[28:29], v[28:29], s[46:47]
    v_pk_mul_f32 v[30:31], v[30:31], s[46:47]
    v_cvt_pk_bf16_f32 v24, v24, v25
    v_cvt_pk_bf16_f32 v26, v26, v27
    v_cvt_pk_bf16_f32 v28, v28, v29
    v_cvt_pk_bf16_f32 v30, v30, v31
    v_accvgpr_write_b32 a84, v24
    v_accvgpr_write_b32 a85, v26
    v_accvgpr_write_b32 a86, v28
    v_accvgpr_write_b32 a87, v30
    v_mfma_f32_16x16x32_bf16 v[176:179], v[160:163], a[80:83], v[176:179]
    v_mfma_f32_16x16x32_bf16 v[180:183], a[240:243], a[80:83], v[180:183]
    s_waitcnt lgkmcnt(1)
    v_lshlrev_b32 v24, 16, v16
    v_and_b32 v25, 0xffff0000, v16
    v_lshlrev_b32_e64 v26, 16, v17
    v_and_b32 v27, 0xffff0000, v17
    v_lshlrev_b32_e64 v28, 16, v18
    v_and_b32 v29, 0xffff0000, v18
    v_lshlrev_b32_e64 v30, 16, v19
    v_and_b32 v31, 0xffff0000, v19
    v_pk_mul_f32 v[24:25], v[24:25], s[46:47]
    v_pk_mul_f32 v[26:27], v[26:27], s[46:47]
    v_pk_mul_f32 v[28:29], v[28:29], s[46:47]
    v_pk_mul_f32 v[30:31], v[30:31], s[46:47]
    v_cvt_pk_bf16_f32 v24, v24, v25
    v_cvt_pk_bf16_f32 v26, v26, v27
    v_cvt_pk_bf16_f32 v28, v28, v29
    v_cvt_pk_bf16_f32 v30, v30, v31
    v_accvgpr_write_b32 a88, v24
    v_accvgpr_write_b32 a89, v26
    v_accvgpr_write_b32 a90, v28
    v_accvgpr_write_b32 a91, v30
    v_mfma_f32_16x16x32_bf16 v[176:179], v[164:167], a[84:87], v[176:179]
    v_mfma_f32_16x16x32_bf16 v[180:183], a[244:247], a[84:87], v[180:183]
    s_waitcnt lgkmcnt(0)
    v_lshlrev_b32 v24, 16, v20
    v_and_b32 v25, 0xffff0000, v20
    v_lshlrev_b32_e64 v26, 16, v21
    v_and_b32 v27, 0xffff0000, v21
    v_lshlrev_b32_e64 v28, 16, v22
    v_and_b32 v29, 0xffff0000, v22
    v_lshlrev_b32_e64 v30, 16, v23
    v_and_b32 v31, 0xffff0000, v23
    v_pk_mul_f32 v[24:25], v[24:25], s[46:47]
    v_pk_mul_f32 v[26:27], v[26:27], s[46:47]
    v_pk_mul_f32 v[28:29], v[28:29], s[46:47]
    v_pk_mul_f32 v[30:31], v[30:31], s[46:47]
    v_cvt_pk_bf16_f32 v24, v24, v25
    v_cvt_pk_bf16_f32 v26, v26, v27
    v_cvt_pk_bf16_f32 v28, v28, v29
    v_cvt_pk_bf16_f32 v30, v30, v31
    v_accvgpr_write_b32 a92, v24
    v_accvgpr_write_b32 a93, v26
    v_accvgpr_write_b32 a94, v28
    v_accvgpr_write_b32 a95, v30
    v_mfma_f32_16x16x32_bf16 v[176:179], v[192:195], a[88:91], v[176:179]
    v_mfma_f32_16x16x32_bf16 v[180:183], a[248:251], a[88:91], v[180:183]
    v_mfma_f32_16x16x32_bf16 v[176:179], v[196:199], a[92:95], v[176:179]
    v_mfma_f32_16x16x32_bf16 v[180:183], a[252:255], a[92:95], v[180:183]
    s_add_u32 m0, s44, 0x18000
    s_mov_b32 s35, 0x3000
    buffer_load_dwordx4 v244, s[20:23], s35 offen nt lds
    s_add_u32 m0, s44, 0x18380
    s_nop 0
    buffer_load_dwordx4 v244, s[20:23], s35 offen offset:128 nt lds
    s_add_u32 m0, s44, 0x18700
    s_nop 0
    buffer_load_dwordx4 v244, s[20:23], s35 offen offset:256 nt lds
    v_max3_f32 v252, v176, v177, v178
    v_max3_f32 v253, v179, v180, v181
    v_max3_f32 v252, v252, v182, v183
    v_max_f32 v252, v252, v253
    v_mov_b32 v253, v252
    s_nop 1
    v_permlane16_swap_b32 v252, v253
    v_max_f32 v252, v252, v253
    v_mov_b32 v253, v252
    s_nop 1
    v_permlane32_swap_b32 v252, v253
    v_max_f32 v252, v252, v253
    v_sub_f32 v176, v176, v252
    v_sub_f32 v177, v177, v252
    v_sub_f32 v178, v178, v252
    v_sub_f32 v179, v179, v252
    v_sub_f32 v180, v180, v252
    v_sub_f32 v181, v181, v252
    v_sub_f32 v182, v182, v252
    v_sub_f32 v183, v183, v252
    v_sub_f32 v224, 0, v252
    v_sub_f32 v225, 0, v252
    v_sub_f32 v226, 0, v252
    v_sub_f32 v227, 0, v252
    s_waitcnt vmcnt(9)
    s_barrier
    ds_read_b128 a[232:235], v237
    ds_read_b128 a[236:239], v238
    ds_read_b128 a[240:243], v237 offset:1024
    ds_read_b128 a[244:247], v238 offset:1024
    v_add_u32 v243, 0x3000, v243
    s_mov_b32 s35, 0x6000
    s_waitcnt lgkmcnt(2)
    s_cmp_lg_u32 s45, 0
    s_cbranch_scc1 L_enterB
L_A0:
    v_mfma_f32_16x16x32_bf16 v[128:131], a[232:235], a[0:3], v[212:215]
    s_bitcmp1_b32 0x10410, s34
    ds_read_b128 a[248:251], v237 offset:2048
    ds_read_b128 a[252:255], v238 offset:2048
    v_exp_f32_e64 v248, v168
    v_mfma_f32_16x16x32_bf16 v[128:131], a[236:239], a[4:7], v[128:131]
    s_cselect_b32 s37, 0xffff1000, s39
    v_exp_f32 v249, v169
    v_exp_f32 v250, v170
    v_mfma_f32_16x16x32_bf16 v[136:139], a[232:235], a[24:27], v[216:219]
    s_bitcmp1_b32 0x4104104, s34
    v_add_f32 v245, v248, v249
    v_exp_f32 v251, v171
    v_cvt_pk_bf16_f32 v200, v248, v249
    v_mfma_f32_16x16x32_bf16 v[136:139], a[236:239], a[28:31], v[136:139]
    s_cselect_b32 s38, 0xffff1000, s39
    v_add_f32 v245, v245, v250
    v_add_f32 v245, v245, v251
    v_exp_f32_e64 v252, v172
    v_mfma_f32_16x16x32_bf16 v[152:155], a[232:235], a[48:51], v[220:223]
    v_exp_f32_e64 v253, v173
    v_cvt_pk_bf16_f32 v201, v250, v251
    v_add_f32_e64 v245, v245, v252
    v_mfma_f32_16x16x32_bf16 v[152:155], a[236:239], a[52:55], v[152:155]
    v_add_f32 v245, v245, v253
    v_exp_f32 v248, v174
    v_cvt_pk_bf16_f32 v202, v252, v253
    v_mfma_f32_16x16x32_bf16 v[160:163], a[232:235], a[72:75], v[224:227]
    v_exp_f32 v249, v175
    v_exp_f32 v250, v176
    v_mfma_f32_16x16x32_bf16 v[160:163], a[236:239], a[76:79], v[160:163]
    ds_read_b128 a[232:235], v237 offset:6144
    ds_read_b128 a[236:239], v238 offset:6144
    v_add_f32 v245, v245, v248
    v_add_f32 v245, v245, v249
    s_waitcnt lgkmcnt(5)
    v_mfma_f32_16x16x32_bf16 v[160:163], a[240:243], a[80:83], v[160:163]
    v_exp_f32 v251, v177
    v_exp_f32 v252, v178
    s_waitcnt lgkmcnt(4)
    v_mfma_f32_16x16x32_bf16 v[160:163], a[244:247], a[84:87], v[160:163]
    v_cvt_pk_bf16_f32 v203, v248, v249
    v_add_f32 v246, v250, v251
    v_exp_f32 v253, v179
    v_mfma_f32_16x16x32_bf16 v[152:155], a[240:243], a[56:59], v[152:155]
    v_cvt_pk_bf16_f32 v204, v250, v251
    v_add_f32 v246, v246, v252
    v_add_f32 v246, v246, v253
    v_cvt_pk_bf16_f32 v205, v252, v253
    v_mfma_f32_16x16x32_bf16 v[152:155], a[244:247], a[60:63], v[152:155]
    v_exp_f32 v248, v180
    v_exp_f32 v249, v181
    v_mfma_f32_16x16x32_bf16 v[136:139], a[240:243], a[32:35], v[136:139]
    v_add_f32 v246, v246, v248
    v_add_f32 v246, v246, v249
    v_exp_f32_e64 v250, v182
    v_mfma_f32_16x16x32_bf16 v[136:139], a[244:247], a[36:39], v[136:139]
    v_exp_f32_e64 v251, v183
    v_cvt_pk_bf16_f32 v206, v248, v249
    v_add_f32_e64 v246, v246, v250
    v_mfma_f32_16x16x32_bf16 v[128:131], a[240:243], a[8:11], v[128:131]
    v_add_f32 v246, v246, v251
    v_exp_f32 v252, v148
    v_cvt_pk_bf16_f32 v207, v250, v251
    v_mfma_f32_16x16x32_bf16 v[128:131], a[244:247], a[12:15], v[128:131]
    ds_read_b128 a[240:243], v237 offset:7168
    ds_read_b128 a[244:247], v238 offset:7168
    v_exp_f32 v253, v149
    s_waitcnt lgkmcnt(5)
    v_mfma_f32_16x16x32_bf16 v[128:131], a[248:251], a[16:19], v[128:131]
    v_add_f32 v247, v247, v252
    v_add_f32 v247, v247, v253
    v_exp_f32 v248, v150
    s_waitcnt lgkmcnt(4)
    v_mfma_f32_16x16x32_bf16 v[128:131], a[252:255], a[20:23], v[128:131]
    v_exp_f32_e64 v249, v151
    v_cvt_pk_bf16_f32 v210, v252, v253
    v_add_f32_e64 v247, v247, v248
    v_mfma_f32_16x16x32_bf16 v[136:139], a[248:251], a[40:43], v[136:139]
    v_add_f32_e64 v247, v247, v249
    v_cvt_pk_bf16_f32 v211, v248, v249
    v_max3_f32 v250, v245, v246, v247
    v_cmp_lt_f32_e64 vcc, s33, v250
    v_mfma_f32_16x16x32_bf16 v[136:139], a[252:255], a[44:47], v[136:139]
    v_mfma_f32_16x16x32_bf16 v[152:155], a[248:251], a[64:67], v[152:155]
    v_mfma_f32_16x16x32_bf16 v[152:155], a[252:255], a[68:71], v[152:155]
    v_mfma_f32_16x16x32_bf16 v[160:163], a[248:251], a[88:91], v[160:163]
    v_mfma_f32_16x16x32_bf16 v[160:163], a[252:255], a[92:95], v[160:163]
    ds_read_b128 a[248:251], v237 offset:8192
    ds_read_b128 a[252:255], v238 offset:8192
    s_waitcnt lgkmcnt(5)
    v_mfma_f32_16x16x32_bf16 v[132:135], a[232:235], a[0:3], v[212:215]
    s_waitcnt lgkmcnt(4)
    v_mfma_f32_16x16x32_bf16 v[132:135], a[236:239], a[4:7], v[132:135]
    v_mfma_f32_16x16x32_bf16 v[140:143], a[232:235], a[24:27], v[216:219]
    v_mfma_f32_16x16x32_bf16 v[140:143], a[236:239], a[28:31], v[140:143]
    v_mfma_f32_16x16x32_bf16 v[156:159], a[232:235], a[48:51], v[220:223]
    v_mfma_f32_16x16x32_bf16 v[156:159], a[236:239], a[52:55], v[156:159]
    v_mfma_f32_16x16x32_bf16 v[164:167], a[232:235], a[72:75], v[224:227]
    s_waitcnt vmcnt(6)
    s_barrier
    v_mfma_f32_16x16x32_bf16 v[164:167], a[236:239], a[76:79], v[164:167]
    ds_read_b64_tr_b16 a[232:233], v239
    ds_read_b64_tr_b16 a[234:235], v239 offset:6144
    ds_read_b64_tr_b16 a[236:237], v240
    ds_read_b64_tr_b16 a[238:239], v240 offset:6144
    s_waitcnt lgkmcnt(7)
    v_mfma_f32_16x16x32_bf16 v[164:167], a[240:243], a[80:83], v[164:167]
    s_waitcnt lgkmcnt(6)
    v_mfma_f32_16x16x32_bf16 v[164:167], a[244:247], a[84:87], v[164:167]
    v_mfma_f32_16x16x32_bf16 v[156:159], a[240:243], a[56:59], v[156:159]
    v_mfma_f32_16x16x32_bf16 v[156:159], a[244:247], a[60:63], v[156:159]
    v_mfma_f32_16x16x32_bf16 v[140:143], a[240:243], a[32:35], v[140:143]
    v_mfma_f32_16x16x32_bf16 v[140:143], a[244:247], a[36:39], v[140:143]
    v_mfma_f32_16x16x32_bf16 v[132:135], a[240:243], a[8:11], v[132:135]
    v_mfma_f32_16x16x32_bf16 v[132:135], a[244:247], a[12:15], v[132:135]
    ds_read_b64_tr_b16 a[240:241], v241
    ds_read_b64_tr_b16 a[242:243], v241 offset:6144
    ds_read_b64_tr_b16 a[244:245], v242
    ds_read_b64_tr_b16 a[246:247], v242 offset:6144
    s_waitcnt lgkmcnt(9)
    v_mfma_f32_16x16x32_bf16 v[132:135], a[248:251], a[16:19], v[132:135]
    s_waitcnt lgkmcnt(8)
    v_mfma_f32_16x16x32_bf16 v[132:135], a[252:255], a[20:23], v[132:135]
    v_mfma_f32_16x16x32_bf16 v[140:143], a[248:251], a[40:43], v[140:143]
    v_mfma_f32_16x16x32_bf16 v[140:143], a[252:255], a[44:47], v[140:143]
    v_mfma_f32_16x16x32_bf16 v[156:159], a[248:251], a[64:67], v[156:159]
    v_mfma_f32_16x16x32_bf16 v[156:159], a[252:255], a[68:71], v[156:159]
    v_mfma_f32_16x16x32_bf16 v[164:167], a[248:251], a[88:91], v[164:167]
    v_mfma_f32_16x16x32_bf16 v[164:167], a[252:255], a[92:95], v[164:167]
    ds_read_b64_tr_b16 a[248:249], v239 offset:1024
    ds_read_b64_tr_b16 a[250:251], v239 offset:7168
    ds_read_b64_tr_b16 a[252:253], v240 offset:1024
    ds_read_b64_tr_b16 a[254:255], v240 offset:7168
    s_waitcnt lgkmcnt(10)
    v_mfma_f32_16x16x32_bf16 v[0:3], a[232:235], v[184:187], 0
    s_waitcnt lgkmcnt(8)
    v_mfma_f32_16x16x32_bf16 v[4:7], a[236:239], v[184:187], 0
    v_mfma_f32_16x16x32_bf16 v[48:51], a[232:235], v[188:191], 0
    s_cbranch_vccnz L_slow1A0
L_ret1A0:
    v_add_f32 v234, v234, v245
    v_add_f32 v235, v235, v246
    v_add_f32 v236, v236, v247
    v_add_u32_e64 v237, s37, v237
    v_mfma_f32_16x16x32_bf16 v[52:55], a[236:239], v[188:191], 0
    v_exp_f32 v251, v128
    v_exp_f32 v252, v129
    v_mfma_f32_16x16x32_bf16 v[96:99], a[232:235], v[200:203], 0
    v_add_u32 v238, s37, v238
    v_add_f32 v254, v251, v252
    v_exp_f32_e64 v253, v130
    v_mfma_f32_16x16x32_bf16 v[100:103], a[236:239], v[200:203], 0
    v_exp_f32_e64 v248, v131
    v_cvt_pk_bf16_f32 v192, v251, v252
    v_add_f32_e64 v254, v254, v253
    v_mfma_f32_16x16x32_bf16 a[168:171], a[232:235], v[204:207], 0
    v_add_f32 v254, v254, v248
    v_exp_f32 v249, v136
    v_cvt_pk_bf16_f32 v193, v253, v248
    v_mfma_f32_16x16x32_bf16 a[172:175], a[236:239], v[204:207], 0
    v_exp_f32 v250, v137
    v_exp_f32 v251, v138
    v_mfma_f32_16x16x32_bf16 a[120:123], a[232:235], v[208:211], 0
    v_add_f32 v246, v249, v250
    v_exp_f32 v252, v139
    v_cvt_pk_bf16_f32 v196, v249, v250
    v_mfma_f32_16x16x32_bf16 a[124:127], a[236:239], v[208:211], 0
    ds_read_b64_tr_b16 a[232:233], v241 offset:1024
    ds_read_b64_tr_b16 a[234:235], v241 offset:7168
    ds_read_b64_tr_b16 a[236:237], v242 offset:1024
    ds_read_b64_tr_b16 a[238:239], v242 offset:7168
    s_waitcnt lgkmcnt(10)
    v_mfma_f32_16x16x32_bf16 a[128:131], a[240:243], v[208:211], 0
    v_add_f32 v246, v246, v251
    v_add_f32 v246, v246, v252
    v_exp_f32 v253, v132
    s_waitcnt lgkmcnt(8)
    v_mfma_f32_16x16x32_bf16 a[132:135], a[244:247], v[208:211], 0
    v_exp_f32 v248, v133
    v_cvt_pk_bf16_f32 v197, v251, v252
    v_add_f32_e64 v254, v254, v253
    v_mfma_f32_16x16x32_bf16 a[176:179], a[240:243], v[204:207], 0
    v_add_f32 v254, v254, v248
    v_exp_f32 v249, v134
    v_cvt_pk_bf16_f32 v194, v253, v248
    v_mfma_f32_16x16x32_bf16 a[180:183], a[244:247], v[204:207], 0
    v_exp_f32 v250, v135
    v_exp_f32 v251, v140
    v_mfma_f32_16x16x32_bf16 v[104:107], a[240:243], v[200:203], 0
    v_add_f32 v254, v254, v249
    v_add_f32 v254, v254, v250
    v_exp_f32_e64 v252, v141
    v_mfma_f32_16x16x32_bf16 v[108:111], a[244:247], v[200:203], 0
    v_cvt_pk_bf16_f32 v195, v249, v250
    v_add_f32 v246, v246, v251
    v_add_f32 v246, v246, v252
    v_cvt_pk_bf16_f32 v198, v251, v252
    v_mfma_f32_16x16x32_bf16 v[56:59], a[240:243], v[188:191], 0
    v_exp_f32 v253, v142
    v_exp_f32 v248, v143
    v_mfma_f32_16x16x32_bf16 v[60:63], a[244:247], v[188:191], 0
    v_add_f32 v246, v246, v253
    v_add_f32 v246, v246, v248
    v_cvt_pk_bf16_f32 v199, v253, v248
    v_max_f32_e64 v249, v254, v246
    v_mfma_f32_16x16x32_bf16 v[8:11], a[240:243], v[184:187], 0
    v_cmp_lt_f32_e64 vcc, s33, v249
    v_mfma_f32_16x16x32_bf16 v[12:15], a[244:247], v[184:187], 0
    ds_read_b64_tr_b16 a[240:241], v239 offset:2048
    ds_read_b64_tr_b16 a[242:243], v239 offset:8192
    ds_read_b64_tr_b16 a[244:245], v240 offset:2048
    ds_read_b64_tr_b16 a[246:247], v240 offset:8192
    s_waitcnt lgkmcnt(10)
    v_mfma_f32_16x16x32_bf16 v[16:19], a[248:251], v[184:187], 0
    s_waitcnt lgkmcnt(8)
    v_mfma_f32_16x16x32_bf16 v[20:23], a[252:255], v[184:187], 0
    v_mfma_f32_16x16x32_bf16 v[64:67], a[248:251], v[188:191], 0
    v_mfma_f32_16x16x32_bf16 v[68:71], a[252:255], v[188:191], 0
    v_mfma_f32_16x16x32_bf16 v[112:115], a[248:251], v[200:203], 0
    v_mfma_f32_16x16x32_bf16 v[116:119], a[252:255], v[200:203], 0
    s_add_u32 m0, s36, 0
    v_mfma_f32_16x16x32_bf16 a[184:187], a[248:251], v[204:207], 0
    buffer_load_dwordx4 v243, s[16:19], s35 offen nt lds
    v_mfma_f32_16x16x32_bf16 a[188:191], a[252:255], v[204:207], 0
    s_add_u32 m0, s36, 0x380
    v_mfma_f32_16x16x32_bf16 a[136:139], a[248:251], v[208:211], 0
    buffer_load_dwordx4 v243, s[16:19], s35 offen offset:128 nt lds
    v_mfma_f32_16x16x32_bf16 a[140:143], a[252:255], v[208:211], 0
    ds_read_b64_tr_b16 a[248:249], v241 offset:2048
    ds_read_b64_tr_b16 a[250:251], v241 offset:8192
    ds_read_b64_tr_b16 a[252:253], v242 offset:2048
    ds_read_b64_tr_b16 a[254:255], v242 offset:8192
    s_waitcnt lgkmcnt(10)
    v_mfma_f32_16x16x32_bf16 a[144:147], a[232:235], v[208:211], 0
    v_add_u32 v241, s37, v241
    v_add_u32 v242, s37, v242
    s_waitcnt lgkmcnt(8)
    v_mfma_f32_16x16x32_bf16 a[148:151], a[236:239], v[208:211], 0
    s_add_u32 m0, s36, 0x700
    v_mfma_f32_16x16x32_bf16 a[192:195], a[232:235], v[204:207], 0
    buffer_load_dwordx4 v243, s[16:19], s35 offen offset:256 nt lds
    v_mfma_f32_16x16x32_bf16 a[196:199], a[236:239], v[204:207], 0
    s_add_u32 m0, s36, 0x12000
    v_mfma_f32_16x16x32_bf16 v[120:123], a[232:235], v[200:203], 0
    buffer_load_dwordx4 v244, s[20:23], s35 offen nt lds
    v_mfma_f32_16x16x32_bf16 v[124:127], a[236:239], v[200:203], 0
    s_add_u32 m0, s36, 0x12380
    v_mfma_f32_16x16x32_bf16 v[72:75], a[232:235], v[188:191], 0
    buffer_load_dwordx4 v244, s[20:23], s35 offen offset:128 nt lds
    v_mfma_f32_16x16x32_bf16 v[76:79], a[236:239], v[188:191], 0
    v_mfma_f32_16x16x32_bf16 v[24:27], a[232:235], v[184:187], 0
    s_add_u32 m0, s36, 0x12700
    v_mfma_f32_16x16x32_bf16 v[28:31], a[236:239], v[184:187], 0
    buffer_load_dwordx4 v244, s[20:23], s35 offen offset:256 nt lds
    s_waitcnt lgkmcnt(6)
    v_mfma_f32_16x16x32_bf16 v[32:35], a[240:243], v[184:187], 0
    s_waitcnt lgkmcnt(4)
    v_mfma_f32_16x16x32_bf16 v[36:39], a[244:247], v[184:187], 0
    s_add_u32 s36, s36, s38
    v_mfma_f32_16x16x32_bf16 v[80:83], a[240:243], v[188:191], 0
    s_add_u32 s35, s35, 0x3000
    v_mfma_f32_16x16x32_bf16 v[84:87], a[244:247], v[188:191], 0
    s_waitcnt vmcnt(6) lgkmcnt(0)
    s_barrier
    ds_read_b128 a[232:235], v237
    ds_read_b128 a[236:239], v238
    v_mfma_f32_16x16x32_bf16 a[216:219], a[240:243], v[200:203], 0
    s_cmp_ge_u32 s34, 13
    v_mfma_f32_16x16x32_bf16 a[220:223], a[244:247], v[200:203], 0
    s_cselect_b32 s36, 0x28000, s36
    v_mfma_f32_16x16x32_bf16 a[200:203], a[240:243], v[204:207], 0
    s_add_u32 s34, s34, 1
    v_mfma_f32_16x16x32_bf16 a[204:207], a[244:247], v[204:207], 0
    v_mfma_f32_16x16x32_bf16 a[152:155], a[240:243], v[208:211], 0
    v_mfma_f32_16x16x32_bf16 a[156:159], a[244:247], v[208:211], 0
    ds_read_b128 a[240:243], v237 offset:1024
    ds_read_b128 a[244:247], v238 offset:1024
    v_mfma_f32_16x16x32_bf16 v[40:43], a[248:251], v[184:187], 0
    v_mfma_f32_16x16x32_bf16 v[44:47], a[252:255], v[184:187], 0
    v_mfma_f32_16x16x32_bf16 v[88:91], a[248:251], v[188:191], 0
    v_mfma_f32_16x16x32_bf16 v[92:95], a[252:255], v[188:191], 0
    v_mfma_f32_16x16x32_bf16 a[224:227], a[248:251], v[200:203], 0
    v_mfma_f32_16x16x32_bf16 a[228:231], a[252:255], v[200:203], 0
    v_mfma_f32_16x16x32_bf16 a[208:211], a[248:251], v[204:207], 0
    v_mfma_f32_16x16x32_bf16 a[212:215], a[252:255], v[204:207], 0
    s_cbranch_vccnz L_slow0A0
L_ret0A0:
    v_add_f32 v232, v232, v254
    v_add_f32_e64 v233, v233, v246
    v_mfma_f32_16x16x32_bf16 a[160:163], a[248:251], v[208:211], 0
    v_add_u32 v239, s37, v239
    v_add_u32 v240, s37, v240
    v_mfma_f32_16x16x32_bf16 a[164:167], a[252:255], v[208:211], 0
    s_waitcnt lgkmcnt(2)
    s_branch L_B
L_A:
    v_mfma_f32_16x16x32_bf16 v[128:131], a[232:235], a[0:3], v[212:215]
    s_bitcmp1_b32 0x10410, s34
    ds_read_b128 a[248:251], v237 offset:2048
    ds_read_b128 a[252:255], v238 offset:2048
    v_mfma_f32_16x16x32_bf16 v[128:131], a[236:239], a[4:7], v[128:131]
    s_cselect_b32 s37, 0xffff1000, s39
    v_exp_f32 v250, v168
    v_mfma_f32_16x16x32_bf16 v[136:139], a[232:235], a[24:27], v[216:219]
    s_bitcmp1_b32 0x4104104, s34
    v_exp_f32 v251, v169
    v_mfma_f32_16x16x32_bf16 v[136:139], a[236:239], a[28:31], v[136:139]
    s_cselect_b32 s38, 0xffff1000, s39
    v_add_f32 v245, v250, v251
    v_cvt_pk_bf16_f32 v200, v250, v251
    v_mfma_f32_16x16x32_bf16 v[152:155], a[232:235], a[48:51], v[220:223]
    v_exp_f32 v252, v170
    v_mfma_f32_16x16x32_bf16 v[152:155], a[236:239], a[52:55], v[152:155]
    v_exp_f32 v253, v171
    v_mfma_f32_16x16x32_bf16 v[160:163], a[232:235], a[72:75], v[224:227]
    v_add_f32 v245, v245, v252
    v_add_f32 v245, v245, v253
    v_mfma_f32_16x16x32_bf16 v[160:163], a[236:239], a[76:79], v[160:163]
    s_waitcnt lgkmcnt(3)
    ds_read_b128 a[232:235], v237 offset:6144
    ds_read_b128 a[236:239], v238 offset:6144
    v_mfma_f32_16x16x32_bf16 v[160:163], a[240:243], a[80:83], v[160:163]
    s_waitcnt lgkmcnt(4)
    v_exp_f32 v248, v172
    v_mfma_f32_16x16x32_bf16 v[160:163], a[244:247], a[84:87], v[160:163]
    v_exp_f32 v249, v173
    v_mfma_f32_16x16x32_bf16 v[152:155], a[240:243], a[56:59], v[152:155]
    v_cvt_pk_bf16_f32 v201, v252, v253
    v_add_f32 v245, v245, v248
    v_mfma_f32_16x16x32_bf16 v[152:155], a[244:247], a[60:63], v[152:155]
    v_add_f32 v245, v245, v249
    v_cvt_pk_bf16_f32 v202, v248, v249
    v_mfma_f32_16x16x32_bf16 v[136:139], a[240:243], a[32:35], v[136:139]
    v_exp_f32 v250, v174
    v_mfma_f32_16x16x32_bf16 v[136:139], a[244:247], a[36:39], v[136:139]
    v_exp_f32 v251, v175
    v_mfma_f32_16x16x32_bf16 v[128:131], a[240:243], a[8:11], v[128:131]
    v_add_f32 v245, v245, v250
    v_add_f32 v245, v245, v251
    v_mfma_f32_16x16x32_bf16 v[128:131], a[244:247], a[12:15], v[128:131]
    s_waitcnt lgkmcnt(3)
    ds_read_b128 a[240:243], v237 offset:7168
    ds_read_b128 a[244:247], v238 offset:7168
    v_mfma_f32_16x16x32_bf16 v[128:131], a[248:251], a[16:19], v[128:131]
    s_waitcnt lgkmcnt(4)
    v_exp_f32 v252, v176
    v_mfma_f32_16x16x32_bf16 v[128:131], a[252:255], a[20:23], v[128:131]
    v_exp_f32 v253, v177
    v_mfma_f32_16x16x32_bf16 v[136:139], a[248:251], a[40:43], v[136:139]
    v_cvt_pk_bf16_f32 v203, v250, v251
    v_add_f32 v246, v252, v253
    v_mfma_f32_16x16x32_bf16 v[136:139], a[252:255], a[44:47], v[136:139]
    v_exp_f32 v248, v178
    v_mfma_f32_16x16x32_bf16 v[152:155], a[248:251], a[64:67], v[152:155]
    v_exp_f32 v249, v179
    v_mfma_f32_16x16x32_bf16 v[152:155], a[252:255], a[68:71], v[152:155]
    v_cvt_pk_bf16_f32 v204, v252, v253
    v_add_f32 v246, v246, v248
    v_mfma_f32_16x16x32_bf16 v[160:163], a[248:251], a[88:91], v[160:163]
    v_add_f32 v246, v246, v249
    v_cvt_pk_bf16_f32 v205, v248, v249
    v_mfma_f32_16x16x32_bf16 v[160:163], a[252:255], a[92:95], v[160:163]
    s_waitcnt lgkmcnt(3)
    ds_read_b128 a[248:251], v237 offset:8192
    ds_read_b128 a[252:255], v238 offset:8192
    v_mfma_f32_16x16x32_bf16 v[132:135], a[232:235], a[0:3], v[212:215]
    s_waitcnt lgkmcnt(4)
    v_exp_f32 v250, v180
    v_mfma_f32_16x16x32_bf16 v[132:135], a[236:239], a[4:7], v[132:135]
    v_exp_f32 v251, v181
    v_mfma_f32_16x16x32_bf16 v[140:143], a[232:235], a[24:27], v[216:219]
    v_add_f32 v246, v246, v250
    v_add_f32 v246, v246, v251
    v_mfma_f32_16x16x32_bf16 v[140:143], a[236:239], a[28:31], v[140:143]
    v_exp_f32 v252, v182
    v_mfma_f32_16x16x32_bf16 v[156:159], a[232:235], a[48:51], v[220:223]
    v_exp_f32 v253, v183
    v_mfma_f32_16x16x32_bf16 v[156:159], a[236:239], a[52:55], v[156:159]
    v_cvt_pk_bf16_f32 v206, v250, v251
    v_add_f32 v246, v246, v252
    v_mfma_f32_16x16x32_bf16 v[164:167], a[232:235], a[72:75], v[224:227]
    v_add_f32 v246, v246, v253
    v_cvt_pk_bf16_f32 v207, v252, v253
    v_mfma_f32_16x16x32_bf16 v[164:167], a[236:239], a[76:79], v[164:167]
    s_waitcnt lgkmcnt(3)
    ds_read_b64_tr_b16 a[232:233], v239
    ds_read_b64_tr_b16 a[234:235], v239 offset:6144
    v_mfma_f32_16x16x32_bf16 v[164:167], a[240:243], a[80:83], v[164:167]
    s_waitcnt lgkmcnt(4)
    ds_read_b64_tr_b16 a[236:237], v240
    ds_read_b64_tr_b16 a[238:239], v240 offset:6144
    v_mfma_f32_16x16x32_bf16 v[164:167], a[244:247], a[84:87], v[164:167]
    v_exp_f32 v248, v148
    v_mfma_f32_16x16x32_bf16 v[156:159], a[240:243], a[56:59], v[156:159]
    v_exp_f32 v249, v149
    v_mfma_f32_16x16x32_bf16 v[156:159], a[244:247], a[60:63], v[156:159]
    v_add_f32 v247, v247, v248
    v_add_f32 v247, v247, v249
    v_mfma_f32_16x16x32_bf16 v[140:143], a[240:243], a[32:35], v[140:143]
    v_exp_f32 v250, v150
    v_mfma_f32_16x16x32_bf16 v[140:143], a[244:247], a[36:39], v[140:143]
    v_exp_f32 v251, v151
    v_mfma_f32_16x16x32_bf16 v[132:135], a[240:243], a[8:11], v[132:135]
    v_cvt_pk_bf16_f32 v210, v248, v249
    v_add_f32 v247, v247, v250
    v_mfma_f32_16x16x32_bf16 v[132:135], a[244:247], a[12:15], v[132:135]
    s_waitcnt lgkmcnt(5)
    ds_read_b64_tr_b16 a[240:241], v241
    ds_read_b64_tr_b16 a[242:243], v241 offset:6144
    v_mfma_f32_16x16x32_bf16 v[132:135], a[248:251], a[16:19], v[132:135]
    s_waitcnt lgkmcnt(6)
    ds_read_b64_tr_b16 a[244:245], v242
    ds_read_b64_tr_b16 a[246:247], v242 offset:6144
    v_mfma_f32_16x16x32_bf16 v[132:135], a[252:255], a[20:23], v[132:135]
    v_add_f32 v247, v247, v251
    v_cvt_pk_bf16_f32 v211, v250, v251
    v_mfma_f32_16x16x32_bf16 v[140:143], a[248:251], a[40:43], v[140:143]
    v_max3_f32 v252, v245, v246, v247
    v_cmp_lt_f32 vcc, s33, v252
    v_mfma_f32_16x16x32_bf16 v[140:143], a[252:255], a[44:47], v[140:143]
    v_mfma_f32_16x16x32_bf16 v[156:159], a[248:251], a[64:67], v[156:159]
    v_mfma_f32_16x16x32_bf16 v[156:159], a[252:255], a[68:71], v[156:159]
    v_mfma_f32_16x16x32_bf16 v[164:167], a[248:251], a[88:91], v[164:167]
    v_mfma_f32_16x16x32_bf16 v[164:167], a[252:255], a[92:95], v[164:167]
    s_waitcnt lgkmcnt(6)
    ds_read_b64_tr_b16 a[248:249], v239 offset:1024
    ds_read_b64_tr_b16 a[250:251], v239 offset:7168
    v_mfma_f32_16x16x32_bf16 v[0:3], a[232:235], v[184:187], v[0:3]
    s_waitcnt lgkmcnt(6)
    ds_read_b64_tr_b16 a[252:253], v240 offset:1024
    ds_read_b64_tr_b16 a[254:255], v240 offset:7168
    v_mfma_f32_16x16x32_bf16 v[4:7], a[236:239], v[184:187], v[4:7]
    v_mfma_f32_16x16x32_bf16 v[48:51], a[232:235], v[188:191], v[48:51]
    s_cbranch_vccnz L_slow1A
L_ret1A:
    v_add_f32 v234, v234, v245
    v_add_f32 v235, v235, v246
    v_mfma_f32_16x16x32_bf16 v[52:55], a[236:239], v[188:191], v[52:55]
    v_add_f32 v236, v236, v247
    v_add_u32 v237, s37, v237
    v_mfma_f32_16x16x32_bf16 v[96:99], a[232:235], v[200:203], v[96:99]
    v_exp_f32 v253, v128
    v_mfma_f32_16x16x32_bf16 v[100:103], a[236:239], v[200:203], v[100:103]
    v_exp_f32 v248, v129
    v_mfma_f32_16x16x32_bf16 a[168:171], a[232:235], v[204:207], a[168:171]
    v_add_u32 v238, s37, v238
    v_add_f32 v254, v253, v248
    v_mfma_f32_16x16x32_bf16 a[172:175], a[236:239], v[204:207], a[172:175]
    v_exp_f32 v249, v130
    v_mfma_f32_16x16x32_bf16 a[120:123], a[232:235], v[208:211], a[120:123]
    v_exp_f32 v250, v131
    v_mfma_f32_16x16x32_bf16 a[124:127], a[236:239], v[208:211], a[124:127]
    s_waitcnt lgkmcnt(6)
    ds_read_b64_tr_b16 a[232:233], v241 offset:1024
    ds_read_b64_tr_b16 a[234:235], v241 offset:7168
    v_mfma_f32_16x16x32_bf16 a[128:131], a[240:243], v[208:211], a[128:131]
    s_waitcnt lgkmcnt(6)
    ds_read_b64_tr_b16 a[236:237], v242 offset:1024
    ds_read_b64_tr_b16 a[238:239], v242 offset:7168
    v_mfma_f32_16x16x32_bf16 a[132:135], a[244:247], v[208:211], a[132:135]
    v_cvt_pk_bf16_f32 v192, v253, v248
    v_add_f32 v254, v254, v249
    v_mfma_f32_16x16x32_bf16 a[176:179], a[240:243], v[204:207], a[176:179]
    v_add_f32 v254, v254, v250
    v_cvt_pk_bf16_f32 v193, v249, v250
    v_mfma_f32_16x16x32_bf16 a[180:183], a[244:247], v[204:207], a[180:183]
    v_exp_f32 v251, v136
    v_mfma_f32_16x16x32_bf16 v[104:107], a[240:243], v[200:203], v[104:107]
    v_exp_f32 v252, v137
    v_mfma_f32_16x16x32_bf16 v[108:111], a[244:247], v[200:203], v[108:111]
    v_add_f32 v246, v251, v252
    v_cvt_pk_bf16_f32 v196, v251, v252
    v_mfma_f32_16x16x32_bf16 v[56:59], a[240:243], v[188:191], v[56:59]
    v_exp_f32 v253, v138
    v_mfma_f32_16x16x32_bf16 v[60:63], a[244:247], v[188:191], v[60:63]
    v_exp_f32 v248, v139
    v_mfma_f32_16x16x32_bf16 v[8:11], a[240:243], v[184:187], v[8:11]
    v_add_f32 v246, v246, v253
    v_add_f32 v246, v246, v248
    v_mfma_f32_16x16x32_bf16 v[12:15], a[244:247], v[184:187], v[12:15]
    s_waitcnt lgkmcnt(6)
    ds_read_b64_tr_b16 a[240:241], v239 offset:2048
    ds_read_b64_tr_b16 a[242:243], v239 offset:8192
    v_mfma_f32_16x16x32_bf16 v[16:19], a[248:251], v[184:187], v[16:19]
    s_waitcnt lgkmcnt(6)
    ds_read_b64_tr_b16 a[244:245], v240 offset:2048
    ds_read_b64_tr_b16 a[246:247], v240 offset:8192
    v_mfma_f32_16x16x32_bf16 v[20:23], a[252:255], v[184:187], v[20:23]
    v_exp_f32 v249, v132
    v_mfma_f32_16x16x32_bf16 v[64:67], a[248:251], v[188:191], v[64:67]
    v_exp_f32 v250, v133
    v_mfma_f32_16x16x32_bf16 v[68:71], a[252:255], v[188:191], v[68:71]
    v_cvt_pk_bf16_f32 v197, v253, v248
    v_add_f32 v254, v254, v249
    v_mfma_f32_16x16x32_bf16 v[112:115], a[248:251], v[200:203], v[112:115]
    v_add_f32 v254, v254, v250
    v_cvt_pk_bf16_f32 v194, v249, v250
    v_mfma_f32_16x16x32_bf16 v[116:119], a[252:255], v[200:203], v[116:119]
    s_add_u32 m0, s36, 0
    v_exp_f32 v251, v134
    v_mfma_f32_16x16x32_bf16 a[184:187], a[248:251], v[204:207], a[184:187]
    buffer_load_dwordx4 v243, s[16:19], s35 offen nt lds
    v_mfma_f32_16x16x32_bf16 a[188:191], a[252:255], v[204:207], a[188:191]
    s_add_u32 m0, s36, 0x380
    v_exp_f32 v252, v135
    v_mfma_f32_16x16x32_bf16 a[136:139], a[248:251], v[208:211], a[136:139]
    buffer_load_dwordx4 v243, s[16:19], s35 offen offset:128 nt lds
    v_mfma_f32_16x16x32_bf16 a[140:143], a[252:255], v[208:211], a[140:143]
    s_waitcnt lgkmcnt(6)
    ds_read_b64_tr_b16 a[248:249], v241 offset:2048
    ds_read_b64_tr_b16 a[250:251], v241 offset:8192
    v_mfma_f32_16x16x32_bf16 a[144:147], a[232:235], v[208:211], a[144:147]
    s_waitcnt lgkmcnt(6)
    ds_read_b64_tr_b16 a[252:253], v242 offset:2048
    ds_read_b64_tr_b16 a[254:255], v242 offset:8192
    v_mfma_f32_16x16x32_bf16 a[148:151], a[236:239], v[208:211], a[148:151]
    s_add_u32 m0, s36, 0x700
    v_add_f32 v254, v254, v251
    v_add_f32 v254, v254, v252
    v_mfma_f32_16x16x32_bf16 a[192:195], a[232:235], v[204:207], a[192:195]
    buffer_load_dwordx4 v243, s[16:19], s35 offen offset:256 nt lds
    v_mfma_f32_16x16x32_bf16 a[196:199], a[236:239], v[204:207], a[196:199]
    s_add_u32 m0, s36, 0x12000
    v_exp_f32 v253, v140
    v_mfma_f32_16x16x32_bf16 v[120:123], a[232:235], v[200:203], v[120:123]
    buffer_load_dwordx4 v244, s[20:23], s35 offen nt lds
    v_mfma_f32_16x16x32_bf16 v[124:127], a[236:239], v[200:203], v[124:127]
    s_add_u32 m0, s36, 0x12380
    v_exp_f32 v248, v141
    v_mfma_f32_16x16x32_bf16 v[72:75], a[232:235], v[188:191], v[72:75]
    buffer_load_dwordx4 v244, s[20:23], s35 offen offset:128 nt lds
    v_mfma_f32_16x16x32_bf16 v[76:79], a[236:239], v[188:191], v[76:79]
    v_cvt_pk_bf16_f32 v195, v251, v252
    v_add_f32 v246, v246, v253
    v_mfma_f32_16x16x32_bf16 v[24:27], a[232:235], v[184:187], v[24:27]
    s_add_u32 m0, s36, 0x12700
    v_add_f32 v246, v246, v248
    v_cvt_pk_bf16_f32 v198, v253, v248
    v_mfma_f32_16x16x32_bf16 v[28:31], a[236:239], v[184:187], v[28:31]
    s_waitcnt lgkmcnt(6)
    buffer_load_dwordx4 v244, s[20:23], s35 offen offset:256 nt lds
    v_mfma_f32_16x16x32_bf16 v[32:35], a[240:243], v[184:187], v[32:35]
    s_waitcnt lgkmcnt(4)
    v_exp_f32 v249, v142
    v_mfma_f32_16x16x32_bf16 v[36:39], a[244:247], v[184:187], v[36:39]
    s_add_u32 s36, s36, s38
    v_exp_f32 v250, v143
    v_mfma_f32_16x16x32_bf16 v[80:83], a[240:243], v[188:191], v[80:83]
    s_add_u32 s35, s35, 0x3000
    v_add_f32 v246, v246, v249
    v_add_f32 v246, v246, v250
    v_mfma_f32_16x16x32_bf16 v[84:87], a[244:247], v[188:191], v[84:87]
    s_waitcnt vmcnt(6) lgkmcnt(0)
    s_barrier
    ds_read_b128 a[232:235], v237
    v_mfma_f32_16x16x32_bf16 a[216:219], a[240:243], v[200:203], a[216:219]
    s_cmp_ge_u32 s34, 13
    ds_read_b128 a[236:239], v238
    v_cvt_pk_bf16_f32 v199, v249, v250
    v_mfma_f32_16x16x32_bf16 a[220:223], a[244:247], v[200:203], a[220:223]
    s_cselect_b32 s36, 0x28000, s36
    v_max_f32 v251, v254, v246
    v_cmp_lt_f32 vcc, s33, v251
    v_mfma_f32_16x16x32_bf16 a[200:203], a[240:243], v[204:207], a[200:203]
    s_add_u32 s34, s34, 1
    v_add_u32 v241, s37, v241
    v_add_u32 v242, s37, v242
    v_mfma_f32_16x16x32_bf16 a[204:207], a[244:247], v[204:207], a[204:207]
    v_mfma_f32_16x16x32_bf16 a[152:155], a[240:243], v[208:211], a[152:155]
    v_mfma_f32_16x16x32_bf16 a[156:159], a[244:247], v[208:211], a[156:159]
    ds_read_b128 a[240:243], v237 offset:1024
    ds_read_b128 a[244:247], v238 offset:1024
    v_mfma_f32_16x16x32_bf16 v[40:43], a[248:251], v[184:187], v[40:43]
    v_mfma_f32_16x16x32_bf16 v[44:47], a[252:255], v[184:187], v[44:47]
    v_mfma_f32_16x16x32_bf16 v[88:91], a[248:251], v[188:191], v[88:91]
    v_mfma_f32_16x16x32_bf16 v[92:95], a[252:255], v[188:191], v[92:95]
    v_mfma_f32_16x16x32_bf16 a[224:227], a[248:251], v[200:203], a[224:227]
    v_mfma_f32_16x16x32_bf16 a[228:231], a[252:255], v[200:203], a[228:231]
    v_mfma_f32_16x16x32_bf16 a[208:211], a[248:251], v[204:207], a[208:211]
    v_mfma_f32_16x16x32_bf16 a[212:215], a[252:255], v[204:207], a[212:215]
    s_cbranch_vccnz L_slow0A
L_ret0A:
    v_add_f32 v232, v232, v254
    v_add_f32 v233, v233, v246
    v_mfma_f32_16x16x32_bf16 a[160:163], a[248:251], v[208:211], a[160:163]
    s_cmp_eq_u32 s34, 15
    v_add_u32 v239, s37, v239
    v_add_u32 v240, s37, v240
    v_mfma_f32_16x16x32_bf16 a[164:167], a[252:255], v[208:211], a[164:167]
    s_waitcnt lgkmcnt(2)
    s_cbranch_scc1 L_tailB
L_B:
    v_mfma_f32_16x16x32_bf16 v[128:131], a[232:235], a[0:3], v[212:215]
    s_bitcmp1_b32 0x10410, s34
    ds_read_b128 a[248:251], v237 offset:2048
    ds_read_b128 a[252:255], v238 offset:2048
    v_mfma_f32_16x16x32_bf16 v[128:131], a[236:239], a[4:7], v[128:131]
    s_cselect_b32 s37, 0xffff1000, s39
    v_exp_f32 v250, v152
    v_mfma_f32_16x16x32_bf16 v[136:139], a[232:235], a[24:27], v[216:219]
    s_bitcmp1_b32 0x4104104, s34
    v_exp_f32 v251, v153
    v_mfma_f32_16x16x32_bf16 v[136:139], a[236:239], a[28:31], v[136:139]
    s_cselect_b32 s38, 0xffff1000, s39
    v_add_f32 v245, v250, v251
    v_cvt_pk_bf16_f32 v200, v250, v251
    v_mfma_f32_16x16x32_bf16 v[168:171], a[232:235], a[48:51], v[220:223]
    v_exp_f32 v252, v154
    v_mfma_f32_16x16x32_bf16 v[168:171], a[236:239], a[52:55], v[168:171]
    v_exp_f32 v253, v155
    v_mfma_f32_16x16x32_bf16 v[176:179], a[232:235], a[72:75], v[224:227]
    v_add_f32 v245, v245, v252
    v_add_f32 v245, v245, v253
    v_mfma_f32_16x16x32_bf16 v[176:179], a[236:239], a[76:79], v[176:179]
    v_exp_f32 v248, v156
    v_mfma_f32_16x16x32_bf16 v[144:147], a[232:235], a[96:99], v[228:231]
    v_exp_f32 v249, v157
    v_mfma_f32_16x16x32_bf16 v[144:147], a[236:239], a[100:103], v[144:147]
    s_waitcnt lgkmcnt(3)
    ds_read_b128 a[232:235], v237 offset:6144
    ds_read_b128 a[236:239], v238 offset:6144
    v_mfma_f32_16x16x32_bf16 v[144:147], a[240:243], a[104:107], v[144:147]
    s_waitcnt lgkmcnt(4)
    v_cvt_pk_bf16_f32 v201, v252, v253
    v_add_f32 v245, v245, v248
    v_mfma_f32_16x16x32_bf16 v[144:147], a[244:247], a[108:111], v[144:147]
    v_add_f32 v245, v245, v249
    v_cvt_pk_bf16_f32 v202, v248, v249
    v_mfma_f32_16x16x32_bf16 v[176:179], a[240:243], a[80:83], v[176:179]
    v_exp_f32 v250, v158
    v_mfma_f32_16x16x32_bf16 v[176:179], a[244:247], a[84:87], v[176:179]
    v_exp_f32 v251, v159
    v_mfma_f32_16x16x32_bf16 v[168:171], a[240:243], a[56:59], v[168:171]
    v_add_f32 v245, v245, v250
    v_add_f32 v245, v245, v251
    v_mfma_f32_16x16x32_bf16 v[168:171], a[244:247], a[60:63], v[168:171]
    v_exp_f32 v252, v160
    v_mfma_f32_16x16x32_bf16 v[136:139], a[240:243], a[32:35], v[136:139]
    v_exp_f32 v253, v161
    v_mfma_f32_16x16x32_bf16 v[136:139], a[244:247], a[36:39], v[136:139]
    v_cvt_pk_bf16_f32 v203, v250, v251
    v_add_f32 v246, v252, v253
    v_mfma_f32_16x16x32_bf16 v[128:131], a[240:243], a[8:11], v[128:131]
    v_exp_f32 v248, v162
    v_mfma_f32_16x16x32_bf16 v[128:131], a[244:247], a[12:15], v[128:131]
    s_waitcnt lgkmcnt(3)
    ds_read_b128 a[240:243], v237 offset:7168
    ds_read_b128 a[244:247], v238 offset:7168
    v_mfma_f32_16x16x32_bf16 v[128:131], a[248:251], a[16:19], v[128:131]
    s_waitcnt lgkmcnt(4)
    v_exp_f32 v249, v163
    v_mfma_f32_16x16x32_bf16 v[128:131], a[252:255], a[20:23], v[128:131]
    v_cvt_pk_bf16_f32 v204, v252, v253
    v_add_f32 v246, v246, v248
    v_mfma_f32_16x16x32_bf16 v[136:139], a[248:251], a[40:43], v[136:139]
    v_add_f32 v246, v246, v249
    v_cvt_pk_bf16_f32 v205, v248, v249
    v_mfma_f32_16x16x32_bf16 v[136:139], a[252:255], a[44:47], v[136:139]
    v_exp_f32 v250, v164
    v_mfma_f32_16x16x32_bf16 v[168:171], a[248:251], a[64:67], v[168:171]
    v_exp_f32 v251, v165
    v_mfma_f32_16x16x32_bf16 v[168:171], a[252:255], a[68:71], v[168:171]
    v_add_f32 v246, v246, v250
    v_add_f32 v246, v246, v251
    v_mfma_f32_16x16x32_bf16 v[176:179], a[248:251], a[88:91], v[176:179]
    v_exp_f32 v252, v166
    v_mfma_f32_16x16x32_bf16 v[176:179], a[252:255], a[92:95], v[176:179]
    v_exp_f32 v253, v167
    v_mfma_f32_16x16x32_bf16 v[144:147], a[248:251], a[112:115], v[144:147]
    v_cvt_pk_bf16_f32 v206, v250, v251
    v_add_f32 v246, v246, v252
    v_mfma_f32_16x16x32_bf16 v[144:147], a[252:255], a[116:119], v[144:147]
    s_waitcnt lgkmcnt(3)
    ds_read_b128 a[248:251], v237 offset:8192
    ds_read_b128 a[252:255], v238 offset:8192
    v_mfma_f32_16x16x32_bf16 v[132:135], a[232:235], a[0:3], v[212:215]
    s_waitcnt lgkmcnt(4)
    v_add_f32 v246, v246, v253
    v_cvt_pk_bf16_f32 v207, v252, v253
    v_mfma_f32_16x16x32_bf16 v[132:135], a[236:239], a[4:7], v[132:135]
    v_max_f32 v248, v245, v246
    v_cmp_lt_f32 vcc, s33, v248
    v_mfma_f32_16x16x32_bf16 v[140:143], a[232:235], a[24:27], v[216:219]
    v_exp_f32 v253, v128
    v_mfma_f32_16x16x32_bf16 v[140:143], a[236:239], a[28:31], v[140:143]
    v_exp_f32 v249, v144
    v_mfma_f32_16x16x32_bf16 v[172:175], a[232:235], a[48:51], v[220:223]
    v_exp_f32 v250, v145
    v_mfma_f32_16x16x32_bf16 v[172:175], a[236:239], a[52:55], v[172:175]
    v_add_f32 v247, v249, v250
    v_cvt_pk_bf16_f32 v208, v249, v250
    v_mfma_f32_16x16x32_bf16 v[180:183], a[232:235], a[72:75], v[224:227]
    v_exp_f32 v251, v146
    v_mfma_f32_16x16x32_bf16 v[180:183], a[236:239], a[76:79], v[180:183]
    v_exp_f32 v252, v147
    v_mfma_f32_16x16x32_bf16 v[148:151], a[232:235], a[96:99], v[228:231]
    v_add_f32 v247, v247, v251
    v_add_f32 v247, v247, v252
    v_mfma_f32_16x16x32_bf16 v[148:151], a[236:239], a[100:103], v[148:151]
    s_waitcnt lgkmcnt(3)
    ds_read_b64_tr_b16 a[232:233], v239
    ds_read_b64_tr_b16 a[234:235], v239 offset:6144
    v_mfma_f32_16x16x32_bf16 v[148:151], a[240:243], a[104:107], v[148:151]
    s_waitcnt lgkmcnt(4)
    ds_read_b64_tr_b16 a[236:237], v240
    ds_read_b64_tr_b16 a[238:239], v240 offset:6144
    v_mfma_f32_16x16x32_bf16 v[148:151], a[244:247], a[108:111], v[148:151]
    v_exp_f32 v248, v129
    v_mfma_f32_16x16x32_bf16 v[180:183], a[240:243], a[80:83], v[180:183]
    v_cvt_pk_bf16_f32 v209, v251, v252
    v_add_f32 v254, v253, v248
    v_mfma_f32_16x16x32_bf16 v[180:183], a[244:247], a[84:87], v[180:183]
    v_exp_f32 v249, v130
    v_mfma_f32_16x16x32_bf16 v[172:175], a[240:243], a[56:59], v[172:175]
    v_exp_f32 v250, v131
    v_mfma_f32_16x16x32_bf16 v[172:175], a[244:247], a[60:63], v[172:175]
    v_cvt_pk_bf16_f32 v184, v253, v248
    v_add_f32 v254, v254, v249
    v_mfma_f32_16x16x32_bf16 v[140:143], a[240:243], a[32:35], v[140:143]
    v_add_f32 v254, v254, v250
    v_cvt_pk_bf16_f32 v185, v249, v250
    v_mfma_f32_16x16x32_bf16 v[140:143], a[244:247], a[36:39], v[140:143]
    v_mfma_f32_16x16x32_bf16 v[132:135], a[240:243], a[8:11], v[132:135]
    v_mfma_f32_16x16x32_bf16 v[132:135], a[244:247], a[12:15], v[132:135]
    s_waitcnt lgkmcnt(5)
    ds_read_b64_tr_b16 a[240:241], v241
    ds_read_b64_tr_b16 a[242:243], v241 offset:6144
    v_mfma_f32_16x16x32_bf16 v[132:135], a[248:251], a[16:19], v[132:135]
    s_waitcnt lgkmcnt(6)
    ds_read_b64_tr_b16 a[244:245], v242
    ds_read_b64_tr_b16 a[246:247], v242 offset:6144
    v_mfma_f32_16x16x32_bf16 v[132:135], a[252:255], a[20:23], v[132:135]
    v_mfma_f32_16x16x32_bf16 v[140:143], a[248:251], a[40:43], v[140:143]
    v_mfma_f32_16x16x32_bf16 v[140:143], a[252:255], a[44:47], v[140:143]
    v_mfma_f32_16x16x32_bf16 v[172:175], a[248:251], a[64:67], v[172:175]
    v_mfma_f32_16x16x32_bf16 v[172:175], a[252:255], a[68:71], v[172:175]
    v_mfma_f32_16x16x32_bf16 v[180:183], a[248:251], a[88:91], v[180:183]
    v_mfma_f32_16x16x32_bf16 v[180:183], a[252:255], a[92:95], v[180:183]
    v_mfma_f32_16x16x32_bf16 v[148:151], a[248:251], a[112:115], v[148:151]
    v_mfma_f32_16x16x32_bf16 v[148:151], a[252:255], a[116:119], v[148:151]
    s_waitcnt lgkmcnt(6)
    ds_read_b64_tr_b16 a[248:249], v239 offset:1024
    ds_read_b64_tr_b16 a[250:251], v239 offset:7168
    v_mfma_f32_16x16x32_bf16 v[0:3], a[232:235], v[192:195], v[0:3]
    s_waitcnt lgkmcnt(6)
    ds_read_b64_tr_b16 a[252:253], v240 offset:1024
    ds_read_b64_tr_b16 a[254:255], v240 offset:7168
    v_mfma_f32_16x16x32_bf16 v[4:7], a[236:239], v[192:195], v[4:7]
    v_mfma_f32_16x16x32_bf16 v[48:51], a[232:235], v[196:199], v[48:51]
    s_cbranch_vccnz L_slow1B
L_ret1B:
    v_add_f32 v234, v234, v245
    v_add_f32 v235, v235, v246
    v_mfma_f32_16x16x32_bf16 v[52:55], a[236:239], v[196:199], v[52:55]
    v_add_u32 v237, s37, v237
    v_add_u32 v238, s37, v238
    v_mfma_f32_16x16x32_bf16 v[96:99], a[232:235], v[200:203], v[96:99]
    v_exp_f32 v249, v136
    v_mfma_f32_16x16x32_bf16 v[100:103], a[236:239], v[200:203], v[100:103]
    v_exp_f32 v250, v137
    v_mfma_f32_16x16x32_bf16 a[168:171], a[232:235], v[204:207], a[168:171]
    v_add_f32 v246, v249, v250
    v_cvt_pk_bf16_f32 v188, v249, v250
    v_mfma_f32_16x16x32_bf16 a[172:175], a[236:239], v[204:207], a[172:175]
    s_waitcnt lgkmcnt(6)
    ds_read_b64_tr_b16 a[232:233], v241 offset:1024
    ds_read_b64_tr_b16 a[234:235], v241 offset:7168
    v_mfma_f32_16x16x32_bf16 a[176:179], a[240:243], v[204:207], a[176:179]
    s_waitcnt lgkmcnt(6)
    ds_read_b64_tr_b16 a[236:237], v242 offset:1024
    ds_read_b64_tr_b16 a[238:239], v242 offset:7168
    v_mfma_f32_16x16x32_bf16 a[180:183], a[244:247], v[204:207], a[180:183]
    v_exp_f32 v251, v138
    v_mfma_f32_16x16x32_bf16 v[104:107], a[240:243], v[200:203], v[104:107]
    v_exp_f32 v252, v139
    v_mfma_f32_16x16x32_bf16 v[108:111], a[244:247], v[200:203], v[108:111]
    v_add_f32 v246, v246, v251
    v_add_f32 v246, v246, v252
    v_mfma_f32_16x16x32_bf16 v[56:59], a[240:243], v[196:199], v[56:59]
    v_exp_f32 v253, v132
    v_mfma_f32_16x16x32_bf16 v[60:63], a[244:247], v[196:199], v[60:63]
    s_add_u32 m0, s36, 0
    v_exp_f32 v248, v133
    v_mfma_f32_16x16x32_bf16 v[8:11], a[240:243], v[192:195], v[8:11]
    buffer_load_dwordx4 v243, s[16:19], s35 offen nt lds
    v_mfma_f32_16x16x32_bf16 v[12:15], a[244:247], v[192:195], v[12:15]
    s_waitcnt lgkmcnt(6)
    ds_read_b64_tr_b16 a[240:241], v239 offset:2048
    ds_read_b64_tr_b16 a[242:243], v239 offset:8192
    v_mfma_f32_16x16x32_bf16 v[16:19], a[248:251], v[192:195], v[16:19]
    s_waitcnt lgkmcnt(6)
    ds_read_b64_tr_b16 a[244:245], v240 offset:2048
    ds_read_b64_tr_b16 a[246:247], v240 offset:8192
    v_mfma_f32_16x16x32_bf16 v[20:23], a[252:255], v[192:195], v[20:23]
    s_add_u32 m0, s36, 0x380
    v_cvt_pk_bf16_f32 v189, v251, v252
    v_add_f32 v254, v254, v253
    v_mfma_f32_16x16x32_bf16 v[64:67], a[248:251], v[196:199], v[64:67]
    buffer_load_dwordx4 v243, s[16:19], s35 offen offset:128 nt lds
    v_mfma_f32_16x16x32_bf16 v[68:71], a[252:255], v[196:199], v[68:71]
    s_add_u32 m0, s36, 0x700
    v_add_f32 v254, v254, v248
    v_cvt_pk_bf16_f32 v186, v253, v248
    v_mfma_f32_16x16x32_bf16 v[112:115], a[248:251], v[200:203], v[112:115]
    buffer_load_dwordx4 v243, s[16:19], s35 offen offset:256 nt lds
    v_mfma_f32_16x16x32_bf16 v[116:119], a[252:255], v[200:203], v[116:119]
    s_add_u32 m0, s36, 0x12000
    v_exp_f32 v249, v134
    v_mfma_f32_16x16x32_bf16 a[184:187], a[248:251], v[204:207], a[184:187]
    buffer_load_dwordx4 v244, s[20:23], s35 offen nt lds
    v_mfma_f32_16x16x32_bf16 a[188:191], a[252:255], v[204:207], a[188:191]
    s_waitcnt lgkmcnt(6)
    ds_read_b64_tr_b16 a[248:249], v241 offset:2048
    ds_read_b64_tr_b16 a[250:251], v241 offset:8192
    v_mfma_f32_16x16x32_bf16 a[192:195], a[232:235], v[204:207], a[192:195]
    s_waitcnt lgkmcnt(6)
    ds_read_b64_tr_b16 a[252:253], v242 offset:2048
    ds_read_b64_tr_b16 a[254:255], v242 offset:8192
    v_mfma_f32_16x16x32_bf16 a[196:199], a[236:239], v[204:207], a[196:199]
    s_add_u32 m0, s36, 0x12380
    v_exp_f32 v250, v135
    v_mfma_f32_16x16x32_bf16 v[120:123], a[232:235], v[200:203], v[120:123]
    buffer_load_dwordx4 v244, s[20:23], s35 offen offset:128 nt lds
    v_mfma_f32_16x16x32_bf16 v[124:127], a[236:239], v[200:203], v[124:127]
    s_add_u32 m0, s36, 0x12700
    v_add_f32 v254, v254, v249
    v_add_f32 v254, v254, v250
    v_mfma_f32_16x16x32_bf16 v[72:75], a[232:235], v[196:199], v[72:75]
    buffer_load_dwordx4 v244, s[20:23], s35 offen offset:256 nt lds
    v_mfma_f32_16x16x32_bf16 v[76:79], a[236:239], v[196:199], v[76:79]
    s_add_u32 s36, s36, s38
    v_exp_f32 v251, v140
    v_mfma_f32_16x16x32_bf16 v[24:27], a[232:235], v[192:195], v[24:27]
    s_add_u32 s35, s35, 0x3000
    v_exp_f32 v252, v141
    v_mfma_f32_16x16x32_bf16 v[28:31], a[236:239], v[192:195], v[28:31]
    s_waitcnt vmcnt(6) lgkmcnt(0)
    s_barrier
    ds_read_b128 a[232:235], v237
    v_mfma_f32_16x16x32_bf16 v[32:35], a[240:243], v[192:195], v[32:35]
    s_cmp_ge_u32 s34, 13
    ds_read_b128 a[236:239], v238
    v_cvt_pk_bf16_f32 v187, v249, v250
    v_mfma_f32_16x16x32_bf16 v[36:39], a[244:247], v[192:195], v[36:39]
    s_cselect_b32 s36, 0x28000, s36
    v_add_f32 v246, v246, v251
    v_add_f32 v246, v246, v252
    v_mfma_f32_16x16x32_bf16 v[80:83], a[240:243], v[196:199], v[80:83]
    s_add_u32 s34, s34, 1
    v_exp_f32 v253, v142
    v_mfma_f32_16x16x32_bf16 v[84:87], a[244:247], v[196:199], v[84:87]
    v_exp_f32 v248, v143
    v_mfma_f32_16x16x32_bf16 a[216:219], a[240:243], v[200:203], a[216:219]
    v_cvt_pk_bf16_f32 v190, v251, v252
    v_add_f32 v246, v246, v253
    v_mfma_f32_16x16x32_bf16 a[220:223], a[244:247], v[200:203], a[220:223]
    v_add_f32 v246, v246, v248
    v_cvt_pk_bf16_f32 v191, v253, v248
    v_mfma_f32_16x16x32_bf16 a[200:203], a[240:243], v[204:207], a[200:203]
    v_max_f32 v249, v254, v246
    v_cmp_lt_f32 vcc, s33, v249
    v_mfma_f32_16x16x32_bf16 a[204:207], a[244:247], v[204:207], a[204:207]
    ds_read_b128 a[240:243], v237 offset:1024
    ds_read_b128 a[244:247], v238 offset:1024
    v_mfma_f32_16x16x32_bf16 v[40:43], a[248:251], v[192:195], v[40:43]
    v_add_u32 v241, s37, v241
    v_add_u32 v242, s37, v242
    v_mfma_f32_16x16x32_bf16 v[44:47], a[252:255], v[192:195], v[44:47]
    v_mfma_f32_16x16x32_bf16 v[88:91], a[248:251], v[196:199], v[88:91]
    v_mfma_f32_16x16x32_bf16 v[92:95], a[252:255], v[196:199], v[92:95]
    v_mfma_f32_16x16x32_bf16 a[224:227], a[248:251], v[200:203], a[224:227]
    v_mfma_f32_16x16x32_bf16 a[228:231], a[252:255], v[200:203], a[228:231]
    s_cbranch_vccnz L_slow0B
L_ret0B:
    v_add_f32 v232, v232, v254
    v_add_f32 v233, v233, v246
    v_mfma_f32_16x16x32_bf16 a[208:211], a[248:251], v[204:207], a[208:211]
    s_cmp_eq_u32 s34, 15
    v_add_u32 v239, s37, v239
    v_add_u32 v240, s37, v240
    v_mfma_f32_16x16x32_bf16 a[212:215], a[252:255], v[204:207], a[212:215]
    s_waitcnt lgkmcnt(2)
    s_cbranch_scc1 L_tailA
    s_branch L_A
L_enterB:
    v_mov_b32 v152, v168
    v_mov_b32 v153, v169
    v_mov_b32 v154, v170
    v_mov_b32 v155, v171
    v_mov_b32 v156, v172
    v_mov_b32 v157, v173
    v_mov_b32 v158, v174
    v_mov_b32 v159, v175
    v_mov_b32 v160, v176
    v_mov_b32 v161, v177
    v_mov_b32 v162, v178
    v_mov_b32 v163, v179
    v_mov_b32 v164, v180
    v_mov_b32 v165, v181
    v_mov_b32 v166, v182
    v_mov_b32 v167, v183
    v_mov_b32 v192, v184
    v_mov_b32 v193, v185
    v_mov_b32 v194, v186
    v_mov_b32 v195, v187
    v_mov_b32 v196, v188
    v_mov_b32 v197, v189
    v_mov_b32 v198, v190
    v_mov_b32 v199, v191
L_B0:
    v_mfma_f32_16x16x32_bf16 v[128:131], a[232:235], a[0:3], v[212:215]
    s_bitcmp1_b32 0x10410, s34
    ds_read_b128 a[248:251], v237 offset:2048
    ds_read_b128 a[252:255], v238 offset:2048
    v_exp_f32_e64 v248, v152
    v_mfma_f32_16x16x32_bf16 v[128:131], a[236:239], a[4:7], v[128:131]
    s_cselect_b32 s37, 0xffff1000, s39
    v_exp_f32 v249, v153
    v_exp_f32 v250, v154
    v_mfma_f32_16x16x32_bf16 v[136:139], a[232:235], a[24:27], v[216:219]
    s_bitcmp1_b32 0x4104104, s34
    v_add_f32 v245, v248, v249
    v_exp_f32 v251, v155
    v_cvt_pk_bf16_f32 v200, v248, v249
    v_mfma_f32_16x16x32_bf16 v[136:139], a[236:239], a[28:31], v[136:139]
    s_cselect_b32 s38, 0xffff1000, s39
    v_add_f32 v245, v245, v250
    v_add_f32 v245, v245, v251
    v_exp_f32_e64 v252, v156
    v_mfma_f32_16x16x32_bf16 v[168:171], a[232:235], a[48:51], v[220:223]
    v_exp_f32_e64 v253, v157
    v_cvt_pk_bf16_f32 v201, v250, v251
    v_add_f32_e64 v245, v245, v252
    v_mfma_f32_16x16x32_bf16 v[168:171], a[236:239], a[52:55], v[168:171]
    v_add_f32 v245, v245, v253
    v_exp_f32 v248, v158
    v_cvt_pk_bf16_f32 v202, v252, v253
    v_mfma_f32_16x16x32_bf16 v[176:179], a[232:235], a[72:75], v[224:227]
    v_exp_f32 v249, v159
    v_exp_f32 v250, v160
    v_mfma_f32_16x16x32_bf16 v[176:179], a[236:239], a[76:79], v[176:179]
    v_add_f32 v245, v245, v248
    v_add_f32 v245, v245, v249
    v_exp_f32_e64 v251, v161
    v_mfma_f32_16x16x32_bf16 v[144:147], a[232:235], a[96:99], v[228:231]
    v_cvt_pk_bf16_f32 v203, v248, v249
    v_add_f32 v246, v250, v251
    v_exp_f32 v252, v162
    v_mfma_f32_16x16x32_bf16 v[144:147], a[236:239], a[100:103], v[144:147]
    ds_read_b128 a[232:235], v237 offset:6144
    ds_read_b128 a[236:239], v238 offset:6144
    v_exp_f32 v253, v163
    s_waitcnt lgkmcnt(5)
    v_mfma_f32_16x16x32_bf16 v[144:147], a[240:243], a[104:107], v[144:147]
    v_cvt_pk_bf16_f32 v204, v250, v251
    v_add_f32 v246, v246, v252
    v_add_f32 v246, v246, v253
    v_cvt_pk_bf16_f32 v205, v252, v253
    s_waitcnt lgkmcnt(4)
    v_mfma_f32_16x16x32_bf16 v[144:147], a[244:247], a[108:111], v[144:147]
    v_exp_f32 v248, v164
    v_exp_f32_e64 v249, v165
    v_mfma_f32_16x16x32_bf16 v[176:179], a[240:243], a[80:83], v[176:179]
    v_add_f32 v246, v246, v248
    v_add_f32 v246, v246, v249
    v_exp_f32_e64 v250, v166
    v_mfma_f32_16x16x32_bf16 v[176:179], a[244:247], a[84:87], v[176:179]
    v_exp_f32_e64 v251, v167
    v_cvt_pk_bf16_f32 v206, v248, v249
    v_add_f32_e64 v246, v246, v250
    v_mfma_f32_16x16x32_bf16 v[168:171], a[240:243], a[56:59], v[168:171]
    v_add_f32_e64 v246, v246, v251
    v_cvt_pk_bf16_f32 v207, v250, v251
    v_max_f32 v252, v245, v246
    v_cmp_lt_f32 vcc, s33, v252
    v_mfma_f32_16x16x32_bf16 v[168:171], a[244:247], a[60:63], v[168:171]
    v_mfma_f32_16x16x32_bf16 v[136:139], a[240:243], a[32:35], v[136:139]
    v_mfma_f32_16x16x32_bf16 v[136:139], a[244:247], a[36:39], v[136:139]
    v_mfma_f32_16x16x32_bf16 v[128:131], a[240:243], a[8:11], v[128:131]
    v_mfma_f32_16x16x32_bf16 v[128:131], a[244:247], a[12:15], v[128:131]
    ds_read_b128 a[240:243], v237 offset:7168
    ds_read_b128 a[244:247], v238 offset:7168
    s_waitcnt lgkmcnt(5)
    v_mfma_f32_16x16x32_bf16 v[128:131], a[248:251], a[16:19], v[128:131]
    s_waitcnt lgkmcnt(4)
    v_mfma_f32_16x16x32_bf16 v[128:131], a[252:255], a[20:23], v[128:131]
    v_mfma_f32_16x16x32_bf16 v[136:139], a[248:251], a[40:43], v[136:139]
    v_mfma_f32_16x16x32_bf16 v[136:139], a[252:255], a[44:47], v[136:139]
    v_mfma_f32_16x16x32_bf16 v[168:171], a[248:251], a[64:67], v[168:171]
    v_mfma_f32_16x16x32_bf16 v[168:171], a[252:255], a[68:71], v[168:171]
    s_nop 3
    v_exp_f32 v251, v128
    v_exp_f32_e64 v252, v129
    v_mfma_f32_16x16x32_bf16 v[176:179], a[248:251], a[88:91], v[176:179]
    v_add_f32_e64 v254, v251, v252
    v_cvt_pk_bf16_f32 v184, v251, v252
    v_mfma_f32_16x16x32_bf16 v[176:179], a[252:255], a[92:95], v[176:179]
    v_mfma_f32_16x16x32_bf16 v[144:147], a[248:251], a[112:115], v[144:147]
    v_mfma_f32_16x16x32_bf16 v[144:147], a[252:255], a[116:119], v[144:147]
    ds_read_b128 a[248:251], v237 offset:8192
    ds_read_b128 a[252:255], v238 offset:8192
    s_waitcnt lgkmcnt(5)
    v_mfma_f32_16x16x32_bf16 v[132:135], a[232:235], a[0:3], v[212:215]
    s_waitcnt lgkmcnt(4)
    v_mfma_f32_16x16x32_bf16 v[132:135], a[236:239], a[4:7], v[132:135]
    v_mfma_f32_16x16x32_bf16 v[140:143], a[232:235], a[24:27], v[216:219]
    v_mfma_f32_16x16x32_bf16 v[140:143], a[236:239], a[28:31], v[140:143]
    v_exp_f32 v253, v144
    v_exp_f32 v248, v145
    v_mfma_f32_16x16x32_bf16 v[172:175], a[232:235], a[48:51], v[220:223]
    v_add_f32 v247, v253, v248
    v_exp_f32 v249, v146
    v_cvt_pk_bf16_f32 v208, v253, v248
    v_mfma_f32_16x16x32_bf16 v[172:175], a[236:239], a[52:55], v[172:175]
    v_exp_f32 v250, v147
    v_exp_f32 v253, v130
    v_mfma_f32_16x16x32_bf16 v[180:183], a[232:235], a[72:75], v[224:227]
    v_add_f32 v247, v247, v249
    v_add_f32 v247, v247, v250
    v_exp_f32_e64 v248, v131
    v_mfma_f32_16x16x32_bf16 v[180:183], a[236:239], a[76:79], v[180:183]
    v_cvt_pk_bf16_f32 v209, v249, v250
    v_add_f32 v254, v254, v253
    v_add_f32 v254, v254, v248
    v_cvt_pk_bf16_f32 v185, v253, v248
    v_mfma_f32_16x16x32_bf16 v[148:151], a[232:235], a[96:99], v[228:231]
    s_waitcnt vmcnt(6)
    s_barrier
    v_mfma_f32_16x16x32_bf16 v[148:151], a[236:239], a[100:103], v[148:151]
    ds_read_b64_tr_b16 a[232:233], v239
    ds_read_b64_tr_b16 a[234:235], v239 offset:6144
    ds_read_b64_tr_b16 a[236:237], v240
    ds_read_b64_tr_b16 a[238:239], v240 offset:6144
    s_waitcnt lgkmcnt(7)
    v_mfma_f32_16x16x32_bf16 v[148:151], a[240:243], a[104:107], v[148:151]
    s_waitcnt lgkmcnt(6)
    v_mfma_f32_16x16x32_bf16 v[148:151], a[244:247], a[108:111], v[148:151]
    v_mfma_f32_16x16x32_bf16 v[180:183], a[240:243], a[80:83], v[180:183]
    v_mfma_f32_16x16x32_bf16 v[180:183], a[244:247], a[84:87], v[180:183]
    v_mfma_f32_16x16x32_bf16 v[172:175], a[240:243], a[56:59], v[172:175]
    v_mfma_f32_16x16x32_bf16 v[172:175], a[244:247], a[60:63], v[172:175]
    v_mfma_f32_16x16x32_bf16 v[140:143], a[240:243], a[32:35], v[140:143]
    v_mfma_f32_16x16x32_bf16 v[140:143], a[244:247], a[36:39], v[140:143]
    v_mfma_f32_16x16x32_bf16 v[132:135], a[240:243], a[8:11], v[132:135]
    v_mfma_f32_16x16x32_bf16 v[132:135], a[244:247], a[12:15], v[132:135]
    ds_read_b64_tr_b16 a[240:241], v241
    ds_read_b64_tr_b16 a[242:243], v241 offset:6144
    ds_read_b64_tr_b16 a[244:245], v242
    ds_read_b64_tr_b16 a[246:247], v242 offset:6144
    s_waitcnt lgkmcnt(9)
    v_mfma_f32_16x16x32_bf16 v[132:135], a[248:251], a[16:19], v[132:135]
    s_waitcnt lgkmcnt(8)
    v_mfma_f32_16x16x32_bf16 v[132:135], a[252:255], a[20:23], v[132:135]
    v_mfma_f32_16x16x32_bf16 v[140:143], a[248:251], a[40:43], v[140:143]
    v_mfma_f32_16x16x32_bf16 v[140:143], a[252:255], a[44:47], v[140:143]
    v_mfma_f32_16x16x32_bf16 v[172:175], a[248:251], a[64:67], v[172:175]
    v_mfma_f32_16x16x32_bf16 v[172:175], a[252:255], a[68:71], v[172:175]
    v_mfma_f32_16x16x32_bf16 v[180:183], a[248:251], a[88:91], v[180:183]
    v_mfma_f32_16x16x32_bf16 v[180:183], a[252:255], a[92:95], v[180:183]
    v_mfma_f32_16x16x32_bf16 v[148:151], a[248:251], a[112:115], v[148:151]
    v_mfma_f32_16x16x32_bf16 v[148:151], a[252:255], a[116:119], v[148:151]
    ds_read_b64_tr_b16 a[248:249], v239 offset:1024
    ds_read_b64_tr_b16 a[250:251], v239 offset:7168
    ds_read_b64_tr_b16 a[252:253], v240 offset:1024
    ds_read_b64_tr_b16 a[254:255], v240 offset:7168
    s_waitcnt lgkmcnt(10)
    v_mfma_f32_16x16x32_bf16 v[0:3], a[232:235], v[192:195], 0
    s_waitcnt lgkmcnt(8)
    v_mfma_f32_16x16x32_bf16 v[4:7], a[236:239], v[192:195], 0
    v_mfma_f32_16x16x32_bf16 v[48:51], a[232:235], v[196:199], 0
    s_cbranch_vccnz L_slow1B0
L_ret1B0:
    v_add_f32 v234, v234, v245
    v_add_f32 v235, v235, v246
    v_add_u32 v237, s37, v237
    v_add_u32_e64 v238, s37, v238
    v_mfma_f32_16x16x32_bf16 v[52:55], a[236:239], v[196:199], 0
    v_exp_f32 v253, v136
    v_exp_f32 v248, v137
    v_mfma_f32_16x16x32_bf16 v[96:99], a[232:235], v[200:203], 0
    v_add_f32 v246, v253, v248
    v_exp_f32 v249, v138
    v_cvt_pk_bf16_f32 v188, v253, v248
    v_mfma_f32_16x16x32_bf16 v[100:103], a[236:239], v[200:203], 0
    v_exp_f32 v250, v139
    v_exp_f32 v251, v132
    v_mfma_f32_16x16x32_bf16 a[168:171], a[232:235], v[204:207], 0
    v_add_f32 v246, v246, v249
    v_add_f32 v246, v246, v250
    v_exp_f32_e64 v252, v133
    v_mfma_f32_16x16x32_bf16 a[172:175], a[236:239], v[204:207], 0
    ds_read_b64_tr_b16 a[232:233], v241 offset:1024
    ds_read_b64_tr_b16 a[234:235], v241 offset:7168
    ds_read_b64_tr_b16 a[236:237], v242 offset:1024
    ds_read_b64_tr_b16 a[238:239], v242 offset:7168
    s_waitcnt lgkmcnt(10)
    v_mfma_f32_16x16x32_bf16 a[176:179], a[240:243], v[204:207], 0
    v_cvt_pk_bf16_f32 v189, v249, v250
    v_add_f32 v254, v254, v251
    v_add_f32_e64 v254, v254, v252
    v_cvt_pk_bf16_f32 v186, v251, v252
    s_waitcnt lgkmcnt(8)
    v_mfma_f32_16x16x32_bf16 a[180:183], a[244:247], v[204:207], 0
    v_exp_f32 v253, v134
    v_exp_f32_e64 v248, v135
    v_mfma_f32_16x16x32_bf16 v[104:107], a[240:243], v[200:203], 0
    v_add_f32 v254, v254, v253
    v_add_f32 v254, v254, v248
    v_exp_f32_e64 v249, v140
    v_mfma_f32_16x16x32_bf16 v[108:111], a[244:247], v[200:203], 0
    v_exp_f32_e64 v250, v141
    v_cvt_pk_bf16_f32 v187, v253, v248
    v_add_f32_e64 v246, v246, v249
    v_mfma_f32_16x16x32_bf16 v[56:59], a[240:243], v[196:199], 0
    v_add_f32 v246, v246, v250
    v_exp_f32 v251, v142
    v_cvt_pk_bf16_f32 v190, v249, v250
    v_mfma_f32_16x16x32_bf16 v[60:63], a[244:247], v[196:199], 0
    s_add_u32 m0, s36, 0
    v_exp_f32 v252, v143
    v_add_f32_e64 v246, v246, v251
    v_mfma_f32_16x16x32_bf16 v[8:11], a[240:243], v[192:195], 0
    buffer_load_dwordx4 v243, s[16:19], s35 offen nt lds
    v_add_f32_e64 v246, v246, v252
    v_cvt_pk_bf16_f32 v191, v251, v252
    v_mfma_f32_16x16x32_bf16 v[12:15], a[244:247], v[192:195], 0
    ds_read_b64_tr_b16 a[240:241], v239 offset:2048
    ds_read_b64_tr_b16 a[242:243], v239 offset:8192
    ds_read_b64_tr_b16 a[244:245], v240 offset:2048
    ds_read_b64_tr_b16 a[246:247], v240 offset:8192
    s_waitcnt lgkmcnt(10)
    v_mfma_f32_16x16x32_bf16 v[16:19], a[248:251], v[192:195], 0
    v_max_f32 v253, v254, v246
    v_cmp_lt_f32 vcc, s33, v253
    s_waitcnt lgkmcnt(8)
    v_mfma_f32_16x16x32_bf16 v[20:23], a[252:255], v[192:195], 0
    s_add_u32 m0, s36, 0x380
    v_mfma_f32_16x16x32_bf16 v[64:67], a[248:251], v[196:199], 0
    buffer_load_dwordx4 v243, s[16:19], s35 offen offset:128 nt lds
    v_mfma_f32_16x16x32_bf16 v[68:71], a[252:255], v[196:199], 0
    s_add_u32 m0, s36, 0x700
    v_mfma_f32_16x16x32_bf16 v[112:115], a[248:251], v[200:203], 0
    buffer_load_dwordx4 v243, s[16:19], s35 offen offset:256 nt lds
    v_mfma_f32_16x16x32_bf16 v[116:119], a[252:255], v[200:203], 0
    s_add_u32 m0, s36, 0x12000
    v_mfma_f32_16x16x32_bf16 a[184:187], a[248:251], v[204:207], 0
    buffer_load_dwordx4 v244, s[20:23], s35 offen nt lds
    v_mfma_f32_16x16x32_bf16 a[188:191], a[252:255], v[204:207], 0
    ds_read_b64_tr_b16 a[248:249], v241 offset:2048
    ds_read_b64_tr_b16 a[250:251], v241 offset:8192
    ds_read_b64_tr_b16 a[252:253], v242 offset:2048
    ds_read_b64_tr_b16 a[254:255], v242 offset:8192
    s_waitcnt lgkmcnt(10)
    v_mfma_f32_16x16x32_bf16 a[192:195], a[232:235], v[204:207], 0
    v_add_u32 v241, s37, v241
    v_add_u32 v242, s37, v242
    s_waitcnt lgkmcnt(8)
    v_mfma_f32_16x16x32_bf16 a[196:199], a[236:239], v[204:207], 0
    s_add_u32 m0, s36, 0x12380
    v_mfma_f32_16x16x32_bf16 v[120:123], a[232:235], v[200:203], 0
    buffer_load_dwordx4 v244, s[20:23], s35 offen offset:128 nt lds
    v_mfma_f32_16x16x32_bf16 v[124:127], a[236:239], v[200:203], 0
    s_add_u32 m0, s36, 0x12700
    v_mfma_f32_16x16x32_bf16 v[72:75], a[232:235], v[196:199], 0
    buffer_load_dwordx4 v244, s[20:23], s35 offen offset:256 nt lds
    v_mfma_f32_16x16x32_bf16 v[76:79], a[236:239], v[196:199], 0
    s_add_u32 s36, s36, s38
    v_mfma_f32_16x16x32_bf16 v[24:27], a[232:235], v[192:195], 0
    s_add_u32 s35, s35, 0x3000
    v_mfma_f32_16x16x32_bf16 v[28:31], a[236:239], v[192:195], 0
    s_waitcnt vmcnt(6) lgkmcnt(0)
    s_barrier
    ds_read_b128 a[232:235], v237
    ds_read_b128 a[236:239], v238
    v_mfma_f32_16x16x32_bf16 v[32:35], a[240:243], v[192:195], 0
    s_cmp_ge_u32 s34, 13
    v_mfma_f32_16x16x32_bf16 v[36:39], a[244:247], v[192:195], 0
    s_cselect_b32 s36, 0x28000, s36
    v_mfma_f32_16x16x32_bf16 v[80:83], a[240:243], v[196:199], 0
    s_add_u32 s34, s34, 1
    v_mfma_f32_16x16x32_bf16 v[84:87], a[244:247], v[196:199], 0
    v_mfma_f32_16x16x32_bf16 a[216:219], a[240:243], v[200:203], 0
    v_mfma_f32_16x16x32_bf16 a[220:223], a[244:247], v[200:203], 0
    v_mfma_f32_16x16x32_bf16 a[200:203], a[240:243], v[204:207], 0
    v_mfma_f32_16x16x32_bf16 a[204:207], a[244:247], v[204:207], 0
    ds_read_b128 a[240:243], v237 offset:1024
    ds_read_b128 a[244:247], v238 offset:1024
    v_mfma_f32_16x16x32_bf16 v[40:43], a[248:251], v[192:195], 0
    v_mfma_f32_16x16x32_bf16 v[44:47], a[252:255], v[192:195], 0
    v_mfma_f32_16x16x32_bf16 v[88:91], a[248:251], v[196:199], 0
    v_mfma_f32_16x16x32_bf16 v[92:95], a[252:255], v[196:199], 0
    v_mfma_f32_16x16x32_bf16 a[224:227], a[248:251], v[200:203], 0
    v_mfma_f32_16x16x32_bf16 a[228:231], a[252:255], v[200:203], 0
    s_cbranch_vccnz L_slow0B0
L_ret0B0:
    v_add_f32 v232, v232, v254
    v_add_f32 v233, v233, v246
    v_mfma_f32_16x16x32_bf16 a[208:211], a[248:251], v[204:207], 0
    v_add_u32 v239, s37, v239
    v_add_u32 v240, s37, v240
    v_mfma_f32_16x16x32_bf16 a[212:215], a[252:255], v[204:207], 0
    s_waitcnt lgkmcnt(2)
L_A1:
    v_mfma_f32_16x16x32_bf16 v[128:131], a[232:235], a[0:3], v[212:215]
    s_bitcmp1_b32 0x10410, s34
    ds_read_b128 a[248:251], v237 offset:2048
    ds_read_b128 a[252:255], v238 offset:2048
    v_exp_f32 v252, v168
    v_mfma_f32_16x16x32_bf16 v[128:131], a[236:239], a[4:7], v[128:131]
    s_cselect_b32 s37, 0xffff1000, s39
    v_exp_f32 v253, v169
    v_exp_f32 v248, v170
    v_mfma_f32_16x16x32_bf16 v[136:139], a[232:235], a[24:27], v[216:219]
    s_bitcmp1_b32 0x4104104, s34
    v_add_f32 v245, v252, v253
    v_exp_f32 v249, v171
    v_cvt_pk_bf16_f32 v200, v252, v253
    v_mfma_f32_16x16x32_bf16 v[136:139], a[236:239], a[28:31], v[136:139]
    s_cselect_b32 s38, 0xffff1000, s39
    v_add_f32 v245, v245, v248
    v_add_f32 v245, v245, v249
    v_exp_f32_e64 v250, v172
    v_mfma_f32_16x16x32_bf16 v[152:155], a[232:235], a[48:51], v[220:223]
    v_exp_f32_e64 v251, v173
    v_cvt_pk_bf16_f32 v201, v248, v249
    v_add_f32_e64 v245, v245, v250
    v_mfma_f32_16x16x32_bf16 v[152:155], a[236:239], a[52:55], v[152:155]
    v_add_f32 v245, v245, v251
    v_exp_f32 v252, v174
    v_cvt_pk_bf16_f32 v202, v250, v251
    v_mfma_f32_16x16x32_bf16 v[160:163], a[232:235], a[72:75], v[224:227]
    v_exp_f32 v253, v175
    v_exp_f32 v248, v176
    v_mfma_f32_16x16x32_bf16 v[160:163], a[236:239], a[76:79], v[160:163]
    ds_read_b128 a[232:235], v237 offset:6144
    ds_read_b128 a[236:239], v238 offset:6144
    v_add_f32 v245, v245, v252
    v_add_f32 v245, v245, v253
    s_waitcnt lgkmcnt(5)
    v_mfma_f32_16x16x32_bf16 v[160:163], a[240:243], a[80:83], v[160:163]
    v_exp_f32 v249, v177
    v_exp_f32 v250, v178
    s_waitcnt lgkmcnt(4)
    v_mfma_f32_16x16x32_bf16 v[160:163], a[244:247], a[84:87], v[160:163]
    v_cvt_pk_bf16_f32 v203, v252, v253
    v_add_f32 v246, v248, v249
    v_exp_f32 v251, v179
    v_mfma_f32_16x16x32_bf16 v[152:155], a[240:243], a[56:59], v[152:155]
    v_cvt_pk_bf16_f32 v204, v248, v249
    v_add_f32 v246, v246, v250
    v_add_f32 v246, v246, v251
    v_cvt_pk_bf16_f32 v205, v250, v251
    v_mfma_f32_16x16x32_bf16 v[152:155], a[244:247], a[60:63], v[152:155]
    v_exp_f32 v252, v180
    v_exp_f32 v253, v181
    v_mfma_f32_16x16x32_bf16 v[136:139], a[240:243], a[32:35], v[136:139]
    v_add_f32 v246, v246, v252
    v_add_f32 v246, v246, v253
    v_exp_f32_e64 v248, v182
    v_mfma_f32_16x16x32_bf16 v[136:139], a[244:247], a[36:39], v[136:139]
    v_exp_f32_e64 v249, v183
    v_cvt_pk_bf16_f32 v206, v252, v253
    v_add_f32_e64 v246, v246, v248
    v_mfma_f32_16x16x32_bf16 v[128:131], a[240:243], a[8:11], v[128:131]
    v_add_f32 v246, v246, v249
    v_exp_f32 v250, v148
    v_cvt_pk_bf16_f32 v207, v248, v249
    v_mfma_f32_16x16x32_bf16 v[128:131], a[244:247], a[12:15], v[128:131]
    ds_read_b128 a[240:243], v237 offset:7168
    ds_read_b128 a[244:247], v238 offset:7168
    v_exp_f32 v251, v149
    s_waitcnt lgkmcnt(5)
    v_mfma_f32_16x16x32_bf16 v[128:131], a[248:251], a[16:19], v[128:131]
    v_add_f32 v247, v247, v250
    v_add_f32 v247, v247, v251
    v_exp_f32 v252, v150
    s_waitcnt lgkmcnt(4)
    v_mfma_f32_16x16x32_bf16 v[128:131], a[252:255], a[20:23], v[128:131]
    v_exp_f32_e64 v253, v151
    v_cvt_pk_bf16_f32 v210, v250, v251
    v_add_f32_e64 v247, v247, v252
    v_mfma_f32_16x16x32_bf16 v[136:139], a[248:251], a[40:43], v[136:139]
    v_add_f32_e64 v247, v247, v253
    v_cvt_pk_bf16_f32 v211, v252, v253
    v_max3_f32 v248, v245, v246, v247
    v_cmp_lt_f32_e64 vcc, s33, v248
    v_mfma_f32_16x16x32_bf16 v[136:139], a[252:255], a[44:47], v[136:139]
    v_mfma_f32_16x16x32_bf16 v[152:155], a[248:251], a[64:67], v[152:155]
    v_mfma_f32_16x16x32_bf16 v[152:155], a[252:255], a[68:71], v[152:155]
    v_mfma_f32_16x16x32_bf16 v[160:163], a[248:251], a[88:91], v[160:163]
    v_mfma_f32_16x16x32_bf16 v[160:163], a[252:255], a[92:95], v[160:163]
    ds_read_b128 a[248:251], v237 offset:8192
    ds_read_b128 a[252:255], v238 offset:8192
    s_waitcnt lgkmcnt(5)
    v_mfma_f32_16x16x32_bf16 v[132:135], a[232:235], a[0:3], v[212:215]
    s_waitcnt lgkmcnt(4)
    v_mfma_f32_16x16x32_bf16 v[132:135], a[236:239], a[4:7], v[132:135]
    v_mfma_f32_16x16x32_bf16 v[140:143], a[232:235], a[24:27], v[216:219]
    v_mfma_f32_16x16x32_bf16 v[140:143], a[236:239], a[28:31], v[140:143]
    v_mfma_f32_16x16x32_bf16 v[156:159], a[232:235], a[48:51], v[220:223]
    v_mfma_f32_16x16x32_bf16 v[156:159], a[236:239], a[52:55], v[156:159]
    v_mfma_f32_16x16x32_bf16 v[164:167], a[232:235], a[72:75], v[224:227]
    v_mfma_f32_16x16x32_bf16 v[164:167], a[236:239], a[76:79], v[164:167]
    ds_read_b64_tr_b16 a[232:233], v239
    ds_read_b64_tr_b16 a[234:235], v239 offset:6144
    ds_read_b64_tr_b16 a[236:237], v240
    ds_read_b64_tr_b16 a[238:239], v240 offset:6144
    s_waitcnt lgkmcnt(7)
    v_mfma_f32_16x16x32_bf16 v[164:167], a[240:243], a[80:83], v[164:167]
    s_waitcnt lgkmcnt(6)
    v_mfma_f32_16x16x32_bf16 v[164:167], a[244:247], a[84:87], v[164:167]
    v_mfma_f32_16x16x32_bf16 v[156:159], a[240:243], a[56:59], v[156:159]
    v_mfma_f32_16x16x32_bf16 v[156:159], a[244:247], a[60:63], v[156:159]
    v_mfma_f32_16x16x32_bf16 v[140:143], a[240:243], a[32:35], v[140:143]
    v_mfma_f32_16x16x32_bf16 v[140:143], a[244:247], a[36:39], v[140:143]
    v_mfma_f32_16x16x32_bf16 v[132:135], a[240:243], a[8:11], v[132:135]
    v_mfma_f32_16x16x32_bf16 v[132:135], a[244:247], a[12:15], v[132:135]
    ds_read_b64_tr_b16 a[240:241], v241
    ds_read_b64_tr_b16 a[242:243], v241 offset:6144
    ds_read_b64_tr_b16 a[244:245], v242
    ds_read_b64_tr_b16 a[246:247], v242 offset:6144
    s_waitcnt lgkmcnt(9)
    v_mfma_f32_16x16x32_bf16 v[132:135], a[248:251], a[16:19], v[132:135]
    s_waitcnt lgkmcnt(8)
    v_mfma_f32_16x16x32_bf16 v[132:135], a[252:255], a[20:23], v[132:135]
    v_mfma_f32_16x16x32_bf16 v[140:143], a[248:251], a[40:43], v[140:143]
    v_mfma_f32_16x16x32_bf16 v[140:143], a[252:255], a[44:47], v[140:143]
    v_mfma_f32_16x16x32_bf16 v[156:159], a[248:251], a[64:67], v[156:159]
    v_mfma_f32_16x16x32_bf16 v[156:159], a[252:255], a[68:71], v[156:159]
    v_mfma_f32_16x16x32_bf16 v[164:167], a[248:251], a[88:91], v[164:167]
    v_mfma_f32_16x16x32_bf16 v[164:167], a[252:255], a[92:95], v[164:167]
    ds_read_b64_tr_b16 a[248:249], v239 offset:1024
    ds_read_b64_tr_b16 a[250:251], v239 offset:7168
    ds_read_b64_tr_b16 a[252:253], v240 offset:1024
    ds_read_b64_tr_b16 a[254:255], v240 offset:7168
    s_waitcnt lgkmcnt(10)
    v_mfma_f32_16x16x32_bf16 v[0:3], a[232:235], v[184:187], v[0:3]
    s_waitcnt lgkmcnt(8)
    v_mfma_f32_16x16x32_bf16 v[4:7], a[236:239], v[184:187], v[4:7]
    v_mfma_f32_16x16x32_bf16 v[48:51], a[232:235], v[188:191], v[48:51]
    s_cbranch_vccnz L_slow1A1
L_ret1A1:
    v_add_f32 v234, v234, v245
    v_add_f32 v235, v235, v246
    v_add_f32 v236, v236, v247
    v_add_u32_e64 v237, s37, v237
    v_mfma_f32_16x16x32_bf16 v[52:55], a[236:239], v[188:191], v[52:55]
    v_exp_f32 v249, v128
    v_exp_f32 v250, v129
    v_mfma_f32_16x16x32_bf16 v[96:99], a[232:235], v[200:203], v[96:99]
    v_add_u32 v238, s37, v238
    v_add_f32 v254, v249, v250
    v_exp_f32_e64 v251, v130
    v_mfma_f32_16x16x32_bf16 v[100:103], a[236:239], v[200:203], v[100:103]
    v_exp_f32_e64 v252, v131
    v_cvt_pk_bf16_f32 v192, v249, v250
    v_add_f32_e64 v254, v254, v251
    v_mfma_f32_16x16x32_bf16 a[168:171], a[232:235], v[204:207], a[168:171]
    v_add_f32 v254, v254, v252
    v_exp_f32 v253, v136
    v_cvt_pk_bf16_f32 v193, v251, v252
    v_mfma_f32_16x16x32_bf16 a[172:175], a[236:239], v[204:207], a[172:175]
    v_exp_f32 v248, v137
    v_exp_f32 v249, v138
    v_mfma_f32_16x16x32_bf16 a[120:123], a[232:235], v[208:211], 0
    v_add_f32 v246, v253, v248
    v_exp_f32 v250, v139
    v_cvt_pk_bf16_f32 v196, v253, v248
    v_mfma_f32_16x16x32_bf16 a[124:127], a[236:239], v[208:211], 0
    ds_read_b64_tr_b16 a[232:233], v241 offset:1024
    ds_read_b64_tr_b16 a[234:235], v241 offset:7168
    ds_read_b64_tr_b16 a[236:237], v242 offset:1024
    ds_read_b64_tr_b16 a[238:239], v242 offset:7168
    s_waitcnt lgkmcnt(10)
    v_mfma_f32_16x16x32_bf16 a[128:131], a[240:243], v[208:211], 0
    v_add_f32 v246, v246, v249
    v_add_f32 v246, v246, v250
    v_exp_f32 v251, v132
    s_waitcnt lgkmcnt(8)
    v_mfma_f32_16x16x32_bf16 a[132:135], a[244:247], v[208:211], 0
    v_exp_f32 v252, v133
    v_cvt_pk_bf16_f32 v197, v249, v250
    v_add_f32_e64 v254, v254, v251
    v_mfma_f32_16x16x32_bf16 a[176:179], a[240:243], v[204:207], a[176:179]
    v_add_f32 v254, v254, v252
    v_exp_f32 v253, v134
    v_cvt_pk_bf16_f32 v194, v251, v252
    v_mfma_f32_16x16x32_bf16 a[180:183], a[244:247], v[204:207], a[180:183]
    v_exp_f32 v248, v135
    v_exp_f32 v249, v140
    v_mfma_f32_16x16x32_bf16 v[104:107], a[240:243], v[200:203], v[104:107]
    v_add_f32 v254, v254, v253
    v_add_f32 v254, v254, v248
    v_exp_f32_e64 v250, v141
    v_mfma_f32_16x16x32_bf16 v[108:111], a[244:247], v[200:203], v[108:111]
    v_cvt_pk_bf16_f32 v195, v253, v248
    v_add_f32 v246, v246, v249
    v_add_f32 v246, v246, v250
    v_cvt_pk_bf16_f32 v198, v249, v250
    v_mfma_f32_16x16x32_bf16 v[56:59], a[240:243], v[188:191], v[56:59]
    v_exp_f32 v251, v142
    v_exp_f32 v252, v143
    v_mfma_f32_16x16x32_bf16 v[60:63], a[244:247], v[188:191], v[60:63]
    v_add_f32 v246, v246, v251
    v_add_f32 v246, v246, v252
    v_cvt_pk_bf16_f32 v199, v251, v252
    v_max_f32_e64 v253, v254, v246
    v_mfma_f32_16x16x32_bf16 v[8:11], a[240:243], v[184:187], v[8:11]
    v_cmp_lt_f32_e64 vcc, s33, v253
    v_mfma_f32_16x16x32_bf16 v[12:15], a[244:247], v[184:187], v[12:15]
    ds_read_b64_tr_b16 a[240:241], v239 offset:2048
    ds_read_b64_tr_b16 a[242:243], v239 offset:8192
    ds_read_b64_tr_b16 a[244:245], v240 offset:2048
    ds_read_b64_tr_b16 a[246:247], v240 offset:8192
    s_waitcnt lgkmcnt(10)
    v_mfma_f32_16x16x32_bf16 v[16:19], a[248:251], v[184:187], v[16:19]
    s_waitcnt lgkmcnt(8)
    v_mfma_f32_16x16x32_bf16 v[20:23], a[252:255], v[184:187], v[20:23]
    v_mfma_f32_16x16x32_bf16 v[64:67], a[248:251], v[188:191], v[64:67]
    v_mfma_f32_16x16x32_bf16 v[68:71], a[252:255], v[188:191], v[68:71]
    v_mfma_f32_16x16x32_bf16 v[112:115], a[248:251], v[200:203], v[112:115]
    v_mfma_f32_16x16x32_bf16 v[116:119], a[252:255], v[200:203], v[116:119]
    s_add_u32 m0, s36, 0
    v_mfma_f32_16x16x32_bf16 a[184:187], a[248:251], v[204:207], a[184:187]
    buffer_load_dwordx4 v243, s[16:19], s35 offen nt lds
    v_mfma_f32_16x16x32_bf16 a[188:191], a[252:255], v[204:207], a[188:191]
    s_add_u32 m0, s36, 0x380
    v_mfma_f32_16x16x32_bf16 a[136:139], a[248:251], v[208:211], 0
    buffer_load_dwordx4 v243, s[16:19], s35 offen offset:128 nt lds
    v_mfma_f32_16x16x32_bf16 a[140:143], a[252:255], v[208:211], 0
    ds_read_b64_tr_b16 a[248:249], v241 offset:2048
    ds_read_b64_tr_b16 a[250:251], v241 offset:8192
    ds_read_b64_tr_b16 a[252:253], v242 offset:2048
    ds_read_b64_tr_b16 a[254:255], v242 offset:8192
    s_waitcnt lgkmcnt(10)
    v_mfma_f32_16x16x32_bf16 a[144:147], a[232:235], v[208:211], 0
    v_add_u32 v241, s37, v241
    v_add_u32 v242, s37, v242
    s_waitcnt lgkmcnt(8)
    v_mfma_f32_16x16x32_bf16 a[148:151], a[236:239], v[208:211], 0
    s_add_u32 m0, s36, 0x700
    v_mfma_f32_16x16x32_bf16 a[192:195], a[232:235], v[204:207], a[192:195]
    buffer_load_dwordx4 v243, s[16:19], s35 offen offset:256 nt lds
    v_mfma_f32_16x16x32_bf16 a[196:199], a[236:239], v[204:207], a[196:199]
    s_add_u32 m0, s36, 0x12000
    v_mfma_f32_16x16x32_bf16 v[120:123], a[232:235], v[200:203], v[120:123]
    buffer_load_dwordx4 v244, s[20:23], s35 offen nt lds
    v_mfma_f32_16x16x32_bf16 v[124:127], a[236:239], v[200:203], v[124:127]
    s_add_u32 m0, s36, 0x12380
    v_mfma_f32_16x16x32_bf16 v[72:75], a[232:235], v[188:191], v[72:75]
    buffer_load_dwordx4 v244, s[20:23], s35 offen offset:128 nt lds
    v_mfma_f32_16x16x32_bf16 v[76:79], a[236:239], v[188:191], v[76:79]
    v_mfma_f32_16x16x32_bf16 v[24:27], a[232:235], v[184:187], v[24:27]
    s_add_u32 m0, s36, 0x12700
    v_mfma_f32_16x16x32_bf16 v[28:31], a[236:239], v[184:187], v[28:31]
    buffer_load_dwordx4 v244, s[20:23], s35 offen offset:256 nt lds
    s_waitcnt lgkmcnt(6)
    v_mfma_f32_16x16x32_bf16 v[32:35], a[240:243], v[184:187], v[32:35]
    s_waitcnt lgkmcnt(4)
    v_mfma_f32_16x16x32_bf16 v[36:39], a[244:247], v[184:187], v[36:39]
    s_add_u32 s36, s36, s38
    v_mfma_f32_16x16x32_bf16 v[80:83], a[240:243], v[188:191], v[80:83]
    s_add_u32 s35, s35, 0x3000
    v_mfma_f32_16x16x32_bf16 v[84:87], a[244:247], v[188:191], v[84:87]
    s_waitcnt vmcnt(6) lgkmcnt(0)
    s_barrier
    ds_read_b128 a[232:235], v237
    ds_read_b128 a[236:239], v238
    v_mfma_f32_16x16x32_bf16 a[216:219], a[240:243], v[200:203], a[216:219]
    s_cmp_ge_u32 s34, 13
    v_mfma_f32_16x16x32_bf16 a[220:223], a[244:247], v[200:203], a[220:223]
    s_cselect_b32 s36, 0x28000, s36
    v_mfma_f32_16x16x32_bf16 a[200:203], a[240:243], v[204:207], a[200:203]
    s_add_u32 s34, s34, 1
    v_mfma_f32_16x16x32_bf16 a[204:207], a[244:247], v[204:207], a[204:207]
    v_mfma_f32_16x16x32_bf16 a[152:155], a[240:243], v[208:211], 0
    v_mfma_f32_16x16x32_bf16 a[156:159], a[244:247], v[208:211], 0
    ds_read_b128 a[240:243], v237 offset:1024
    ds_read_b128 a[244:247], v238 offset:1024
    v_mfma_f32_16x16x32_bf16 v[40:43], a[248:251], v[184:187], v[40:43]
    v_mfma_f32_16x16x32_bf16 v[44:47], a[252:255], v[184:187], v[44:47]
    v_mfma_f32_16x16x32_bf16 v[88:91], a[248:251], v[188:191], v[88:91]
    v_mfma_f32_16x16x32_bf16 v[92:95], a[252:255], v[188:191], v[92:95]
    v_mfma_f32_16x16x32_bf16 a[224:227], a[248:251], v[200:203], a[224:227]
    v_mfma_f32_16x16x32_bf16 a[228:231], a[252:255], v[200:203], a[228:231]
    v_mfma_f32_16x16x32_bf16 a[208:211], a[248:251], v[204:207], a[208:211]
    v_mfma_f32_16x16x32_bf16 a[212:215], a[252:255], v[204:207], a[212:215]
    s_cbranch_vccnz L_slow0A1
L_ret0A1:
    v_add_f32 v232, v232, v254
    v_add_f32_e64 v233, v233, v246
    v_mfma_f32_16x16x32_bf16 a[160:163], a[248:251], v[208:211], 0
    v_add_u32 v239, s37, v239
    v_add_u32 v240, s37, v240
    v_mfma_f32_16x16x32_bf16 a[164:167], a[252:255], v[208:211], 0
    s_waitcnt lgkmcnt(2)
    s_branch L_B
L_tailB:
    ds_read_b64_tr_b16 a[0:1], v239
    ds_read_b64_tr_b16 a[2:3], v239 offset:6144
    ds_read_b64_tr_b16 a[4:5], v240
    ds_read_b64_tr_b16 a[6:7], v240 offset:6144
    ds_read_b64_tr_b16 a[8:9], v241
    ds_read_b64_tr_b16 a[10:11], v241 offset:6144
    ds_read_b64_tr_b16 a[12:13], v242
    ds_read_b64_tr_b16 a[14:15], v242 offset:6144
    v_mov_b32_e64 v177, v232
    v_mbcnt_lo_u32_b32 v128, -1, 0
    v_mbcnt_hi_u32_b32 v128, -1, v128
    v_permlane16_swap_b32 v232, v177
    v_add_f32 v232, v232, v177
    v_mov_b32 v177, v232
    v_and_b32 v129, 15, v128
    v_lshrrev_b32 v130, 4, v128
    v_and_b32 v133, 7, v129
    v_lshrrev_b32 v131, 1, v130
    v_permlane32_swap_b32 v232, v177
    v_mul_u32_u24 v142, 0x180, v129
    v_xor_b32 v133, v133, v131
    v_add_f32 v232, v232, v177
    v_lshl_add_u32 v132, v133, 4, v142
    v_rcp_f32 v176, v232
    v_and_b32 v133, 1, v130
    s_mul_i32 s40, s32, 0x6000
    v_lshl_add_u32 v132, v133, 3, v132
    v_lshrrev_b32 v131, 3, v128
    s_waitcnt lgkmcnt(6)
    v_mfma_f32_16x16x32_bf16 v[0:3], a[0:3], v[192:195], v[0:3]
    s_waitcnt lgkmcnt(4)
    s_mov_b32 s54, 0
    ds_read_b64_tr_b16 a[16:17], v239 offset:1024
    ds_read_b64_tr_b16 a[18:19], v239 offset:7168
    v_mfma_f32_16x16x32_bf16 v[4:7], a[4:7], v[192:195], v[4:7]
    s_waitcnt lgkmcnt(4)
    ds_read_b64_tr_b16 a[20:21], v240 offset:1024
    ds_read_b64_tr_b16 a[22:23], v240 offset:7168
    v_mfma_f32_16x16x32_bf16 v[8:11], a[8:11], v[192:195], v[8:11]
    s_waitcnt lgkmcnt(4)
    ds_read_b64_tr_b16 a[24:25], v241 offset:1024
    ds_read_b64_tr_b16 a[26:27], v241 offset:7168
    v_mfma_f32_16x16x32_bf16 v[12:15], a[12:15], v[192:195], v[12:15]
    ds_read_b64_tr_b16 a[28:29], v242 offset:1024
    ds_read_b64_tr_b16 a[30:31], v242 offset:7168
    v_add_u32_e64 v134, s40, v132
    v_mul_u32_u24 v133, 0x180, v131
    v_and_b32 v132, 7, v128
    v_add_u32 v133, s40, v133
    v_pk_mul_f32 v[0:1], v[0:1], v[176:177] op_sel_hi:[1,0]
    v_pk_mul_f32 v[4:5], v[4:5], v[176:177] op_sel_hi:[1,0]
    v_pk_mul_f32 v[8:9], v[8:9], v[176:177] op_sel_hi:[1,0]
    v_pk_mul_f32 v[12:13], v[12:13], v[176:177] op_sel_hi:[1,0]
    v_lshl_add_u32 v139, v132, 4, v133
    v_pk_mul_f32 v[2:3], v[2:3], v[176:177] op_sel_hi:[1,0]
    v_cvt_pk_bf16_f32 v0, v0, v1
    v_pk_mul_f32 v[6:7], v[6:7], v[176:177] op_sel_hi:[1,0]
    v_cvt_pk_bf16_f32 v4, v4, v5
    v_pk_mul_f32 v[10:11], v[10:11], v[176:177] op_sel_hi:[1,0]
    v_cvt_pk_bf16_f32 v8, v8, v9
    v_pk_mul_f32 v[14:15], v[14:15], v[176:177] op_sel_hi:[1,0]
    v_cvt_pk_bf16_f32 v12, v12, v13
    v_xor_b32 v135, 32, v134
    v_xor_b32 v136, 64, v134
    v_xor_b32 v137, 0x60, v134
    v_xor_b32_e64 v132, v132, v131
    v_cvt_pk_bf16_f32 v1, v2, v3
    v_cvt_pk_bf16_f32 v5, v6, v7
    v_cvt_pk_bf16_f32 v9, v10, v11
    v_cvt_pk_bf16_f32 v13, v14, v15
    v_lshl_add_u32 v138, v132, 4, v133
    s_waitcnt lgkmcnt(6)
    v_mfma_f32_16x16x32_bf16 v[16:19], a[16:19], v[192:195], v[16:19]
    s_waitcnt lgkmcnt(4)
    ds_write_b64 v134, v[0:1]
    v_mfma_f32_16x16x32_bf16 v[20:23], a[20:23], v[192:195], v[20:23]
    s_waitcnt lgkmcnt(3)
    ds_read_b64_tr_b16 a[32:33], v239 offset:2048
    ds_read_b64_tr_b16 a[34:35], v239 offset:8192
    v_mfma_f32_16x16x32_bf16 v[24:27], a[24:27], v[192:195], v[24:27]
    s_waitcnt lgkmcnt(3)
    ds_write_b64 v135, v[4:5]
    v_mfma_f32_16x16x32_bf16 v[28:31], a[28:31], v[192:195], v[28:31]
    ds_read_b64_tr_b16 a[36:37], v240 offset:2048
    ds_read_b64_tr_b16 a[38:39], v240 offset:8192
    ds_read_b64_tr_b16 a[40:41], v241 offset:2048
    ds_write_b64 v136, v[8:9]
    ds_read_b64_tr_b16 a[42:43], v241 offset:8192
    ds_read_b64_tr_b16 a[44:45], v242 offset:2048
    ds_read_b64_tr_b16 a[46:47], v242 offset:8192
    v_pk_mul_f32 v[16:17], v[16:17], v[176:177] op_sel_hi:[1,0]
    v_pk_mul_f32 v[20:21], v[20:21], v[176:177] op_sel_hi:[1,0]
    v_pk_mul_f32 v[24:25], v[24:25], v[176:177] op_sel_hi:[1,0]
    v_pk_mul_f32 v[28:29], v[28:29], v[176:177] op_sel_hi:[1,0]
    v_pk_mul_f32 v[18:19], v[18:19], v[176:177] op_sel_hi:[1,0]
    v_cvt_pk_bf16_f32 v16, v16, v17
    v_pk_mul_f32 v[22:23], v[22:23], v[176:177] op_sel_hi:[1,0]
    v_cvt_pk_bf16_f32 v20, v20, v21
    v_pk_mul_f32 v[26:27], v[26:27], v[176:177] op_sel_hi:[1,0]
    v_cvt_pk_bf16_f32 v24, v24, v25
    v_pk_mul_f32 v[30:31], v[30:31], v[176:177] op_sel_hi:[1,0]
    v_cvt_pk_bf16_f32 v28, v28, v29
    v_cvt_pk_bf16_f32 v17, v18, v19
    v_cvt_pk_bf16_f32 v21, v22, v23
    v_cvt_pk_bf16_f32 v25, v26, v27
    v_cvt_pk_bf16_f32 v29, v30, v31
    s_waitcnt lgkmcnt(8)
    v_mfma_f32_16x16x32_bf16 v[32:35], a[32:35], v[192:195], v[32:35]
    s_waitcnt lgkmcnt(5)
    ds_write_b64 v137, v[12:13]
    ds_read_b128 v[0:3], v138
    ds_read_b128 v[4:7], v138 offset:3072
    v_mfma_f32_16x16x32_bf16 v[36:39], a[36:39], v[192:195], v[36:39]
    s_waitcnt lgkmcnt(5)
    s_mov_b32 s55, 0x1000
    v_mov_b32 v179, v233
    v_mfma_f32_16x16x32_bf16 v[40:43], a[40:43], v[192:195], v[40:43]
    s_waitcnt lgkmcnt(3)
    ds_write_b64 v134, v[16:17] offset:128
    v_mfma_f32_16x16x32_bf16 v[44:47], a[44:47], v[192:195], v[44:47]
    v_permlane16_swap_b32 v233, v179
    v_mfma_f32_16x16x32_bf16 v[48:51], a[0:3], v[196:199], v[48:51]
    ds_write_b64 v135, v[20:21] offset:128
    v_pk_mul_f32 v[32:33], v[32:33], v[176:177] op_sel_hi:[1,0]
    v_pk_mul_f32 v[36:37], v[36:37], v[176:177] op_sel_hi:[1,0]
    v_pk_mul_f32 v[40:41], v[40:41], v[176:177] op_sel_hi:[1,0]
    s_nop 1
    v_pk_mul_f32 v[44:45], v[44:45], v[176:177] op_sel_hi:[1,0]
    v_pk_mul_f32 v[34:35], v[34:35], v[176:177] op_sel_hi:[1,0]
    v_cvt_pk_bf16_f32 v32, v32, v33
    v_pk_mul_f32 v[38:39], v[38:39], v[176:177] op_sel_hi:[1,0]
    v_cvt_pk_bf16_f32 v36, v36, v37
    v_pk_mul_f32 v[42:43], v[42:43], v[176:177] op_sel_hi:[1,0]
    v_cvt_pk_bf16_f32 v40, v40, v41
    v_pk_mul_f32 v[46:47], v[46:47], v[176:177] op_sel_hi:[1,0]
    v_cvt_pk_bf16_f32 v44, v44, v45
    v_cvt_pk_bf16_f32 v33, v34, v35
    v_cvt_pk_bf16_f32 v37, v38, v39
    v_cvt_pk_bf16_f32 v41, v42, v43
    v_cvt_pk_bf16_f32 v45, v46, v47
    v_mfma_f32_16x16x32_bf16 v[52:55], a[4:7], v[196:199], v[52:55]
    s_waitcnt lgkmcnt(3)
    buffer_store_dwordx4 v[0:3], v139, s[24:27], s54 offen nt
    ds_write_b64 v136, v[24:25] offset:128
    s_waitcnt lgkmcnt(3)
    buffer_store_dwordx4 v[4:7], v139, s[24:27], s54 offen offset:3072 nt
    ds_write_b64 v137, v[28:29] offset:128
    ds_read_b128 v[16:19], v138 offset:128
    ds_read_b128 v[20:23], v138 offset:3200
    v_mfma_f32_16x16x32_bf16 v[56:59], a[8:11], v[196:199], v[56:59]
    v_add_f32 v233, v233, v179
    v_mov_b32_e64 v179, v233
    v_mfma_f32_16x16x32_bf16 v[60:63], a[12:15], v[196:199], v[60:63]
    ds_write_b64 v134, v[32:33] offset:256
    v_permlane32_swap_b32 v233, v179
    v_add_f32 v233, v233, v179
    v_rcp_f32_e64 v178, v233
    v_mfma_f32_16x16x32_bf16 v[64:67], a[16:19], v[196:199], v[64:67]
    ds_write_b64 v135, v[36:37] offset:256
    v_pk_mul_f32 v[48:49], v[48:49], v[178:179] op_sel_hi:[1,0]
    v_pk_mul_f32 v[52:53], v[52:53], v[178:179] op_sel_hi:[1,0]
    v_pk_mul_f32 v[56:57], v[56:57], v[178:179] op_sel_hi:[1,0]
    v_pk_mul_f32 v[60:61], v[60:61], v[178:179] op_sel_hi:[1,0]
    v_pk_mul_f32 v[50:51], v[50:51], v[178:179] op_sel_hi:[1,0]
    v_cvt_pk_bf16_f32 v48, v48, v49
    v_pk_mul_f32 v[54:55], v[54:55], v[178:179] op_sel_hi:[1,0]
    v_cvt_pk_bf16_f32 v52, v52, v53
    v_pk_mul_f32 v[58:59], v[58:59], v[178:179] op_sel_hi:[1,0]
    v_cvt_pk_bf16_f32 v56, v56, v57
    v_pk_mul_f32 v[62:63], v[62:63], v[178:179] op_sel_hi:[1,0]
    v_cvt_pk_bf16_f32 v60, v60, v61
    v_cvt_pk_bf16_f32 v49, v50, v51
    v_cvt_pk_bf16_f32 v53, v54, v55
    v_cvt_pk_bf16_f32 v57, v58, v59
    v_cvt_pk_bf16_f32 v61, v62, v63
    v_mfma_f32_16x16x32_bf16 v[68:71], a[20:23], v[196:199], v[68:71]
    s_waitcnt lgkmcnt(3)
    buffer_store_dwordx4 v[16:19], v139, s[24:27], s54 offen offset:128 nt
    ds_write_b64 v136, v[40:41] offset:256
    s_waitcnt lgkmcnt(3)
    buffer_store_dwordx4 v[20:23], v139, s[24:27], s54 offen offset:3200 nt
    ds_write_b64 v137, v[44:45] offset:256
    ds_read_b128 v[32:35], v138 offset:256
    ds_read_b128 v[36:39], v138 offset:3328
    v_mfma_f32_16x16x32_bf16 v[72:75], a[24:27], v[196:199], v[72:75]
    s_mov_b32 s56, 0x2000
    ds_write_b64 v134, v[48:49] offset:6144
    v_mfma_f32_16x16x32_bf16 v[76:79], a[28:31], v[196:199], v[76:79]
    v_exp_f32_e64 v252, v152
    v_mfma_f32_16x16x32_bf16 v[80:83], a[32:35], v[196:199], v[80:83]
    ds_write_b64 v135, v[52:53] offset:6144
    v_pk_mul_f32 v[64:65], v[64:65], v[178:179] op_sel_hi:[1,0]
    v_pk_mul_f32 v[68:69], v[68:69], v[178:179] op_sel_hi:[1,0]
    v_pk_mul_f32 v[72:73], v[72:73], v[178:179] op_sel_hi:[1,0]
    s_nop 1
    v_pk_mul_f32 v[76:77], v[76:77], v[178:179] op_sel_hi:[1,0]
    v_pk_mul_f32 v[66:67], v[66:67], v[178:179] op_sel_hi:[1,0]
    v_cvt_pk_bf16_f32 v64, v64, v65
    v_pk_mul_f32 v[70:71], v[70:71], v[178:179] op_sel_hi:[1,0]
    v_cvt_pk_bf16_f32 v68, v68, v69
    v_pk_mul_f32 v[74:75], v[74:75], v[178:179] op_sel_hi:[1,0]
    v_cvt_pk_bf16_f32 v72, v72, v73
    v_pk_mul_f32 v[78:79], v[78:79], v[178:179] op_sel_hi:[1,0]
    v_cvt_pk_bf16_f32 v76, v76, v77
    v_cvt_pk_bf16_f32 v65, v66, v67
    v_cvt_pk_bf16_f32 v69, v70, v71
    v_cvt_pk_bf16_f32 v73, v74, v75
    v_cvt_pk_bf16_f32 v77, v78, v79
    v_mfma_f32_16x16x32_bf16 v[84:87], a[36:39], v[196:199], v[84:87]
    s_waitcnt lgkmcnt(3)
    buffer_store_dwordx4 v[32:35], v139, s[24:27], s54 offen offset:256 nt
    ds_write_b64 v136, v[56:57] offset:6144
    s_waitcnt lgkmcnt(3)
    buffer_store_dwordx4 v[36:39], v139, s[24:27], s54 offen offset:3328 nt
    ds_write_b64 v137, v[60:61] offset:6144
    ds_read_b128 v[48:51], v138 offset:6144
    ds_read_b128 v[52:55], v138 offset:9216
    v_mfma_f32_16x16x32_bf16 v[88:91], a[40:43], v[196:199], v[88:91]
    v_exp_f32 v253, v153
    v_mfma_f32_16x16x32_bf16 v[92:95], a[44:47], v[196:199], v[92:95]
    ds_write_b64 v134, v[64:65] offset:6272
    v_exp_f32 v248, v154
    v_exp_f32 v249, v155
    v_exp_f32 v250, v156
    v_exp_f32 v251, v157
    v_add_f32_e64 v245, v252, v253
    v_cvt_pk_bf16_f32 v200, v252, v253
    v_add_f32 v245, v245, v248
    v_exp_f32 v252, v158
    v_exp_f32 v253, v159
    v_add_f32 v245, v245, v249
    v_cvt_pk_bf16_f32 v201, v248, v249
    v_add_f32_e64 v245, v245, v250
    v_cvt_pk_bf16_f32 v202, v250, v251
    v_exp_f32 v248, v160
    v_exp_f32 v249, v161
    v_add_f32 v245, v245, v251
    v_exp_f32 v250, v162
    v_pk_mul_f32 v[80:81], v[80:81], v[178:179] op_sel_hi:[1,0]
    v_pk_mul_f32 v[84:85], v[84:85], v[178:179] op_sel_hi:[1,0]
    v_pk_mul_f32 v[88:89], v[88:89], v[178:179] op_sel_hi:[1,0]
    v_pk_mul_f32 v[92:93], v[92:93], v[178:179] op_sel_hi:[1,0]
    v_add_f32_e64 v245, v245, v252
    v_cvt_pk_bf16_f32 v203, v252, v253
    v_exp_f32_e64 v251, v163
    v_pk_mul_f32 v[82:83], v[82:83], v[178:179] op_sel_hi:[1,0]
    v_cvt_pk_bf16_f32 v80, v80, v81
    v_pk_mul_f32 v[86:87], v[86:87], v[178:179] op_sel_hi:[1,0]
    v_cvt_pk_bf16_f32 v84, v84, v85
    v_pk_mul_f32 v[90:91], v[90:91], v[178:179] op_sel_hi:[1,0]
    v_cvt_pk_bf16_f32 v88, v88, v89
    v_pk_mul_f32 v[94:95], v[94:95], v[178:179] op_sel_hi:[1,0]
    v_cvt_pk_bf16_f32 v92, v92, v93
    v_add_f32 v245, v245, v253
    v_exp_f32 v252, v164
    v_cvt_pk_bf16_f32 v81, v82, v83
    v_cvt_pk_bf16_f32 v85, v86, v87
    v_cvt_pk_bf16_f32 v89, v90, v91
    v_cvt_pk_bf16_f32 v93, v94, v95
    v_add_f32_e64 v246, v248, v249
    v_cvt_pk_bf16_f32 v204, v248, v249
    v_exp_f32 v253, v165
    v_add_f32 v246, v246, v250
    v_exp_f32 v248, v166
    v_add_f32 v246, v246, v251
    v_exp_f32 v249, v167
    v_add_f32 v246, v246, v252
    v_add_f32 v246, v246, v253
    v_add_f32 v246, v246, v248
    v_cvt_pk_bf16_f32 v205, v250, v251
    v_add_f32 v246, v246, v249
    v_max_f32 v250, v245, v246
    v_cmp_lt_f32_e64 vcc, s33, v250
    v_cvt_pk_bf16_f32 v206, v252, v253
    v_cvt_pk_bf16_f32 v207, v248, v249
    v_mov_b32 v184, v236
    s_lshr_b32 s41, s32, 1
    s_waitcnt lgkmcnt(2)
    buffer_store_dwordx4 v[48:51], v139, s[24:27], s55 offen offset:2048 nt
    ds_write_b64 v135, v[68:69] offset:6272
    s_waitcnt lgkmcnt(2)
    buffer_store_dwordx4 v[52:55], v139, s[24:27], s56 offen offset:1024 nt
    ds_write_b64 v136, v[72:73] offset:6272
    s_cbranch_vccnz L_slowTB
L_retTB:
    v_add_f32 v234, v234, v245
    v_mov_b32_e64 v181, v234
    v_mfma_f32_16x16x32_bf16 v[96:99], a[0:3], v[200:203], v[96:99]
    ds_write_b64 v137, v[76:77] offset:6272
    ds_read_b128 v[64:67], v138 offset:6272
    ds_read_b128 v[68:71], v138 offset:9344
    v_permlane16_swap_b32 v234, v181
    v_mfma_f32_16x16x32_bf16 v[100:103], a[4:7], v[200:203], v[100:103]
    ds_write_b64 v134, v[80:81] offset:6400
    v_mfma_f32_16x16x32_bf16 v[104:107], a[8:11], v[200:203], v[104:107]
    s_mul_i32 s42, s41, 0x9000
    v_add_f32 v234, v234, v181
    v_mov_b32_e64 v181, v234
    v_mfma_f32_16x16x32_bf16 v[108:111], a[12:15], v[200:203], v[108:111]
    ds_write_b64 v135, v[84:85] offset:6400
    v_permlane32_swap_b32 v234, v181
    v_add_f32 v234, v234, v181
    v_rcp_f32_e64 v180, v234
    v_mfma_f32_16x16x32_bf16 v[112:115], a[16:19], v[200:203], v[112:115]
    ds_write_b64 v136, v[88:89] offset:6400
    v_pk_mul_f32 v[96:97], v[96:97], v[180:181] op_sel_hi:[1,0]
    v_pk_mul_f32 v[100:101], v[100:101], v[180:181] op_sel_hi:[1,0]
    v_pk_mul_f32 v[104:105], v[104:105], v[180:181] op_sel_hi:[1,0]
    v_pk_mul_f32 v[108:109], v[108:109], v[180:181] op_sel_hi:[1,0]
    v_pk_mul_f32 v[98:99], v[98:99], v[180:181] op_sel_hi:[1,0]
    v_cvt_pk_bf16_f32 v96, v96, v97
    v_pk_mul_f32 v[102:103], v[102:103], v[180:181] op_sel_hi:[1,0]
    v_cvt_pk_bf16_f32 v100, v100, v101
    v_pk_mul_f32 v[106:107], v[106:107], v[180:181] op_sel_hi:[1,0]
    v_cvt_pk_bf16_f32 v104, v104, v105
    v_pk_mul_f32 v[110:111], v[110:111], v[180:181] op_sel_hi:[1,0]
    v_cvt_pk_bf16_f32 v108, v108, v109
    v_cvt_pk_bf16_f32 v97, v98, v99
    v_cvt_pk_bf16_f32 v101, v102, v103
    v_cvt_pk_bf16_f32 v105, v106, v107
    v_cvt_pk_bf16_f32 v109, v110, v111
    v_mfma_f32_16x16x32_bf16 v[116:119], a[20:23], v[200:203], v[116:119]
    s_waitcnt lgkmcnt(4)
    buffer_store_dwordx4 v[64:67], v139, s[24:27], s55 offen offset:2176 nt
    ds_write_b64 v137, v[92:93] offset:6400
    ds_read_b128 v[80:83], v138 offset:6400
    s_waitcnt lgkmcnt(5)
    buffer_store_dwordx4 v[68:71], v139, s[24:27], s56 offen offset:1152 nt
    ds_read_b128 v[84:87], v138 offset:9472
    ds_write_b64 v134, v[96:97] offset:12288
    v_mfma_f32_16x16x32_bf16 v[120:123], a[24:27], v[200:203], v[120:123]
    s_add_u32 s42, s42, 0x18000
    v_permlane16_swap_b32 v236, v184
    v_mfma_f32_16x16x32_bf16 v[124:127], a[28:31], v[200:203], v[124:127]
    s_mov_b32 s57, 0x3000
    ds_write_b64 v135, v[100:101] offset:12288
    v_add_f32 v236, v236, v184
    v_mov_b32_e64 v184, v236
    v_lshl_add_u32 v140, v128, 4, s42
    s_lshl_b32 s42, s41, 8
    v_permlane32_swap_b32 v236, v184
    v_pk_mul_f32 v[112:113], v[112:113], v[180:181] op_sel_hi:[1,0]
    v_pk_mul_f32 v[116:117], v[116:117], v[180:181] op_sel_hi:[1,0]
    v_pk_mul_f32 v[120:121], v[120:121], v[180:181] op_sel_hi:[1,0]
    v_pk_mul_f32 v[124:125], v[124:125], v[180:181] op_sel_hi:[1,0]
    s_add_u32 s42, s42, 0x27000
    v_add_f32_e64 v236, v236, v184
    v_pk_mul_f32 v[114:115], v[114:115], v[180:181] op_sel_hi:[1,0]
    v_cvt_pk_bf16_f32 v112, v112, v113
    v_pk_mul_f32 v[118:119], v[118:119], v[180:181] op_sel_hi:[1,0]
    v_cvt_pk_bf16_f32 v116, v116, v117
    v_pk_mul_f32 v[122:123], v[122:123], v[180:181] op_sel_hi:[1,0]
    v_cvt_pk_bf16_f32 v120, v120, v121
    v_pk_mul_f32 v[126:127], v[126:127], v[180:181] op_sel_hi:[1,0]
    v_cvt_pk_bf16_f32 v124, v124, v125
    v_lshl_add_u32 v141, v129, 3, s42
    v_mov_b32 v184, v228
    v_mov_b32 v185, v236
    v_cvt_pk_bf16_f32 v113, v114, v115
    v_cvt_pk_bf16_f32 v117, v118, v119
    v_cvt_pk_bf16_f32 v121, v122, v123
    v_cvt_pk_bf16_f32 v125, v126, v127
    v_mfma_f32_16x16x32_bf16 a[216:219], a[32:35], v[200:203], a[216:219]
    s_waitcnt lgkmcnt(3)
    buffer_store_dwordx4 v[80:83], v139, s[24:27], s55 offen offset:2304 nt
    ds_write_b64 v136, v[104:105] offset:12288
    s_waitcnt lgkmcnt(3)
    buffer_store_dwordx4 v[84:87], v139, s[24:27], s56 offen offset:1280 nt
    ds_write_b64 v137, v[108:109] offset:12288
    ds_read_b128 v[8:11], v138 offset:12288
    ds_read_b128 v[12:15], v138 offset:15360
    v_mfma_f32_16x16x32_bf16 a[220:223], a[36:39], v[200:203], a[220:223]
    v_accvgpr_read_b32 v168, a216
    v_accvgpr_read_b32 v169, a217
    v_mfma_f32_16x16x32_bf16 a[224:227], a[40:43], v[200:203], a[224:227]
    ds_write_b128 v140, a[152:155] offset:8192
    v_mfma_f32_16x16x32_bf16 a[228:231], a[44:47], v[200:203], a[228:231]
    s_nop 2
    v_accvgpr_read_b32 v172, a220
    v_accvgpr_read_b32 v173, a221
    v_accvgpr_read_b32 v170, a218
    v_accvgpr_read_b32 v171, a219
    v_pk_mul_f32 v[168:169], v[168:169], v[180:181] op_sel_hi:[1,0]
    v_accvgpr_read_b32 v174, a222
    v_accvgpr_read_b32 v175, a223
    v_pk_mul_f32 v[172:173], v[172:173], v[180:181] op_sel_hi:[1,0]
    v_pk_mul_f32 v[170:171], v[170:171], v[180:181] op_sel_hi:[1,0]
    v_cvt_pk_bf16_f32 v168, v168, v169
    v_pk_mul_f32 v[174:175], v[174:175], v[180:181] op_sel_hi:[1,0]
    v_cvt_pk_bf16_f32 v172, v172, v173
    v_cvt_pk_bf16_f32 v169, v170, v171
    v_cvt_pk_bf16_f32 v173, v174, v175
    v_accvgpr_read_b32 v170, a226
    v_accvgpr_read_b32 v171, a227
    v_accvgpr_read_b32 v174, a230
    v_accvgpr_read_b32 v175, a231
    v_pk_mul_f32 v[170:171], v[170:171], v[180:181] op_sel_hi:[1,0]
    v_pk_mul_f32 v[174:175], v[174:175], v[180:181] op_sel_hi:[1,0]
    v_add_f32 v235, v235, v246
    v_mov_b32_e64 v183, v235
    v_mfma_f32_16x16x32_bf16 a[168:171], a[0:3], v[204:207], a[168:171]
    s_waitcnt lgkmcnt(2)
    buffer_store_dwordx4 v[8:11], v139, s[24:27], s57 offen nt
    ds_write_b128 v140, a[156:159] offset:9216
    s_waitcnt lgkmcnt(2)
    buffer_store_dwordx4 v[12:15], v139, s[24:27], s57 offen offset:3072 nt
    v_mfma_f32_16x16x32_bf16 a[172:175], a[4:7], v[204:207], a[172:175]
    ds_write_b128 v140, a[160:163] offset:10240
    v_permlane16_swap_b32 v235, v183
    v_add_f32 v235, v235, v183
    v_mov_b32_e64 v183, v235
    v_mfma_f32_16x16x32_bf16 a[176:179], a[8:11], v[204:207], a[176:179]
    s_mov_b32 s58, 0x4000
    v_permlane32_swap_b32 v235, v183
    v_mfma_f32_16x16x32_bf16 a[180:183], a[12:15], v[204:207], a[180:183]
    ds_write_b128 v140, a[164:167] offset:11264
    v_add_f32 v235, v235, v183
    v_rcp_f32_e64 v182, v235
    v_mfma_f32_16x16x32_bf16 a[184:187], a[16:19], v[204:207], a[184:187]
    s_mov_b32 s59, 0x5000
    v_accvgpr_read_b32 v248, a120
    v_accvgpr_read_b32 v249, a121
    v_mfma_f32_16x16x32_bf16 a[188:191], a[20:23], v[204:207], a[188:191]
    ds_write_b64 v141, v[184:185]
    v_mfma_f32_16x16x32_bf16 a[192:195], a[24:27], v[204:207], a[192:195]
    s_mul_i32 s41, s41, 0x1800
    v_accvgpr_read_b32 v252, a124
    v_accvgpr_read_b32 v253, a125
    v_mfma_f32_16x16x32_bf16 a[196:199], a[28:31], v[204:207], a[196:199]
    ds_write_b64 v134, v[112:113] offset:12416
    v_accvgpr_read_b32 v250, a122
    v_accvgpr_read_b32 v251, a123
    v_mfma_f32_16x16x32_bf16 a[200:203], a[32:35], v[204:207], a[200:203]
    ds_write_b64 v135, v[116:117] offset:12416
    v_mfma_f32_16x16x32_bf16 a[204:207], a[36:39], v[204:207], a[204:207]
    s_add_u32 s41, s41, 0x18000
    s_sub_u32 s41, s41, s40
    ds_write_b64 v136, v[120:121] offset:12416
    v_mfma_f32_16x16x32_bf16 a[208:211], a[40:43], v[204:207], a[208:211]
    ds_write_b64 v137, v[124:125] offset:12416
    ds_read_b128 v[24:27], v138 offset:12416
    ds_read_b128 v[28:31], v138 offset:15488
    v_mfma_f32_16x16x32_bf16 a[212:215], a[44:47], v[204:207], a[212:215]
    s_waitcnt lgkmcnt(6)
    s_barrier
    ds_write_b64 v134, v[168:169] offset:12544
    v_accvgpr_read_b32 v168, a224
    v_accvgpr_read_b32 v169, a225
    v_pk_mul_f32 v[168:169], v[168:169], v[180:181] op_sel_hi:[1,0]
    v_cvt_pk_bf16_f32 v168, v168, v169
    v_cvt_pk_bf16_f32 v169, v170, v171
    v_accvgpr_read_b32 v170, a170
    v_accvgpr_read_b32 v171, a171
    v_pk_mul_f32 v[170:171], v[170:171], v[182:183] op_sel_hi:[1,0]
    ds_write_b64 v135, v[172:173] offset:12544
    v_accvgpr_read_b32 v172, a228
    v_accvgpr_read_b32 v173, a229
    v_pk_mul_f32 v[172:173], v[172:173], v[180:181] op_sel_hi:[1,0]
    v_cvt_pk_bf16_f32 v172, v172, v173
    v_cvt_pk_bf16_f32 v173, v174, v175
    v_accvgpr_read_b32 v174, a174
    v_accvgpr_read_b32 v175, a175
    v_pk_mul_f32 v[174:175], v[174:175], v[182:183] op_sel_hi:[1,0]
    s_waitcnt lgkmcnt(3)
    buffer_store_dwordx4 v[24:27], v139, s[24:27], s57 offen offset:128 nt
    ds_write_b64 v136, v[168:169] offset:12544
    ds_read_b64 v[186:187], v141 offset:128
    s_waitcnt lgkmcnt(4)
    buffer_store_dwordx4 v[28:31], v139, s[24:27], s57 offen offset:3200 nt
    ds_write_b64 v137, v[172:173] offset:12544
    ds_read_b128 v[40:43], v138 offset:12544
    ds_read_b128 v[44:47], v138 offset:15616
    ds_read_b128 v[152:155], v140
    ds_read_b128 v[156:159], v140 offset:1024
    v_accvgpr_read_b32 v168, a168
    v_accvgpr_read_b32 v169, a169
    v_accvgpr_read_b32 v172, a172
    v_accvgpr_read_b32 v173, a173
    v_pk_mul_f32 v[168:169], v[168:169], v[182:183] op_sel_hi:[1,0]
    v_pk_mul_f32 v[172:173], v[172:173], v[182:183] op_sel_hi:[1,0]
    v_cvt_pk_bf16_f32 v168, v168, v169
    v_cvt_pk_bf16_f32 v172, v172, v173
    v_cvt_pk_bf16_f32 v169, v170, v171
    v_cvt_pk_bf16_f32 v173, v174, v175
    v_accvgpr_read_b32 v170, a178
    v_accvgpr_read_b32 v171, a179
    v_accvgpr_read_b32 v174, a182
    v_accvgpr_read_b32 v175, a183
    v_pk_mul_f32 v[170:171], v[170:171], v[182:183] op_sel_hi:[1,0]
    v_pk_mul_f32 v[174:175], v[174:175], v[182:183] op_sel_hi:[1,0]
    s_waitcnt lgkmcnt(5)
    v_min_f32 v189, v184, v186
    v_sub_f32 v188, v189, v184
    v_sub_f32 v190, v189, v186
    v_exp_f32 v188, v188
    v_exp_f32 v190, v190
    v_mul_f32 v191, v188, v185
    v_fma_f32 v191, v190, v187, v191
    v_rcp_f32_e64 v191, v191
    ds_read_b128 v[160:163], v140 offset:2048
    ds_read_b128 v[164:167], v140 offset:3072
    ds_read_b128 v[144:147], v140 offset:4096
    ds_write_b64 v134, v[168:169] offset:18432
    v_accvgpr_read_b32 v168, a176
    v_accvgpr_read_b32 v169, a177
    v_pk_mul_f32 v[168:169], v[168:169], v[182:183] op_sel_hi:[1,0]
    v_cvt_pk_bf16_f32 v168, v168, v169
    v_cvt_pk_bf16_f32 v169, v170, v171
    v_mul_f32 v190, v190, v191
    v_mul_f32 v188, v188, v191
    s_waitcnt lgkmcnt(5)
    v_pk_mul_f32 v[152:153], v[152:153], v[190:191] op_sel_hi:[1,0]
    v_pk_fma_f32 v[152:153], v[248:249], v[188:189], v[152:153] op_sel_hi:[1,0,1]
    s_waitcnt lgkmcnt(4)
    v_pk_mul_f32 v[156:157], v[156:157], v[190:191] op_sel_hi:[1,0]
    v_pk_mul_f32 v[154:155], v[154:155], v[190:191] op_sel_hi:[1,0]
    v_pk_fma_f32 v[156:157], v[252:253], v[188:189], v[156:157] op_sel_hi:[1,0,1]
    v_accvgpr_read_b32 v248, a126
    v_accvgpr_read_b32 v249, a127
    v_pk_mul_f32 v[158:159], v[158:159], v[190:191] op_sel_hi:[1,0]
    v_pk_fma_f32 v[154:155], v[250:251], v[188:189], v[154:155] op_sel_hi:[1,0,1]
    v_pk_fma_f32 v[158:159], v[248:249], v[188:189], v[158:159] op_sel_hi:[1,0,1]
    v_accvgpr_read_b32 v252, a130
    v_accvgpr_read_b32 v253, a131
    v_accvgpr_read_b32 v250, a128
    v_accvgpr_read_b32 v251, a129
    v_accvgpr_read_b32 v248, a132
    v_accvgpr_read_b32 v249, a133
    v_accvgpr_read_b32 v170, a186
    s_waitcnt lgkmcnt(3)
    v_pk_mul_f32 v[162:163], v[162:163], v[190:191] op_sel_hi:[1,0]
    v_pk_mul_f32 v[160:161], v[160:161], v[190:191] op_sel_hi:[1,0]
    v_pk_fma_f32 v[162:163], v[252:253], v[188:189], v[162:163] op_sel_hi:[1,0,1]
    s_waitcnt lgkmcnt(2)
    v_pk_mul_f32 v[164:165], v[164:165], v[190:191] op_sel_hi:[1,0]
    v_accvgpr_read_b32 v171, a187
    v_pk_fma_f32 v[160:161], v[250:251], v[188:189], v[160:161] op_sel_hi:[1,0,1]
    v_pk_fma_f32 v[164:165], v[248:249], v[188:189], v[164:165] op_sel_hi:[1,0,1]
    v_accvgpr_read_b32 v252, a136
    v_accvgpr_read_b32 v253, a137
    s_waitcnt lgkmcnt(1)
    v_pk_mul_f32 v[144:145], v[144:145], v[190:191] op_sel_hi:[1,0]
    v_pk_mul_f32 v[170:171], v[170:171], v[182:183] op_sel_hi:[1,0]
    v_accvgpr_read_b32 v250, a134
    v_accvgpr_read_b32 v251, a135
    v_pk_mul_f32 v[166:167], v[166:167], v[190:191] op_sel_hi:[1,0]
    v_pk_fma_f32 v[144:145], v[252:253], v[188:189], v[144:145] op_sel_hi:[1,0,1]
    v_accvgpr_read_b32 v248, a138
    v_accvgpr_read_b32 v249, a139
    v_pk_mul_f32 v[146:147], v[146:147], v[190:191] op_sel_hi:[1,0]
    v_pk_fma_f32 v[166:167], v[250:251], v[188:189], v[166:167] op_sel_hi:[1,0,1]
    v_pk_fma_f32 v[146:147], v[248:249], v[188:189], v[146:147] op_sel_hi:[1,0,1]
    v_accvgpr_read_b32 v252, a142
    v_accvgpr_read_b32 v253, a143
    v_accvgpr_read_b32 v250, a140
    v_accvgpr_read_b32 v251, a141
    v_accvgpr_read_b32 v248, a144
    v_accvgpr_read_b32 v249, a145
    v_cvt_pk_bf16_f32 v152, v152, v153
    v_cvt_pk_bf16_f32 v156, v156, v157
    v_cvt_pk_bf16_f32 v160, v160, v161
    v_cvt_pk_bf16_f32 v164, v164, v165
    v_cvt_pk_bf16_f32 v144, v144, v145
    v_cvt_pk_bf16_f32 v153, v154, v155
    v_cvt_pk_bf16_f32 v157, v158, v159
    v_cvt_pk_bf16_f32 v161, v162, v163
    v_cvt_pk_bf16_f32 v165, v166, v167
    v_cvt_pk_bf16_f32 v145, v146, v147
    ds_write_b64 v135, v[172:173] offset:18432
    v_accvgpr_read_b32 v172, a180
    v_accvgpr_read_b32 v173, a181
    v_pk_mul_f32 v[172:173], v[172:173], v[182:183] op_sel_hi:[1,0]
    v_cvt_pk_bf16_f32 v172, v172, v173
    v_cvt_pk_bf16_f32 v173, v174, v175
    v_accvgpr_read_b32 v174, a190
    v_accvgpr_read_b32 v175, a191
    v_pk_mul_f32 v[174:175], v[174:175], v[182:183] op_sel_hi:[1,0]
    ds_read_b128 v[148:151], v140 offset:5120
    ds_read_b128 v[192:195], v140 offset:6144
    ds_read_b128 v[196:199], v140 offset:7168
    buffer_store_dwordx4 v[40:43], v139, s[24:27], s57 offen offset:256 nt
    ds_write_b64 v136, v[168:169] offset:18432
    buffer_store_dwordx4 v[44:47], v139, s[24:27], s57 offen offset:3328 nt
    ds_write_b64 v137, v[172:173] offset:18432
    ds_read_b128 v[56:59], v138 offset:18432
    ds_read_b128 v[60:63], v138 offset:21504
    v_accvgpr_read_b32 v168, a184
    v_accvgpr_read_b32 v169, a185
    v_accvgpr_read_b32 v172, a188
    v_accvgpr_read_b32 v173, a189
    v_pk_mul_f32 v[168:169], v[168:169], v[182:183] op_sel_hi:[1,0]
    v_pk_mul_f32 v[172:173], v[172:173], v[182:183] op_sel_hi:[1,0]
    v_cvt_pk_bf16_f32 v168, v168, v169
    v_cvt_pk_bf16_f32 v172, v172, v173
    v_cvt_pk_bf16_f32 v169, v170, v171
    v_cvt_pk_bf16_f32 v173, v174, v175
    s_waitcnt lgkmcnt(6)
    v_pk_mul_f32 v[150:151], v[150:151], v[190:191] op_sel_hi:[1,0]
    v_pk_mul_f32 v[148:149], v[148:149], v[190:191] op_sel_hi:[1,0]
    v_pk_fma_f32 v[150:151], v[252:253], v[188:189], v[150:151] op_sel_hi:[1,0,1]
    s_waitcnt lgkmcnt(5)
    v_pk_mul_f32 v[192:193], v[192:193], v[190:191] op_sel_hi:[1,0]
    v_pk_fma_f32 v[148:149], v[250:251], v[188:189], v[148:149] op_sel_hi:[1,0,1]
    v_pk_fma_f32 v[192:193], v[248:249], v[188:189], v[192:193] op_sel_hi:[1,0,1]
    v_accvgpr_read_b32 v252, a148
    v_accvgpr_read_b32 v253, a149
    s_waitcnt lgkmcnt(4)
    v_pk_mul_f32 v[196:197], v[196:197], v[190:191] op_sel_hi:[1,0]
    v_accvgpr_read_b32 v170, a194
    v_accvgpr_read_b32 v171, a195
    v_accvgpr_read_b32 v174, a198
    v_accvgpr_read_b32 v175, a199
    v_accvgpr_read_b32 v250, a146
    v_accvgpr_read_b32 v251, a147
    v_pk_mul_f32 v[194:195], v[194:195], v[190:191] op_sel_hi:[1,0]
    v_pk_fma_f32 v[196:197], v[252:253], v[188:189], v[196:197] op_sel_hi:[1,0,1]
    v_accvgpr_read_b32 v248, a150
    v_accvgpr_read_b32 v249, a151
    v_pk_mul_f32 v[198:199], v[198:199], v[190:191] op_sel_hi:[1,0]
    v_pk_mul_f32 v[170:171], v[170:171], v[182:183] op_sel_hi:[1,0]
    v_pk_mul_f32 v[174:175], v[174:175], v[182:183] op_sel_hi:[1,0]
    v_cvt_pk_bf16_f32 v148, v148, v149
    v_pk_fma_f32 v[194:195], v[250:251], v[188:189], v[194:195] op_sel_hi:[1,0,1]
    v_cvt_pk_bf16_f32 v192, v192, v193
    v_pk_fma_f32 v[198:199], v[248:249], v[188:189], v[198:199] op_sel_hi:[1,0,1]
    v_cvt_pk_bf16_f32 v196, v196, v197
    v_cvt_pk_bf16_f32 v149, v150, v151
    v_cvt_pk_bf16_f32 v193, v194, v195
    v_cvt_pk_bf16_f32 v197, v198, v199
    ds_write_b64 v134, v[168:169] offset:18560
    v_accvgpr_read_b32 v168, a192
    v_accvgpr_read_b32 v169, a193
    v_pk_mul_f32 v[168:169], v[168:169], v[182:183] op_sel_hi:[1,0]
    v_cvt_pk_bf16_f32 v168, v168, v169
    v_cvt_pk_bf16_f32 v169, v170, v171
    v_accvgpr_read_b32 v170, a202
    v_accvgpr_read_b32 v171, a203
    v_pk_mul_f32 v[170:171], v[170:171], v[182:183] op_sel_hi:[1,0]
    ds_write_b64 v135, v[172:173] offset:18560
    v_accvgpr_read_b32 v172, a196
    v_accvgpr_read_b32 v173, a197
    v_pk_mul_f32 v[172:173], v[172:173], v[182:183] op_sel_hi:[1,0]
    v_cvt_pk_bf16_f32 v172, v172, v173
    v_cvt_pk_bf16_f32 v173, v174, v175
    v_accvgpr_read_b32 v174, a206
    v_accvgpr_read_b32 v175, a207
    v_pk_mul_f32 v[174:175], v[174:175], v[182:183] op_sel_hi:[1,0]
    s_waitcnt lgkmcnt(3)
    buffer_store_dwordx4 v[56:59], v139, s[24:27], s58 offen offset:2048 nt
    ds_write_b64 v136, v[168:169] offset:18560
    s_waitcnt lgkmcnt(3)
    buffer_store_dwordx4 v[60:63], v139, s[24:27], s59 offen offset:1024 nt
    ds_write_b64 v137, v[172:173] offset:18560
    ds_read_b128 v[72:75], v138 offset:18560
    ds_read_b128 v[76:79], v138 offset:21632
    v_accvgpr_read_b32 v168, a200
    v_accvgpr_read_b32 v169, a201
    v_accvgpr_read_b32 v172, a204
    v_accvgpr_read_b32 v173, a205
    v_pk_mul_f32 v[168:169], v[168:169], v[182:183] op_sel_hi:[1,0]
    v_pk_mul_f32 v[172:173], v[172:173], v[182:183] op_sel_hi:[1,0]
    v_cvt_pk_bf16_f32 v168, v168, v169
    v_cvt_pk_bf16_f32 v172, v172, v173
    v_cvt_pk_bf16_f32 v169, v170, v171
    v_cvt_pk_bf16_f32 v173, v174, v175
    v_accvgpr_read_b32 v170, a210
    v_accvgpr_read_b32 v171, a211
    v_accvgpr_read_b32 v174, a214
    v_accvgpr_read_b32 v175, a215
    v_pk_mul_f32 v[170:171], v[170:171], v[182:183] op_sel_hi:[1,0]
    v_pk_mul_f32 v[174:175], v[174:175], v[182:183] op_sel_hi:[1,0]
    ds_write_b64 v134, v[152:153]
    ds_write_b64 v135, v[156:157]
    s_waitcnt lgkmcnt(3)
    buffer_store_dwordx4 v[72:75], v139, s[24:27], s58 offen offset:2176 nt
    ds_write_b64 v136, v[160:161]
    s_waitcnt lgkmcnt(3)
    buffer_store_dwordx4 v[76:79], v139, s[24:27], s59 offen offset:1152 nt
    ds_write_b64 v137, v[164:165]
    ds_read_b128 v[164:167], v138
    ds_read_b128 v[160:163], v138 offset:3072
    ds_write_b64 v134, v[144:145] offset:128
    ds_write_b64 v135, v[148:149] offset:128
    ds_write_b64 v136, v[192:193] offset:128
    ds_write_b64 v137, v[196:197] offset:128
    ds_read_b128 v[196:199], v138 offset:128
    ds_read_b128 v[192:195], v138 offset:3200
    s_waitcnt lgkmcnt(7)
    buffer_store_dwordx4 v[164:167], v139, s[24:27], s41 offen nt
    ds_write_b64 v134, v[168:169] offset:18688
    v_accvgpr_read_b32 v168, a208
    v_accvgpr_read_b32 v169, a209
    v_pk_mul_f32 v[168:169], v[168:169], v[182:183] op_sel_hi:[1,0]
    v_cvt_pk_bf16_f32 v168, v168, v169
    v_cvt_pk_bf16_f32 v169, v170, v171
    ds_write_b64 v135, v[172:173] offset:18688
    v_accvgpr_read_b32 v172, a212
    v_accvgpr_read_b32 v173, a213
    v_pk_mul_f32 v[172:173], v[172:173], v[182:183] op_sel_hi:[1,0]
    v_cvt_pk_bf16_f32 v172, v172, v173
    v_cvt_pk_bf16_f32 v173, v174, v175
    s_waitcnt lgkmcnt(8)
    buffer_store_dwordx4 v[160:163], v139, s[24:27], s41 offen offset:3072 nt
    s_waitcnt lgkmcnt(3)
    buffer_store_dwordx4 v[196:199], v139, s[24:27], s41 offen offset:128 nt
    s_waitcnt lgkmcnt(2)
    buffer_store_dwordx4 v[192:195], v139, s[24:27], s41 offen offset:3200 nt
    ds_write_b64 v136, v[168:169] offset:18688
    ds_write_b64 v137, v[172:173] offset:18688
    ds_read_b128 v[88:91], v138 offset:18688
    ds_read_b128 v[92:95], v138 offset:21760
    s_waitcnt lgkmcnt(1)
    buffer_store_dwordx4 v[88:91], v139, s[24:27], s58 offen offset:2304 nt
    s_waitcnt lgkmcnt(0)
    buffer_store_dwordx4 v[92:95], v139, s[24:27], s59 offen offset:1280 nt
    s_endpgm
L_tailA:
    ds_read_b64_tr_b16 a[0:1], v239
    ds_read_b64_tr_b16 a[2:3], v239 offset:6144
    ds_read_b64_tr_b16 a[4:5], v240
    ds_read_b64_tr_b16 a[6:7], v240 offset:6144
    ds_read_b64_tr_b16 a[8:9], v241
    ds_read_b64_tr_b16 a[10:11], v241 offset:6144
    ds_read_b64_tr_b16 a[12:13], v242
    ds_read_b64_tr_b16 a[14:15], v242 offset:6144
    v_mov_b32 v161, v232
    v_mbcnt_lo_u32_b32 v128, -1, 0
    v_mbcnt_hi_u32_b32 v128, -1, v128
    v_permlane16_swap_b32 v232, v161
    v_add_f32 v232, v232, v161
    v_mov_b32 v161, v232
    v_and_b32 v129, 15, v128
    v_lshrrev_b32 v130, 4, v128
    v_and_b32 v133, 7, v129
    v_lshrrev_b32 v131, 1, v130
    v_permlane32_swap_b32 v232, v161
    v_mul_u32_u24 v142, 0x180, v129
    v_xor_b32 v133, v133, v131
    v_add_f32 v232, v232, v161
    v_lshl_add_u32 v132, v133, 4, v142
    v_rcp_f32 v160, v232
    v_and_b32 v133, 1, v130
    s_mul_i32 s40, s32, 0x6000
    v_lshl_add_u32 v132, v133, 3, v132
    v_lshrrev_b32 v131, 3, v128
    s_waitcnt lgkmcnt(6)
    v_mfma_f32_16x16x32_bf16 v[0:3], a[0:3], v[184:187], v[0:3]
    s_waitcnt lgkmcnt(4)
    s_mov_b32 s54, 0
    ds_read_b64_tr_b16 a[16:17], v239 offset:1024
    ds_read_b64_tr_b16 a[18:19], v239 offset:7168
    v_mfma_f32_16x16x32_bf16 v[4:7], a[4:7], v[184:187], v[4:7]
    s_waitcnt lgkmcnt(4)
    ds_read_b64_tr_b16 a[20:21], v240 offset:1024
    ds_read_b64_tr_b16 a[22:23], v240 offset:7168
    v_mfma_f32_16x16x32_bf16 v[8:11], a[8:11], v[184:187], v[8:11]
    s_waitcnt lgkmcnt(4)
    ds_read_b64_tr_b16 a[24:25], v241 offset:1024
    ds_read_b64_tr_b16 a[26:27], v241 offset:7168
    v_mfma_f32_16x16x32_bf16 v[12:15], a[12:15], v[184:187], v[12:15]
    ds_read_b64_tr_b16 a[28:29], v242 offset:1024
    ds_read_b64_tr_b16 a[30:31], v242 offset:7168
    v_add_u32_e64 v134, s40, v132
    v_mul_u32_u24 v133, 0x180, v131
    v_and_b32 v132, 7, v128
    v_add_u32 v133, s40, v133
    v_pk_mul_f32 v[0:1], v[0:1], v[160:161] op_sel_hi:[1,0]
    v_pk_mul_f32 v[4:5], v[4:5], v[160:161] op_sel_hi:[1,0]
    v_pk_mul_f32 v[8:9], v[8:9], v[160:161] op_sel_hi:[1,0]
    v_pk_mul_f32 v[12:13], v[12:13], v[160:161] op_sel_hi:[1,0]
    v_lshl_add_u32 v139, v132, 4, v133
    v_pk_mul_f32 v[2:3], v[2:3], v[160:161] op_sel_hi:[1,0]
    v_cvt_pk_bf16_f32 v0, v0, v1
    v_pk_mul_f32 v[6:7], v[6:7], v[160:161] op_sel_hi:[1,0]
    v_cvt_pk_bf16_f32 v4, v4, v5
    v_pk_mul_f32 v[10:11], v[10:11], v[160:161] op_sel_hi:[1,0]
    v_cvt_pk_bf16_f32 v8, v8, v9
    v_pk_mul_f32 v[14:15], v[14:15], v[160:161] op_sel_hi:[1,0]
    v_cvt_pk_bf16_f32 v12, v12, v13
    v_xor_b32 v135, 32, v134
    v_xor_b32 v136, 64, v134
    v_xor_b32 v137, 0x60, v134
    v_xor_b32_e64 v132, v132, v131
    v_cvt_pk_bf16_f32 v1, v2, v3
    v_cvt_pk_bf16_f32 v5, v6, v7
    v_cvt_pk_bf16_f32 v9, v10, v11
    v_cvt_pk_bf16_f32 v13, v14, v15
    v_lshl_add_u32 v138, v132, 4, v133
    s_waitcnt lgkmcnt(6)
    v_mfma_f32_16x16x32_bf16 v[16:19], a[16:19], v[184:187], v[16:19]
    s_waitcnt lgkmcnt(4)
    ds_write_b64 v134, v[0:1]
    v_mfma_f32_16x16x32_bf16 v[20:23], a[20:23], v[184:187], v[20:23]
    s_waitcnt lgkmcnt(3)
    ds_read_b64_tr_b16 a[32:33], v239 offset:2048
    ds_read_b64_tr_b16 a[34:35], v239 offset:8192
    v_mfma_f32_16x16x32_bf16 v[24:27], a[24:27], v[184:187], v[24:27]
    s_waitcnt lgkmcnt(3)
    ds_write_b64 v135, v[4:5]
    v_mfma_f32_16x16x32_bf16 v[28:31], a[28:31], v[184:187], v[28:31]
    ds_read_b64_tr_b16 a[36:37], v240 offset:2048
    ds_read_b64_tr_b16 a[38:39], v240 offset:8192
    ds_read_b64_tr_b16 a[40:41], v241 offset:2048
    ds_write_b64 v136, v[8:9]
    ds_read_b64_tr_b16 a[42:43], v241 offset:8192
    ds_read_b64_tr_b16 a[44:45], v242 offset:2048
    ds_read_b64_tr_b16 a[46:47], v242 offset:8192
    v_pk_mul_f32 v[16:17], v[16:17], v[160:161] op_sel_hi:[1,0]
    v_pk_mul_f32 v[20:21], v[20:21], v[160:161] op_sel_hi:[1,0]
    v_pk_mul_f32 v[24:25], v[24:25], v[160:161] op_sel_hi:[1,0]
    v_pk_mul_f32 v[28:29], v[28:29], v[160:161] op_sel_hi:[1,0]
    v_pk_mul_f32 v[18:19], v[18:19], v[160:161] op_sel_hi:[1,0]
    v_cvt_pk_bf16_f32 v16, v16, v17
    v_pk_mul_f32 v[22:23], v[22:23], v[160:161] op_sel_hi:[1,0]
    v_cvt_pk_bf16_f32 v20, v20, v21
    v_pk_mul_f32 v[26:27], v[26:27], v[160:161] op_sel_hi:[1,0]
    v_cvt_pk_bf16_f32 v24, v24, v25
    v_pk_mul_f32 v[30:31], v[30:31], v[160:161] op_sel_hi:[1,0]
    v_cvt_pk_bf16_f32 v28, v28, v29
    v_cvt_pk_bf16_f32 v17, v18, v19
    v_cvt_pk_bf16_f32 v21, v22, v23
    v_cvt_pk_bf16_f32 v25, v26, v27
    v_cvt_pk_bf16_f32 v29, v30, v31
    s_waitcnt lgkmcnt(8)
    v_mfma_f32_16x16x32_bf16 v[32:35], a[32:35], v[184:187], v[32:35]
    s_waitcnt lgkmcnt(5)
    ds_write_b64 v137, v[12:13]
    ds_read_b128 v[0:3], v138
    ds_read_b128 v[4:7], v138 offset:3072
    v_mfma_f32_16x16x32_bf16 v[36:39], a[36:39], v[184:187], v[36:39]
    s_waitcnt lgkmcnt(5)
    s_mov_b32 s55, 0x1000
    v_mov_b32 v163, v233
    v_mfma_f32_16x16x32_bf16 v[40:43], a[40:43], v[184:187], v[40:43]
    s_waitcnt lgkmcnt(3)
    ds_write_b64 v134, v[16:17] offset:128
    v_mfma_f32_16x16x32_bf16 v[44:47], a[44:47], v[184:187], v[44:47]
    v_permlane16_swap_b32 v233, v163
    v_mfma_f32_16x16x32_bf16 v[48:51], a[0:3], v[188:191], v[48:51]
    ds_write_b64 v135, v[20:21] offset:128
    v_pk_mul_f32 v[32:33], v[32:33], v[160:161] op_sel_hi:[1,0]
    v_pk_mul_f32 v[36:37], v[36:37], v[160:161] op_sel_hi:[1,0]
    v_pk_mul_f32 v[40:41], v[40:41], v[160:161] op_sel_hi:[1,0]
    s_nop 1
    v_pk_mul_f32 v[44:45], v[44:45], v[160:161] op_sel_hi:[1,0]
    v_pk_mul_f32 v[34:35], v[34:35], v[160:161] op_sel_hi:[1,0]
    v_cvt_pk_bf16_f32 v32, v32, v33
    v_pk_mul_f32 v[38:39], v[38:39], v[160:161] op_sel_hi:[1,0]
    v_cvt_pk_bf16_f32 v36, v36, v37
    v_pk_mul_f32 v[42:43], v[42:43], v[160:161] op_sel_hi:[1,0]
    v_cvt_pk_bf16_f32 v40, v40, v41
    v_pk_mul_f32 v[46:47], v[46:47], v[160:161] op_sel_hi:[1,0]
    v_cvt_pk_bf16_f32 v44, v44, v45
    v_cvt_pk_bf16_f32 v33, v34, v35
    v_cvt_pk_bf16_f32 v37, v38, v39
    v_cvt_pk_bf16_f32 v41, v42, v43
    v_cvt_pk_bf16_f32 v45, v46, v47
    v_mfma_f32_16x16x32_bf16 v[52:55], a[4:7], v[188:191], v[52:55]
    s_waitcnt lgkmcnt(3)
    buffer_store_dwordx4 v[0:3], v139, s[24:27], s54 offen nt
    ds_write_b64 v136, v[24:25] offset:128
    s_waitcnt lgkmcnt(3)
    buffer_store_dwordx4 v[4:7], v139, s[24:27], s54 offen offset:3072 nt
    ds_write_b64 v137, v[28:29] offset:128
    ds_read_b128 v[16:19], v138 offset:128
    ds_read_b128 v[20:23], v138 offset:3200
    v_mfma_f32_16x16x32_bf16 v[56:59], a[8:11], v[188:191], v[56:59]
    v_add_f32 v233, v233, v163
    v_mov_b32_e64 v163, v233
    v_mfma_f32_16x16x32_bf16 v[60:63], a[12:15], v[188:191], v[60:63]
    ds_write_b64 v134, v[32:33] offset:256
    v_permlane32_swap_b32 v233, v163
    v_add_f32 v233, v233, v163
    v_rcp_f32_e64 v162, v233
    v_mfma_f32_16x16x32_bf16 v[64:67], a[16:19], v[188:191], v[64:67]
    ds_write_b64 v135, v[36:37] offset:256
    v_pk_mul_f32 v[48:49], v[48:49], v[162:163] op_sel_hi:[1,0]
    v_pk_mul_f32 v[52:53], v[52:53], v[162:163] op_sel_hi:[1,0]
    v_pk_mul_f32 v[56:57], v[56:57], v[162:163] op_sel_hi:[1,0]
    v_pk_mul_f32 v[60:61], v[60:61], v[162:163] op_sel_hi:[1,0]
    v_pk_mul_f32 v[50:51], v[50:51], v[162:163] op_sel_hi:[1,0]
    v_cvt_pk_bf16_f32 v48, v48, v49
    v_pk_mul_f32 v[54:55], v[54:55], v[162:163] op_sel_hi:[1,0]
    v_cvt_pk_bf16_f32 v52, v52, v53
    v_pk_mul_f32 v[58:59], v[58:59], v[162:163] op_sel_hi:[1,0]
    v_cvt_pk_bf16_f32 v56, v56, v57
    v_pk_mul_f32 v[62:63], v[62:63], v[162:163] op_sel_hi:[1,0]
    v_cvt_pk_bf16_f32 v60, v60, v61
    v_cvt_pk_bf16_f32 v49, v50, v51
    v_cvt_pk_bf16_f32 v53, v54, v55
    v_cvt_pk_bf16_f32 v57, v58, v59
    v_cvt_pk_bf16_f32 v61, v62, v63
    v_mfma_f32_16x16x32_bf16 v[68:71], a[20:23], v[188:191], v[68:71]
    s_waitcnt lgkmcnt(3)
    buffer_store_dwordx4 v[16:19], v139, s[24:27], s54 offen offset:128 nt
    ds_write_b64 v136, v[40:41] offset:256
    s_waitcnt lgkmcnt(3)
    buffer_store_dwordx4 v[20:23], v139, s[24:27], s54 offen offset:3200 nt
    ds_write_b64 v137, v[44:45] offset:256
    ds_read_b128 v[32:35], v138 offset:256
    ds_read_b128 v[36:39], v138 offset:3328
    v_mfma_f32_16x16x32_bf16 v[72:75], a[24:27], v[188:191], v[72:75]
    s_mov_b32 s56, 0x2000
    v_exp_f32_e64 v249, v148
    v_mfma_f32_16x16x32_bf16 v[76:79], a[28:31], v[188:191], v[76:79]
    ds_write_b64 v134, v[48:49] offset:6144
    v_pk_mul_f32 v[64:65], v[64:65], v[162:163] op_sel_hi:[1,0]
    v_pk_mul_f32 v[68:69], v[68:69], v[162:163] op_sel_hi:[1,0]
    s_nop 1
    v_pk_mul_f32 v[72:73], v[72:73], v[162:163] op_sel_hi:[1,0]
    v_pk_mul_f32 v[66:67], v[66:67], v[162:163] op_sel_hi:[1,0]
    v_cvt_pk_bf16_f32 v64, v64, v65
    v_pk_mul_f32 v[70:71], v[70:71], v[162:163] op_sel_hi:[1,0]
    v_pk_mul_f32 v[76:77], v[76:77], v[162:163] op_sel_hi:[1,0]
    v_cvt_pk_bf16_f32 v68, v68, v69
    v_pk_mul_f32 v[74:75], v[74:75], v[162:163] op_sel_hi:[1,0]
    v_cvt_pk_bf16_f32 v72, v72, v73
    v_pk_mul_f32 v[78:79], v[78:79], v[162:163] op_sel_hi:[1,0]
    v_cvt_pk_bf16_f32 v76, v76, v77
    v_cvt_pk_bf16_f32 v65, v66, v67
    v_cvt_pk_bf16_f32 v69, v70, v71
    v_cvt_pk_bf16_f32 v73, v74, v75
    v_cvt_pk_bf16_f32 v77, v78, v79
    v_exp_f32 v250, v149
    v_exp_f32_e64 v251, v150
    v_mfma_f32_16x16x32_bf16 v[80:83], a[32:35], v[188:191], v[80:83]
    s_waitcnt lgkmcnt(2)
    buffer_store_dwordx4 v[32:35], v139, s[24:27], s54 offen offset:256 nt
    ds_write_b64 v135, v[52:53] offset:6144
    s_waitcnt lgkmcnt(2)
    buffer_store_dwordx4 v[36:39], v139, s[24:27], s54 offen offset:3328 nt
    ds_write_b64 v136, v[56:57] offset:6144
    v_mfma_f32_16x16x32_bf16 v[84:87], a[36:39], v[188:191], v[84:87]
    v_exp_f32_e64 v252, v151
    v_mfma_f32_16x16x32_bf16 v[88:91], a[40:43], v[188:191], v[88:91]
    ds_write_b64 v137, v[60:61] offset:6144
    ds_read_b128 v[48:51], v138 offset:6144
    ds_read_b128 v[52:55], v138 offset:9216
    v_mfma_f32_16x16x32_bf16 v[92:95], a[44:47], v[188:191], v[92:95]
    v_add_f32 v247, v247, v249
    v_add_f32 v247, v247, v250
    v_cvt_pk_bf16_f32 v210, v249, v250
    v_exp_f32 v253, v168
    v_exp_f32 v248, v169
    v_add_f32 v247, v247, v251
    v_exp_f32 v249, v170
    v_add_f32_e64 v247, v247, v252
    v_cvt_pk_bf16_f32 v211, v251, v252
    v_exp_f32 v250, v171
    v_exp_f32 v251, v172
    v_exp_f32 v252, v173
    v_add_f32 v245, v253, v248
    v_cvt_pk_bf16_f32 v200, v253, v248
    v_add_f32 v245, v245, v249
    v_exp_f32 v253, v174
    v_exp_f32 v248, v175
    v_add_f32 v245, v245, v250
    v_cvt_pk_bf16_f32 v201, v249, v250
    v_add_f32_e64 v245, v245, v251
    v_cvt_pk_bf16_f32 v202, v251, v252
    v_exp_f32 v249, v176
    v_exp_f32 v250, v177
    v_add_f32 v245, v245, v252
    v_exp_f32 v251, v178
    v_pk_mul_f32 v[80:81], v[80:81], v[162:163] op_sel_hi:[1,0]
    v_pk_mul_f32 v[84:85], v[84:85], v[162:163] op_sel_hi:[1,0]
    v_pk_mul_f32 v[88:89], v[88:89], v[162:163] op_sel_hi:[1,0]
    v_pk_mul_f32 v[92:93], v[92:93], v[162:163] op_sel_hi:[1,0]
    v_add_f32_e64 v245, v245, v253
    v_cvt_pk_bf16_f32 v203, v253, v248
    v_exp_f32_e64 v252, v179
    v_pk_mul_f32 v[82:83], v[82:83], v[162:163] op_sel_hi:[1,0]
    v_cvt_pk_bf16_f32 v80, v80, v81
    v_pk_mul_f32 v[86:87], v[86:87], v[162:163] op_sel_hi:[1,0]
    v_cvt_pk_bf16_f32 v84, v84, v85
    v_pk_mul_f32 v[90:91], v[90:91], v[162:163] op_sel_hi:[1,0]
    v_cvt_pk_bf16_f32 v88, v88, v89
    v_pk_mul_f32 v[94:95], v[94:95], v[162:163] op_sel_hi:[1,0]
    v_cvt_pk_bf16_f32 v92, v92, v93
    v_add_f32 v245, v245, v248
    v_exp_f32 v253, v180
    v_cvt_pk_bf16_f32 v81, v82, v83
    v_cvt_pk_bf16_f32 v85, v86, v87
    v_cvt_pk_bf16_f32 v89, v90, v91
    v_cvt_pk_bf16_f32 v93, v94, v95
    v_add_f32_e64 v246, v249, v250
    v_cvt_pk_bf16_f32 v204, v249, v250
    v_exp_f32 v248, v181
    v_add_f32 v246, v246, v251
    v_exp_f32 v249, v182
    v_add_f32 v246, v246, v252
    v_exp_f32 v250, v183
    v_add_f32 v246, v246, v253
    v_add_f32 v246, v246, v248
    v_add_f32 v246, v246, v249
    v_cvt_pk_bf16_f32 v205, v251, v252
    v_add_f32_e64 v246, v246, v250
    v_max3_f32 v251, v245, v246, v247
    v_cmp_lt_f32_e64 vcc, s33, v251
    v_cvt_pk_bf16_f32 v206, v253, v248
    v_cvt_pk_bf16_f32 v207, v249, v250
    s_lshr_b32 s41, s32, 1
    s_waitcnt lgkmcnt(1)
    buffer_store_dwordx4 v[48:51], v139, s[24:27], s55 offen offset:2048 nt
    ds_write_b64 v134, v[64:65] offset:6272
    s_waitcnt lgkmcnt(1)
    buffer_store_dwordx4 v[52:55], v139, s[24:27], s56 offen offset:1024 nt
    ds_write_b64 v135, v[68:69] offset:6272
    s_cbranch_vccnz L_slowTA
L_retTA:
    v_add_f32 v234, v234, v245
    v_mov_b32 v165, v234
    v_mfma_f32_16x16x32_bf16 v[96:99], a[0:3], v[200:203], v[96:99]
    ds_write_b64 v136, v[72:73] offset:6272
    v_permlane16_swap_b32 v234, v165
    v_mfma_f32_16x16x32_bf16 v[100:103], a[4:7], v[200:203], v[100:103]
    s_mov_b32 s57, 0x3000
    ds_write_b64 v137, v[76:77] offset:6272
    ds_read_b128 v[64:67], v138 offset:6272
    ds_read_b128 v[68:71], v138 offset:9344
    v_mfma_f32_16x16x32_bf16 v[104:107], a[8:11], v[200:203], v[104:107]
    s_mul_i32 s42, s41, 0x9000
    v_add_f32 v234, v234, v165
    v_mov_b32_e64 v165, v234
    v_mfma_f32_16x16x32_bf16 v[108:111], a[12:15], v[200:203], v[108:111]
    ds_write_b64 v134, v[80:81] offset:6400
    v_permlane32_swap_b32 v234, v165
    v_add_f32 v234, v234, v165
    v_rcp_f32_e64 v164, v234
    v_mfma_f32_16x16x32_bf16 v[112:115], a[16:19], v[200:203], v[112:115]
    ds_write_b64 v135, v[84:85] offset:6400
    v_pk_mul_f32 v[96:97], v[96:97], v[164:165] op_sel_hi:[1,0]
    v_pk_mul_f32 v[100:101], v[100:101], v[164:165] op_sel_hi:[1,0]
    v_pk_mul_f32 v[104:105], v[104:105], v[164:165] op_sel_hi:[1,0]
    v_pk_mul_f32 v[108:109], v[108:109], v[164:165] op_sel_hi:[1,0]
    v_pk_mul_f32 v[98:99], v[98:99], v[164:165] op_sel_hi:[1,0]
    v_cvt_pk_bf16_f32 v96, v96, v97
    v_pk_mul_f32 v[102:103], v[102:103], v[164:165] op_sel_hi:[1,0]
    v_cvt_pk_bf16_f32 v100, v100, v101
    v_pk_mul_f32 v[106:107], v[106:107], v[164:165] op_sel_hi:[1,0]
    v_cvt_pk_bf16_f32 v104, v104, v105
    v_pk_mul_f32 v[110:111], v[110:111], v[164:165] op_sel_hi:[1,0]
    v_cvt_pk_bf16_f32 v108, v108, v109
    v_cvt_pk_bf16_f32 v97, v98, v99
    v_cvt_pk_bf16_f32 v101, v102, v103
    v_cvt_pk_bf16_f32 v105, v106, v107
    v_cvt_pk_bf16_f32 v109, v110, v111
    v_mfma_f32_16x16x32_bf16 v[116:119], a[20:23], v[200:203], v[116:119]
    s_waitcnt lgkmcnt(3)
    buffer_store_dwordx4 v[64:67], v139, s[24:27], s55 offen offset:2176 nt
    ds_write_b64 v136, v[88:89] offset:6400
    s_waitcnt lgkmcnt(3)
    buffer_store_dwordx4 v[68:71], v139, s[24:27], s56 offen offset:1152 nt
    ds_write_b64 v137, v[92:93] offset:6400
    ds_read_b128 v[80:83], v138 offset:6400
    ds_read_b128 v[84:87], v138 offset:9472
    v_mfma_f32_16x16x32_bf16 v[120:123], a[24:27], v[200:203], v[120:123]
    s_add_u32 s42, s42, 0x18000
    v_add_f32 v236, v236, v247
    v_mov_b32 v192, v236
    v_mfma_f32_16x16x32_bf16 v[124:127], a[28:31], v[200:203], v[124:127]
    ds_write_b64 v134, v[96:97] offset:12288
    v_mfma_f32_16x16x32_bf16 a[120:123], a[0:3], v[208:211], a[120:123]
    v_permlane16_swap_b32 v236, v192
    v_mfma_f32_16x16x32_bf16 a[124:127], a[4:7], v[208:211], a[124:127]
    ds_write_b64 v135, v[100:101] offset:12288
    v_mfma_f32_16x16x32_bf16 a[128:131], a[8:11], v[208:211], a[128:131]
    v_add_f32 v236, v236, v192
    v_mov_b32_e64 v192, v236
    v_mfma_f32_16x16x32_bf16 a[132:135], a[12:15], v[208:211], a[132:135]
    ds_write_b64 v136, v[104:105] offset:12288
    v_mfma_f32_16x16x32_bf16 a[136:139], a[16:19], v[208:211], a[136:139]
    s_waitcnt lgkmcnt(4)
    buffer_store_dwordx4 v[80:83], v139, s[24:27], s55 offen offset:2304 nt
    ds_write_b64 v137, v[108:109] offset:12288
    ds_read_b128 v[8:11], v138 offset:12288
    s_waitcnt lgkmcnt(5)
    buffer_store_dwordx4 v[84:87], v139, s[24:27], s56 offen offset:1280 nt
    ds_read_b128 v[12:15], v138 offset:15360
    v_mfma_f32_16x16x32_bf16 a[140:143], a[20:23], v[208:211], a[140:143]
    v_lshl_add_u32 v140, v128, 4, s42
    s_lshl_b32 s42, s41, 8
    v_mfma_f32_16x16x32_bf16 a[144:147], a[24:27], v[208:211], a[144:147]
    s_add_u32 s42, s42, 0x27000
    v_permlane32_swap_b32 v236, v192
    v_mfma_f32_16x16x32_bf16 a[148:151], a[28:31], v[208:211], a[148:151]
    v_add_f32_e64 v236, v236, v192
    v_lshl_add_u32 v141, v129, 3, s42
    v_mov_b32_e64 v192, v228
    v_pk_mul_f32 v[112:113], v[112:113], v[164:165] op_sel_hi:[1,0]
    v_pk_mul_f32 v[116:117], v[116:117], v[164:165] op_sel_hi:[1,0]
    v_pk_mul_f32 v[120:121], v[120:121], v[164:165] op_sel_hi:[1,0]
    v_pk_mul_f32 v[124:125], v[124:125], v[164:165] op_sel_hi:[1,0]
    v_pk_mul_f32 v[114:115], v[114:115], v[164:165] op_sel_hi:[1,0]
    v_cvt_pk_bf16_f32 v112, v112, v113
    v_pk_mul_f32 v[118:119], v[118:119], v[164:165] op_sel_hi:[1,0]
    v_cvt_pk_bf16_f32 v116, v116, v117
    v_pk_mul_f32 v[122:123], v[122:123], v[164:165] op_sel_hi:[1,0]
    v_cvt_pk_bf16_f32 v120, v120, v121
    v_pk_mul_f32 v[126:127], v[126:127], v[164:165] op_sel_hi:[1,0]
    v_cvt_pk_bf16_f32 v124, v124, v125
    v_cvt_pk_bf16_f32 v113, v114, v115
    v_cvt_pk_bf16_f32 v117, v118, v119
    v_cvt_pk_bf16_f32 v121, v122, v123
    v_cvt_pk_bf16_f32 v125, v126, v127
    v_mov_b32_e64 v193, v236
    v_mfma_f32_16x16x32_bf16 a[216:219], a[32:35], v[200:203], a[216:219]
    s_waitcnt lgkmcnt(1)
    buffer_store_dwordx4 v[8:11], v139, s[24:27], s57 offen nt
    ds_write_b64 v134, v[112:113] offset:12416
    v_mfma_f32_16x16x32_bf16 a[220:223], a[36:39], v[200:203], a[220:223]
    s_waitcnt lgkmcnt(1)
    buffer_store_dwordx4 v[12:15], v139, s[24:27], s57 offen offset:3072 nt
    ds_write_b64 v135, v[116:117] offset:12416
    v_mfma_f32_16x16x32_bf16 a[224:227], a[40:43], v[200:203], a[224:227]
    v_accvgpr_read_b32 v152, a216
    v_accvgpr_read_b32 v153, a217
    v_mfma_f32_16x16x32_bf16 a[228:231], a[44:47], v[200:203], a[228:231]
    ds_write_b64 v136, v[120:121] offset:12416
    v_accvgpr_read_b32 v156, a220
    v_accvgpr_read_b32 v157, a221
    v_accvgpr_read_b32 v154, a218
    v_accvgpr_read_b32 v155, a219
    v_pk_mul_f32 v[152:153], v[152:153], v[164:165] op_sel_hi:[1,0]
    v_accvgpr_read_b32 v158, a222
    v_accvgpr_read_b32 v159, a223
    v_pk_mul_f32 v[156:157], v[156:157], v[164:165] op_sel_hi:[1,0]
    v_pk_mul_f32 v[154:155], v[154:155], v[164:165] op_sel_hi:[1,0]
    v_cvt_pk_bf16_f32 v152, v152, v153
    v_pk_mul_f32 v[158:159], v[158:159], v[164:165] op_sel_hi:[1,0]
    v_cvt_pk_bf16_f32 v156, v156, v157
    v_cvt_pk_bf16_f32 v153, v154, v155
    v_cvt_pk_bf16_f32 v157, v158, v159
    v_accvgpr_read_b32 v154, a226
    v_accvgpr_read_b32 v155, a227
    v_accvgpr_read_b32 v158, a230
    v_accvgpr_read_b32 v159, a231
    v_pk_mul_f32 v[154:155], v[154:155], v[164:165] op_sel_hi:[1,0]
    v_pk_mul_f32 v[158:159], v[158:159], v[164:165] op_sel_hi:[1,0]
    v_add_f32 v235, v235, v246
    v_mov_b32 v167, v235
    v_mfma_f32_16x16x32_bf16 a[168:171], a[0:3], v[204:207], a[168:171]
    ds_write_b64 v137, v[124:125] offset:12416
    ds_read_b128 v[24:27], v138 offset:12416
    ds_read_b128 v[28:31], v138 offset:15488
    v_mfma_f32_16x16x32_bf16 a[172:175], a[4:7], v[204:207], a[172:175]
    s_mov_b32 s58, 0x4000
    v_permlane16_swap_b32 v235, v167
    v_add_f32 v235, v235, v167
    v_mov_b32_e64 v167, v235
    v_mfma_f32_16x16x32_bf16 a[176:179], a[8:11], v[204:207], a[176:179]
    ds_write_b128 v140, a[120:123]
    v_mfma_f32_16x16x32_bf16 a[180:183], a[12:15], v[204:207], a[180:183]
    v_permlane32_swap_b32 v235, v167
    v_add_f32 v235, v235, v167
    v_rcp_f32_e64 v166, v235
    v_mfma_f32_16x16x32_bf16 a[184:187], a[16:19], v[204:207], a[184:187]
    ds_write_b128 v140, a[124:127] offset:1024
    v_mfma_f32_16x16x32_bf16 a[188:191], a[20:23], v[204:207], a[188:191]
    s_waitcnt lgkmcnt(3)
    buffer_store_dwordx4 v[24:27], v139, s[24:27], s57 offen offset:128 nt
    ds_write_b128 v140, a[128:131] offset:2048
    s_waitcnt lgkmcnt(3)
    buffer_store_dwordx4 v[28:31], v139, s[24:27], s57 offen offset:3200 nt
    v_mfma_f32_16x16x32_bf16 a[152:155], a[32:35], v[208:211], a[152:155]
    ds_write_b128 v140, a[132:135] offset:3072
    v_mfma_f32_16x16x32_bf16 a[156:159], a[36:39], v[208:211], a[156:159]
    s_mov_b32 s59, 0x5000
    s_mul_i32 s41, s41, 0x1800
    s_add_u32 s41, s41, 0x18000
    v_mfma_f32_16x16x32_bf16 a[160:163], a[40:43], v[208:211], a[160:163]
    s_sub_u32 s41, s41, s40
    s_nop 0
    v_accvgpr_read_b32 v248, a152
    v_accvgpr_read_b32 v249, a153
    v_mfma_f32_16x16x32_bf16 a[192:195], a[24:27], v[204:207], a[192:195]
    ds_write_b128 v140, a[136:139] offset:4096
    v_mfma_f32_16x16x32_bf16 a[196:199], a[28:31], v[204:207], a[196:199]
    v_accvgpr_read_b32 v250, a154
    v_accvgpr_read_b32 v251, a155
    v_mfma_f32_16x16x32_bf16 a[164:167], a[44:47], v[208:211], a[164:167]
    v_accvgpr_read_b32 v252, a156
    v_accvgpr_read_b32 v253, a157
    ds_write_b128 v140, a[140:143] offset:5120
    v_mfma_f32_16x16x32_bf16 a[200:203], a[32:35], v[204:207], a[200:203]
    v_mfma_f32_16x16x32_bf16 a[204:207], a[36:39], v[204:207], a[204:207]
    ds_write_b128 v140, a[144:147] offset:6144
    v_mfma_f32_16x16x32_bf16 a[208:211], a[40:43], v[204:207], a[208:211]
    v_mfma_f32_16x16x32_bf16 a[212:215], a[44:47], v[204:207], a[212:215]
    ds_write_b128 v140, a[148:151] offset:7168
    ds_write_b64 v141, v[192:193] offset:128
    ds_write_b64 v134, v[152:153] offset:12544
    v_accvgpr_read_b32 v152, a224
    v_accvgpr_read_b32 v153, a225
    v_pk_mul_f32 v[152:153], v[152:153], v[164:165] op_sel_hi:[1,0]
    v_cvt_pk_bf16_f32 v152, v152, v153
    v_cvt_pk_bf16_f32 v153, v154, v155
    v_accvgpr_read_b32 v154, a170
    v_accvgpr_read_b32 v155, a171
    v_pk_mul_f32 v[154:155], v[154:155], v[166:167] op_sel_hi:[1,0]
    ds_write_b64 v135, v[156:157] offset:12544
    v_accvgpr_read_b32 v156, a228
    v_accvgpr_read_b32 v157, a229
    v_pk_mul_f32 v[156:157], v[156:157], v[164:165] op_sel_hi:[1,0]
    v_cvt_pk_bf16_f32 v156, v156, v157
    v_cvt_pk_bf16_f32 v157, v158, v159
    v_accvgpr_read_b32 v158, a174
    v_accvgpr_read_b32 v159, a175
    v_pk_mul_f32 v[158:159], v[158:159], v[166:167] op_sel_hi:[1,0]
    ds_write_b64 v136, v[152:153] offset:12544
    v_accvgpr_read_b32 v152, a168
    v_accvgpr_read_b32 v153, a169
    v_pk_mul_f32 v[152:153], v[152:153], v[166:167] op_sel_hi:[1,0]
    s_waitcnt lgkmcnt(3)
    s_barrier
    v_cvt_pk_bf16_f32 v152, v152, v153
    v_cvt_pk_bf16_f32 v153, v154, v155
    v_accvgpr_read_b32 v154, a178
    v_accvgpr_read_b32 v155, a179
    v_pk_mul_f32 v[154:155], v[154:155], v[166:167] op_sel_hi:[1,0]
    ds_write_b64 v137, v[156:157] offset:12544
    ds_read_b128 v[40:43], v138 offset:12544
    ds_read_b64 v[194:195], v141
    ds_read_b128 v[44:47], v138 offset:15616
    v_accvgpr_read_b32 v156, a172
    v_accvgpr_read_b32 v157, a173
    v_pk_mul_f32 v[156:157], v[156:157], v[166:167] op_sel_hi:[1,0]
    v_cvt_pk_bf16_f32 v156, v156, v157
    v_cvt_pk_bf16_f32 v157, v158, v159
    v_accvgpr_read_b32 v158, a182
    v_accvgpr_read_b32 v159, a183
    v_pk_mul_f32 v[158:159], v[158:159], v[166:167] op_sel_hi:[1,0]
    ds_read_b128 v[168:171], v140 offset:8192
    ds_write_b64 v134, v[152:153] offset:18432
    v_accvgpr_read_b32 v152, a176
    v_accvgpr_read_b32 v153, a177
    v_pk_mul_f32 v[152:153], v[152:153], v[166:167] op_sel_hi:[1,0]
    v_cvt_pk_bf16_f32 v152, v152, v153
    v_cvt_pk_bf16_f32 v153, v154, v155
    v_accvgpr_read_b32 v154, a186
    v_accvgpr_read_b32 v155, a187
    v_pk_mul_f32 v[154:155], v[154:155], v[166:167] op_sel_hi:[1,0]
    ds_write_b64 v135, v[156:157] offset:18432
    v_accvgpr_read_b32 v156, a180
    v_accvgpr_read_b32 v157, a181
    v_pk_mul_f32 v[156:157], v[156:157], v[166:167] op_sel_hi:[1,0]
    v_cvt_pk_bf16_f32 v156, v156, v157
    v_cvt_pk_bf16_f32 v157, v158, v159
    s_waitcnt lgkmcnt(4)
    v_min_f32 v197, v192, v194
    v_sub_f32 v196, v197, v192
    v_sub_f32 v198, v197, v194
    v_exp_f32 v196, v196
    v_exp_f32 v198, v198
    v_mul_f32_e64 v199, v196, v193
    v_accvgpr_read_b32 v158, a190
    v_fma_f32 v199, v198, v195, v199
    v_rcp_f32_e64 v199, v199
    v_accvgpr_read_b32 v159, a191
    v_pk_mul_f32 v[158:159], v[158:159], v[166:167] op_sel_hi:[1,0]
    v_mul_f32 v198, v198, v199
    v_mul_f32 v196, v196, v199
    s_waitcnt lgkmcnt(2)
    v_pk_mul_f32 v[168:169], v[168:169], v[198:199] op_sel_hi:[1,0]
    v_pk_fma_f32 v[168:169], v[248:249], v[196:197], v[168:169] op_sel_hi:[1,0,1]
    v_pk_mul_f32 v[170:171], v[170:171], v[198:199] op_sel_hi:[1,0]
    v_pk_fma_f32 v[170:171], v[250:251], v[196:197], v[170:171] op_sel_hi:[1,0,1]
    v_accvgpr_read_b32 v248, a158
    v_accvgpr_read_b32 v249, a159
    v_accvgpr_read_b32 v250, a160
    v_accvgpr_read_b32 v251, a161
    v_cvt_pk_bf16_f32 v168, v168, v169
    v_cvt_pk_bf16_f32 v169, v170, v171
    ds_read_b128 v[172:175], v140 offset:9216
    ds_read_b128 v[176:179], v140 offset:10240
    ds_read_b128 v[180:183], v140 offset:11264
    buffer_store_dwordx4 v[40:43], v139, s[24:27], s57 offen offset:256 nt
    ds_write_b64 v136, v[152:153] offset:18432
    buffer_store_dwordx4 v[44:47], v139, s[24:27], s57 offen offset:3328 nt
    ds_write_b64 v137, v[156:157] offset:18432
    ds_read_b128 v[56:59], v138 offset:18432
    ds_read_b128 v[60:63], v138 offset:21504
    v_accvgpr_read_b32 v152, a184
    v_accvgpr_read_b32 v153, a185
    v_accvgpr_read_b32 v156, a188
    v_accvgpr_read_b32 v157, a189
    v_pk_mul_f32 v[152:153], v[152:153], v[166:167] op_sel_hi:[1,0]
    v_pk_mul_f32 v[156:157], v[156:157], v[166:167] op_sel_hi:[1,0]
    v_cvt_pk_bf16_f32 v152, v152, v153
    v_cvt_pk_bf16_f32 v156, v156, v157
    v_cvt_pk_bf16_f32 v153, v154, v155
    v_cvt_pk_bf16_f32 v157, v158, v159
    s_waitcnt lgkmcnt(6)
    v_pk_mul_f32 v[174:175], v[174:175], v[198:199] op_sel_hi:[1,0]
    v_pk_mul_f32 v[172:173], v[172:173], v[198:199] op_sel_hi:[1,0]
    v_pk_fma_f32 v[174:175], v[248:249], v[196:197], v[174:175] op_sel_hi:[1,0,1]
    s_waitcnt lgkmcnt(5)
    v_pk_mul_f32 v[176:177], v[176:177], v[198:199] op_sel_hi:[1,0]
    v_pk_fma_f32 v[172:173], v[252:253], v[196:197], v[172:173] op_sel_hi:[1,0,1]
    v_pk_fma_f32 v[176:177], v[250:251], v[196:197], v[176:177] op_sel_hi:[1,0,1]
    v_accvgpr_read_b32 v248, a164
    v_accvgpr_read_b32 v249, a165
    s_waitcnt lgkmcnt(4)
    v_pk_mul_f32 v[180:181], v[180:181], v[198:199] op_sel_hi:[1,0]
    v_accvgpr_read_b32 v154, a194
    v_accvgpr_read_b32 v155, a195
    v_accvgpr_read_b32 v158, a198
    v_accvgpr_read_b32 v159, a199
    v_accvgpr_read_b32 v252, a162
    v_accvgpr_read_b32 v253, a163
    v_pk_mul_f32 v[178:179], v[178:179], v[198:199] op_sel_hi:[1,0]
    v_pk_fma_f32 v[180:181], v[248:249], v[196:197], v[180:181] op_sel_hi:[1,0,1]
    v_accvgpr_read_b32 v250, a166
    v_accvgpr_read_b32 v251, a167
    v_pk_mul_f32 v[182:183], v[182:183], v[198:199] op_sel_hi:[1,0]
    v_pk_mul_f32 v[154:155], v[154:155], v[166:167] op_sel_hi:[1,0]
    v_pk_mul_f32 v[158:159], v[158:159], v[166:167] op_sel_hi:[1,0]
    v_cvt_pk_bf16_f32 v172, v172, v173
    v_pk_fma_f32 v[178:179], v[252:253], v[196:197], v[178:179] op_sel_hi:[1,0,1]
    v_cvt_pk_bf16_f32 v176, v176, v177
    v_pk_fma_f32 v[182:183], v[250:251], v[196:197], v[182:183] op_sel_hi:[1,0,1]
    v_cvt_pk_bf16_f32 v180, v180, v181
    v_cvt_pk_bf16_f32 v173, v174, v175
    v_cvt_pk_bf16_f32 v177, v178, v179
    v_cvt_pk_bf16_f32 v181, v182, v183
    ds_write_b64 v134, v[152:153] offset:18560
    v_accvgpr_read_b32 v152, a192
    v_accvgpr_read_b32 v153, a193
    v_pk_mul_f32 v[152:153], v[152:153], v[166:167] op_sel_hi:[1,0]
    v_cvt_pk_bf16_f32 v152, v152, v153
    v_cvt_pk_bf16_f32 v153, v154, v155
    v_accvgpr_read_b32 v154, a202
    v_accvgpr_read_b32 v155, a203
    v_pk_mul_f32 v[154:155], v[154:155], v[166:167] op_sel_hi:[1,0]
    ds_write_b64 v135, v[156:157] offset:18560
    v_accvgpr_read_b32 v156, a196
    v_accvgpr_read_b32 v157, a197
    v_pk_mul_f32 v[156:157], v[156:157], v[166:167] op_sel_hi:[1,0]
    v_cvt_pk_bf16_f32 v156, v156, v157
    v_cvt_pk_bf16_f32 v157, v158, v159
    v_accvgpr_read_b32 v158, a206
    v_accvgpr_read_b32 v159, a207
    v_pk_mul_f32 v[158:159], v[158:159], v[166:167] op_sel_hi:[1,0]
    s_waitcnt lgkmcnt(3)
    buffer_store_dwordx4 v[56:59], v139, s[24:27], s58 offen offset:2048 nt
    ds_write_b64 v136, v[152:153] offset:18560
    s_waitcnt lgkmcnt(3)
    buffer_store_dwordx4 v[60:63], v139, s[24:27], s59 offen offset:1024 nt
    ds_write_b64 v137, v[156:157] offset:18560
    ds_read_b128 v[72:75], v138 offset:18560
    ds_read_b128 v[76:79], v138 offset:21632
    v_accvgpr_read_b32 v152, a200
    v_accvgpr_read_b32 v153, a201
    v_accvgpr_read_b32 v156, a204
    v_accvgpr_read_b32 v157, a205
    v_pk_mul_f32 v[152:153], v[152:153], v[166:167] op_sel_hi:[1,0]
    v_pk_mul_f32 v[156:157], v[156:157], v[166:167] op_sel_hi:[1,0]
    v_cvt_pk_bf16_f32 v152, v152, v153
    v_cvt_pk_bf16_f32 v156, v156, v157
    v_cvt_pk_bf16_f32 v153, v154, v155
    v_cvt_pk_bf16_f32 v157, v158, v159
    v_accvgpr_read_b32 v154, a210
    v_accvgpr_read_b32 v155, a211
    v_accvgpr_read_b32 v158, a214
    v_accvgpr_read_b32 v159, a215
    v_pk_mul_f32 v[154:155], v[154:155], v[166:167] op_sel_hi:[1,0]
    v_pk_mul_f32 v[158:159], v[158:159], v[166:167] op_sel_hi:[1,0]
    ds_write_b64 v134, v[168:169] offset:256
    ds_write_b64 v135, v[172:173] offset:256
    s_waitcnt lgkmcnt(3)
    buffer_store_dwordx4 v[72:75], v139, s[24:27], s58 offen offset:2176 nt
    ds_write_b64 v136, v[176:177] offset:256
    s_waitcnt lgkmcnt(3)
    buffer_store_dwordx4 v[76:79], v139, s[24:27], s59 offen offset:1152 nt
    ds_write_b64 v137, v[180:181] offset:256
    ds_read_b128 v[180:183], v138 offset:256
    ds_read_b128 v[176:179], v138 offset:3328
    ds_write_b64 v134, v[152:153] offset:18688
    v_accvgpr_read_b32 v152, a208
    v_accvgpr_read_b32 v153, a209
    v_pk_mul_f32 v[152:153], v[152:153], v[166:167] op_sel_hi:[1,0]
    v_cvt_pk_bf16_f32 v152, v152, v153
    v_cvt_pk_bf16_f32 v153, v154, v155
    ds_write_b64 v135, v[156:157] offset:18688
    v_accvgpr_read_b32 v156, a212
    v_accvgpr_read_b32 v157, a213
    v_pk_mul_f32 v[156:157], v[156:157], v[166:167] op_sel_hi:[1,0]
    v_cvt_pk_bf16_f32 v156, v156, v157
    v_cvt_pk_bf16_f32 v157, v158, v159
    ds_write_b64 v136, v[152:153] offset:18688
    s_waitcnt lgkmcnt(4)
    buffer_store_dwordx4 v[180:183], v139, s[24:27], s41 offen offset:256 nt
    s_waitcnt lgkmcnt(3)
    buffer_store_dwordx4 v[176:179], v139, s[24:27], s41 offen offset:3328 nt
    ds_write_b64 v137, v[156:157] offset:18688
    ds_read_b128 v[88:91], v138 offset:18688
    ds_read_b128 v[92:95], v138 offset:21760
    s_waitcnt lgkmcnt(1)
    buffer_store_dwordx4 v[88:91], v139, s[24:27], s58 offen offset:2304 nt
    s_waitcnt lgkmcnt(0)
    buffer_store_dwordx4 v[92:95], v139, s[24:27], s59 offen offset:1280 nt
L_end:
    s_endpgm
L_slow1A:
    s_nop 15
    v_max3_f32 v248, v168, v169, v170
    v_max3_f32 v250, v171, v172, v173
    v_max3_f32 v248, v248, v174, v175
    v_max_f32 v248, v248, v250
    v_mov_b32 v250, v248
    s_nop 1
    v_permlane16_swap_b32 v248, v250
    v_max_f32 v248, v248, v250
    v_mov_b32 v250, v248
    s_nop 1
    v_permlane32_swap_b32 v248, v250
    v_max_f32 v248, v248, v250
    v_max_f32 v248, 0, v248
    v_sub_f32 v249, 0, v248
    v_exp_f32 v249, v249
    v_sub_f32 v220, v220, v248
    v_sub_f32 v221, v221, v248
    v_sub_f32 v222, v222, v248
    v_sub_f32 v223, v223, v248
    v_sub_f32 v168, v168, v248
    v_sub_f32 v169, v169, v248
    v_sub_f32 v170, v170, v248
    v_sub_f32 v171, v171, v248
    v_sub_f32 v172, v172, v248
    v_sub_f32 v173, v173, v248
    v_sub_f32 v174, v174, v248
    v_sub_f32 v175, v175, v248
    v_sub_f32 v152, v152, v248
    v_sub_f32 v153, v153, v248
    v_sub_f32 v154, v154, v248
    v_sub_f32 v155, v155, v248
    v_sub_f32 v156, v156, v248
    v_sub_f32 v157, v157, v248
    v_sub_f32 v158, v158, v248
    v_sub_f32 v159, v159, v248
    v_mul_f32 v234, v249, v234
    v_mul_f32 v96, v249, v96
    v_mul_f32 v97, v249, v97
    v_mul_f32 v98, v249, v98
    v_mul_f32 v99, v249, v99
    v_mul_f32 v100, v249, v100
    v_mul_f32 v101, v249, v101
    v_mul_f32 v102, v249, v102
    v_mul_f32 v103, v249, v103
    v_mul_f32 v104, v249, v104
    v_mul_f32 v105, v249, v105
    v_mul_f32 v106, v249, v106
    v_mul_f32 v107, v249, v107
    v_mul_f32 v108, v249, v108
    v_mul_f32 v109, v249, v109
    v_mul_f32 v110, v249, v110
    v_mul_f32 v111, v249, v111
    v_mul_f32 v112, v249, v112
    v_mul_f32 v113, v249, v113
    v_mul_f32 v114, v249, v114
    v_mul_f32 v115, v249, v115
    v_mul_f32 v116, v249, v116
    v_mul_f32 v117, v249, v117
    v_mul_f32 v118, v249, v118
    v_mul_f32 v119, v249, v119
    v_mul_f32 v120, v249, v120
    v_mul_f32 v121, v249, v121
    v_mul_f32 v122, v249, v122
    v_mul_f32 v123, v249, v123
    v_mul_f32 v124, v249, v124
    v_mul_f32 v125, v249, v125
    v_mul_f32 v126, v249, v126
    v_mul_f32_e64 v127, v249, v127
    v_accvgpr_read_b32 v250, a216
    v_mul_f32_e64 v250, v249, v250
    v_accvgpr_write_b32 a216, v250
    v_accvgpr_read_b32 v251, a217
    v_mul_f32_e64 v251, v249, v251
    v_accvgpr_write_b32 a217, v251
    v_accvgpr_read_b32 v250, a218
    v_mul_f32_e64 v250, v249, v250
    v_accvgpr_write_b32 a218, v250
    v_accvgpr_read_b32 v251, a219
    v_mul_f32_e64 v251, v249, v251
    v_accvgpr_write_b32 a219, v251
    v_accvgpr_read_b32 v250, a220
    v_mul_f32_e64 v250, v249, v250
    v_accvgpr_write_b32 a220, v250
    v_accvgpr_read_b32 v251, a221
    v_mul_f32_e64 v251, v249, v251
    v_accvgpr_write_b32 a221, v251
    v_accvgpr_read_b32 v250, a222
    v_mul_f32_e64 v250, v249, v250
    v_accvgpr_write_b32 a222, v250
    v_accvgpr_read_b32 v251, a223
    v_mul_f32_e64 v251, v249, v251
    v_accvgpr_write_b32 a223, v251
    v_accvgpr_read_b32 v250, a224
    v_mul_f32_e64 v250, v249, v250
    v_accvgpr_write_b32 a224, v250
    v_accvgpr_read_b32 v251, a225
    v_mul_f32_e64 v251, v249, v251
    v_accvgpr_write_b32 a225, v251
    v_accvgpr_read_b32 v250, a226
    v_mul_f32_e64 v250, v249, v250
    v_accvgpr_write_b32 a226, v250
    v_accvgpr_read_b32 v251, a227
    v_mul_f32_e64 v251, v249, v251
    v_accvgpr_write_b32 a227, v251
    v_accvgpr_read_b32 v250, a228
    v_mul_f32_e64 v250, v249, v250
    v_accvgpr_write_b32 a228, v250
    v_accvgpr_read_b32 v251, a229
    v_mul_f32_e64 v251, v249, v251
    v_accvgpr_write_b32 a229, v251
    v_accvgpr_read_b32 v250, a230
    v_mul_f32_e64 v250, v249, v250
    v_accvgpr_write_b32 a230, v250
    v_accvgpr_read_b32 v251, a231
    v_mul_f32_e64 v251, v249, v251
    v_accvgpr_write_b32 a231, v251
    v_exp_f32 v253, v168
    v_exp_f32 v248, v169
    s_nop 0
    v_add_f32 v245, v253, v248
    v_cvt_pk_bf16_f32 v200, v253, v248
    v_exp_f32 v249, v170
    v_exp_f32 v250, v171
    v_add_f32 v245, v245, v249
    v_add_f32 v245, v245, v250
    v_cvt_pk_bf16_f32 v201, v249, v250
    v_exp_f32 v251, v172
    v_exp_f32 v252, v173
    v_add_f32 v245, v245, v251
    v_add_f32 v245, v245, v252
    v_cvt_pk_bf16_f32 v202, v251, v252
    v_exp_f32 v253, v174
    v_exp_f32 v248, v175
    v_add_f32 v245, v245, v253
    v_add_f32 v245, v245, v248
    v_cvt_pk_bf16_f32 v203, v253, v248
    v_max3_f32 v248, v176, v177, v178
    v_max3_f32 v250, v179, v180, v181
    v_max3_f32 v248, v248, v182, v183
    v_max_f32 v248, v248, v250
    v_mov_b32 v250, v248
    s_nop 1
    v_permlane16_swap_b32 v248, v250
    v_max_f32 v248, v248, v250
    v_mov_b32 v250, v248
    s_nop 1
    v_permlane32_swap_b32 v248, v250
    v_max_f32 v248, v248, v250
    v_max_f32 v248, 0, v248
    v_sub_f32 v249, 0, v248
    v_exp_f32 v249, v249
    v_sub_f32 v224, v224, v248
    v_sub_f32 v225, v225, v248
    v_sub_f32 v226, v226, v248
    v_sub_f32 v227, v227, v248
    v_sub_f32 v176, v176, v248
    v_sub_f32 v177, v177, v248
    v_sub_f32 v178, v178, v248
    v_sub_f32 v179, v179, v248
    v_sub_f32 v180, v180, v248
    v_sub_f32 v181, v181, v248
    v_sub_f32 v182, v182, v248
    v_sub_f32 v183, v183, v248
    v_sub_f32 v160, v160, v248
    v_sub_f32 v161, v161, v248
    v_sub_f32 v162, v162, v248
    v_sub_f32 v163, v163, v248
    v_sub_f32 v164, v164, v248
    v_sub_f32 v165, v165, v248
    v_sub_f32 v166, v166, v248
    v_sub_f32 v167, v167, v248
    v_mul_f32_e64 v235, v249, v235
    v_accvgpr_read_b32 v250, a168
    v_mul_f32_e64 v250, v249, v250
    v_accvgpr_write_b32 a168, v250
    v_accvgpr_read_b32 v251, a169
    v_mul_f32_e64 v251, v249, v251
    v_accvgpr_write_b32 a169, v251
    v_accvgpr_read_b32 v250, a170
    v_mul_f32_e64 v250, v249, v250
    v_accvgpr_write_b32 a170, v250
    v_accvgpr_read_b32 v251, a171
    v_mul_f32_e64 v251, v249, v251
    v_accvgpr_write_b32 a171, v251
    v_accvgpr_read_b32 v250, a172
    v_mul_f32_e64 v250, v249, v250
    v_accvgpr_write_b32 a172, v250
    v_accvgpr_read_b32 v251, a173
    v_mul_f32_e64 v251, v249, v251
    v_accvgpr_write_b32 a173, v251
    v_accvgpr_read_b32 v250, a174
    v_mul_f32_e64 v250, v249, v250
    v_accvgpr_write_b32 a174, v250
    v_accvgpr_read_b32 v251, a175
    v_mul_f32_e64 v251, v249, v251
    v_accvgpr_write_b32 a175, v251
    v_accvgpr_read_b32 v250, a176
    v_mul_f32_e64 v250, v249, v250
    v_accvgpr_write_b32 a176, v250
    v_accvgpr_read_b32 v251, a177
    v_mul_f32_e64 v251, v249, v251
    v_accvgpr_write_b32 a177, v251
    v_accvgpr_read_b32 v250, a178
    v_mul_f32_e64 v250, v249, v250
    v_accvgpr_write_b32 a178, v250
    v_accvgpr_read_b32 v251, a179
    v_mul_f32_e64 v251, v249, v251
    v_accvgpr_write_b32 a179, v251
    v_accvgpr_read_b32 v250, a180
    v_mul_f32_e64 v250, v249, v250
    v_accvgpr_write_b32 a180, v250
    v_accvgpr_read_b32 v251, a181
    v_mul_f32_e64 v251, v249, v251
    v_accvgpr_write_b32 a181, v251
    v_accvgpr_read_b32 v250, a182
    v_mul_f32_e64 v250, v249, v250
    v_accvgpr_write_b32 a182, v250
    v_accvgpr_read_b32 v251, a183
    v_mul_f32_e64 v251, v249, v251
    v_accvgpr_write_b32 a183, v251
    v_accvgpr_read_b32 v250, a184
    v_mul_f32_e64 v250, v249, v250
    v_accvgpr_write_b32 a184, v250
    v_accvgpr_read_b32 v251, a185
    v_mul_f32_e64 v251, v249, v251
    v_accvgpr_write_b32 a185, v251
    v_accvgpr_read_b32 v250, a186
    v_mul_f32_e64 v250, v249, v250
    v_accvgpr_write_b32 a186, v250
    v_accvgpr_read_b32 v251, a187
    v_mul_f32_e64 v251, v249, v251
    v_accvgpr_write_b32 a187, v251
    v_accvgpr_read_b32 v250, a188
    v_mul_f32_e64 v250, v249, v250
    v_accvgpr_write_b32 a188, v250
    v_accvgpr_read_b32 v251, a189
    v_mul_f32_e64 v251, v249, v251
    v_accvgpr_write_b32 a189, v251
    v_accvgpr_read_b32 v250, a190
    v_mul_f32_e64 v250, v249, v250
    v_accvgpr_write_b32 a190, v250
    v_accvgpr_read_b32 v251, a191
    v_mul_f32_e64 v251, v249, v251
    v_accvgpr_write_b32 a191, v251
    v_accvgpr_read_b32 v250, a192
    v_mul_f32_e64 v250, v249, v250
    v_accvgpr_write_b32 a192, v250
    v_accvgpr_read_b32 v251, a193
    v_mul_f32_e64 v251, v249, v251
    v_accvgpr_write_b32 a193, v251
    v_accvgpr_read_b32 v250, a194
    v_mul_f32_e64 v250, v249, v250
    v_accvgpr_write_b32 a194, v250
    v_accvgpr_read_b32 v251, a195
    v_mul_f32_e64 v251, v249, v251
    v_accvgpr_write_b32 a195, v251
    v_accvgpr_read_b32 v250, a196
    v_mul_f32_e64 v250, v249, v250
    v_accvgpr_write_b32 a196, v250
    v_accvgpr_read_b32 v251, a197
    v_mul_f32_e64 v251, v249, v251
    v_accvgpr_write_b32 a197, v251
    v_accvgpr_read_b32 v250, a198
    v_mul_f32_e64 v250, v249, v250
    v_accvgpr_write_b32 a198, v250
    v_accvgpr_read_b32 v251, a199
    v_mul_f32_e64 v251, v249, v251
    v_accvgpr_write_b32 a199, v251
    v_accvgpr_read_b32 v250, a200
    v_mul_f32_e64 v250, v249, v250
    v_accvgpr_write_b32 a200, v250
    v_accvgpr_read_b32 v251, a201
    v_mul_f32_e64 v251, v249, v251
    v_accvgpr_write_b32 a201, v251
    v_accvgpr_read_b32 v250, a202
    v_mul_f32_e64 v250, v249, v250
    v_accvgpr_write_b32 a202, v250
    v_accvgpr_read_b32 v251, a203
    v_mul_f32_e64 v251, v249, v251
    v_accvgpr_write_b32 a203, v251
    v_accvgpr_read_b32 v250, a204
    v_mul_f32_e64 v250, v249, v250
    v_accvgpr_write_b32 a204, v250
    v_accvgpr_read_b32 v251, a205
    v_mul_f32_e64 v251, v249, v251
    v_accvgpr_write_b32 a205, v251
    v_accvgpr_read_b32 v250, a206
    v_mul_f32_e64 v250, v249, v250
    v_accvgpr_write_b32 a206, v250
    v_accvgpr_read_b32 v251, a207
    v_mul_f32_e64 v251, v249, v251
    v_accvgpr_write_b32 a207, v251
    v_accvgpr_read_b32 v250, a208
    v_mul_f32_e64 v250, v249, v250
    v_accvgpr_write_b32 a208, v250
    v_accvgpr_read_b32 v251, a209
    v_mul_f32_e64 v251, v249, v251
    v_accvgpr_write_b32 a209, v251
    v_accvgpr_read_b32 v250, a210
    v_mul_f32_e64 v250, v249, v250
    v_accvgpr_write_b32 a210, v250
    v_accvgpr_read_b32 v251, a211
    v_mul_f32_e64 v251, v249, v251
    v_accvgpr_write_b32 a211, v251
    v_accvgpr_read_b32 v250, a212
    v_mul_f32_e64 v250, v249, v250
    v_accvgpr_write_b32 a212, v250
    v_accvgpr_read_b32 v251, a213
    v_mul_f32_e64 v251, v249, v251
    v_accvgpr_write_b32 a213, v251
    v_accvgpr_read_b32 v250, a214
    v_mul_f32_e64 v250, v249, v250
    v_accvgpr_write_b32 a214, v250
    v_accvgpr_read_b32 v251, a215
    v_mul_f32_e64 v251, v249, v251
    v_accvgpr_write_b32 a215, v251
    v_exp_f32 v249, v176
    v_exp_f32 v250, v177
    s_nop 0
    v_add_f32 v246, v249, v250
    v_cvt_pk_bf16_f32 v204, v249, v250
    v_exp_f32 v251, v178
    v_exp_f32 v252, v179
    v_add_f32 v246, v246, v251
    v_add_f32 v246, v246, v252
    v_cvt_pk_bf16_f32 v205, v251, v252
    v_exp_f32 v253, v180
    v_exp_f32 v248, v181
    v_add_f32 v246, v246, v253
    v_add_f32 v246, v246, v248
    v_cvt_pk_bf16_f32 v206, v253, v248
    v_exp_f32 v249, v182
    v_exp_f32 v250, v183
    v_add_f32 v246, v246, v249
    v_add_f32 v246, v246, v250
    v_cvt_pk_bf16_f32 v207, v249, v250
    v_max3_f32 v248, v144, v145, v146
    v_max3_f32 v250, v147, v148, v149
    v_max3_f32 v248, v248, v150, v151
    v_max_f32 v248, v248, v250
    v_mov_b32 v250, v248
    s_nop 1
    v_permlane16_swap_b32 v248, v250
    v_max_f32 v248, v248, v250
    v_mov_b32 v250, v248
    s_nop 1
    v_permlane32_swap_b32 v248, v250
    v_max_f32 v248, v248, v250
    v_max_f32 v248, 0, v248
    v_sub_f32 v249, 0, v248
    v_exp_f32 v249, v249
    v_sub_f32 v228, v228, v248
    v_sub_f32 v229, v229, v248
    v_sub_f32 v230, v230, v248
    v_sub_f32 v231, v231, v248
    v_sub_f32 v144, v144, v248
    v_sub_f32 v145, v145, v248
    v_sub_f32 v146, v146, v248
    v_sub_f32 v147, v147, v248
    v_sub_f32 v148, v148, v248
    v_sub_f32 v149, v149, v248
    v_sub_f32 v150, v150, v248
    v_sub_f32 v151, v151, v248
    v_mul_f32_e64 v236, v249, v236
    v_accvgpr_read_b32 v250, a120
    v_mul_f32_e64 v250, v249, v250
    v_accvgpr_write_b32 a120, v250
    v_accvgpr_read_b32 v251, a121
    v_mul_f32_e64 v251, v249, v251
    v_accvgpr_write_b32 a121, v251
    v_accvgpr_read_b32 v250, a122
    v_mul_f32_e64 v250, v249, v250
    v_accvgpr_write_b32 a122, v250
    v_accvgpr_read_b32 v251, a123
    v_mul_f32_e64 v251, v249, v251
    v_accvgpr_write_b32 a123, v251
    v_accvgpr_read_b32 v250, a124
    v_mul_f32_e64 v250, v249, v250
    v_accvgpr_write_b32 a124, v250
    v_accvgpr_read_b32 v251, a125
    v_mul_f32_e64 v251, v249, v251
    v_accvgpr_write_b32 a125, v251
    v_accvgpr_read_b32 v250, a126
    v_mul_f32_e64 v250, v249, v250
    v_accvgpr_write_b32 a126, v250
    v_accvgpr_read_b32 v251, a127
    v_mul_f32_e64 v251, v249, v251
    v_accvgpr_write_b32 a127, v251
    v_accvgpr_read_b32 v250, a128
    v_mul_f32_e64 v250, v249, v250
    v_accvgpr_write_b32 a128, v250
    v_accvgpr_read_b32 v251, a129
    v_mul_f32_e64 v251, v249, v251
    v_accvgpr_write_b32 a129, v251
    v_accvgpr_read_b32 v250, a130
    v_mul_f32_e64 v250, v249, v250
    v_accvgpr_write_b32 a130, v250
    v_accvgpr_read_b32 v251, a131
    v_mul_f32_e64 v251, v249, v251
    v_accvgpr_write_b32 a131, v251
    v_accvgpr_read_b32 v250, a132
    v_mul_f32_e64 v250, v249, v250
    v_accvgpr_write_b32 a132, v250
    v_accvgpr_read_b32 v251, a133
    v_mul_f32_e64 v251, v249, v251
    v_accvgpr_write_b32 a133, v251
    v_accvgpr_read_b32 v250, a134
    v_mul_f32_e64 v250, v249, v250
    v_accvgpr_write_b32 a134, v250
    v_accvgpr_read_b32 v251, a135
    v_mul_f32_e64 v251, v249, v251
    v_accvgpr_write_b32 a135, v251
    v_accvgpr_read_b32 v250, a136
    v_mul_f32_e64 v250, v249, v250
    v_accvgpr_write_b32 a136, v250
    v_accvgpr_read_b32 v251, a137
    v_mul_f32_e64 v251, v249, v251
    v_accvgpr_write_b32 a137, v251
    v_accvgpr_read_b32 v250, a138
    v_mul_f32_e64 v250, v249, v250
    v_accvgpr_write_b32 a138, v250
    v_accvgpr_read_b32 v251, a139
    v_mul_f32_e64 v251, v249, v251
    v_accvgpr_write_b32 a139, v251
    v_accvgpr_read_b32 v250, a140
    v_mul_f32_e64 v250, v249, v250
    v_accvgpr_write_b32 a140, v250
    v_accvgpr_read_b32 v251, a141
    v_mul_f32_e64 v251, v249, v251
    v_accvgpr_write_b32 a141, v251
    v_accvgpr_read_b32 v250, a142
    v_mul_f32_e64 v250, v249, v250
    v_accvgpr_write_b32 a142, v250
    v_accvgpr_read_b32 v251, a143
    v_mul_f32_e64 v251, v249, v251
    v_accvgpr_write_b32 a143, v251
    v_accvgpr_read_b32 v250, a144
    v_mul_f32_e64 v250, v249, v250
    v_accvgpr_write_b32 a144, v250
    v_accvgpr_read_b32 v251, a145
    v_mul_f32_e64 v251, v249, v251
    v_accvgpr_write_b32 a145, v251
    v_accvgpr_read_b32 v250, a146
    v_mul_f32_e64 v250, v249, v250
    v_accvgpr_write_b32 a146, v250
    v_accvgpr_read_b32 v251, a147
    v_mul_f32_e64 v251, v249, v251
    v_accvgpr_write_b32 a147, v251
    v_accvgpr_read_b32 v250, a148
    v_mul_f32_e64 v250, v249, v250
    v_accvgpr_write_b32 a148, v250
    v_accvgpr_read_b32 v251, a149
    v_mul_f32_e64 v251, v249, v251
    v_accvgpr_write_b32 a149, v251
    v_accvgpr_read_b32 v250, a150
    v_mul_f32_e64 v250, v249, v250
    v_accvgpr_write_b32 a150, v250
    v_accvgpr_read_b32 v251, a151
    v_mul_f32_e64 v251, v249, v251
    v_accvgpr_write_b32 a151, v251
    v_accvgpr_read_b32 v250, a152
    v_mul_f32_e64 v250, v249, v250
    v_accvgpr_write_b32 a152, v250
    v_accvgpr_read_b32 v251, a153
    v_mul_f32_e64 v251, v249, v251
    v_accvgpr_write_b32 a153, v251
    v_accvgpr_read_b32 v250, a154
    v_mul_f32_e64 v250, v249, v250
    v_accvgpr_write_b32 a154, v250
    v_accvgpr_read_b32 v251, a155
    v_mul_f32_e64 v251, v249, v251
    v_accvgpr_write_b32 a155, v251
    v_accvgpr_read_b32 v250, a156
    v_mul_f32_e64 v250, v249, v250
    v_accvgpr_write_b32 a156, v250
    v_accvgpr_read_b32 v251, a157
    v_mul_f32_e64 v251, v249, v251
    v_accvgpr_write_b32 a157, v251
    v_accvgpr_read_b32 v250, a158
    v_mul_f32_e64 v250, v249, v250
    v_accvgpr_write_b32 a158, v250
    v_accvgpr_read_b32 v251, a159
    v_mul_f32_e64 v251, v249, v251
    v_accvgpr_write_b32 a159, v251
    v_accvgpr_read_b32 v250, a160
    v_mul_f32_e64 v250, v249, v250
    v_accvgpr_write_b32 a160, v250
    v_accvgpr_read_b32 v251, a161
    v_mul_f32_e64 v251, v249, v251
    v_accvgpr_write_b32 a161, v251
    v_accvgpr_read_b32 v250, a162
    v_mul_f32_e64 v250, v249, v250
    v_accvgpr_write_b32 a162, v250
    v_accvgpr_read_b32 v251, a163
    v_mul_f32_e64 v251, v249, v251
    v_accvgpr_write_b32 a163, v251
    v_accvgpr_read_b32 v250, a164
    v_mul_f32_e64 v250, v249, v250
    v_accvgpr_write_b32 a164, v250
    v_accvgpr_read_b32 v251, a165
    v_mul_f32_e64 v251, v249, v251
    v_accvgpr_write_b32 a165, v251
    v_accvgpr_read_b32 v250, a166
    v_mul_f32_e64 v250, v249, v250
    v_accvgpr_write_b32 a166, v250
    v_accvgpr_read_b32 v251, a167
    v_mul_f32_e64 v251, v249, v251
    v_accvgpr_write_b32 a167, v251
    v_exp_f32 v251, v144
    v_exp_f32 v252, v145
    s_nop 0
    v_add_f32 v247, v251, v252
    v_cvt_pk_bf16_f32 v208, v251, v252
    v_exp_f32 v253, v146
    v_exp_f32 v248, v147
    v_add_f32 v247, v247, v253
    v_add_f32 v247, v247, v248
    v_cvt_pk_bf16_f32 v209, v253, v248
    v_exp_f32 v249, v148
    v_exp_f32 v250, v149
    v_add_f32 v247, v247, v249
    v_add_f32 v247, v247, v250
    v_cvt_pk_bf16_f32 v210, v249, v250
    v_exp_f32 v251, v150
    v_exp_f32 v252, v151
    v_add_f32 v247, v247, v251
    v_add_f32 v247, v247, v252
    v_cvt_pk_bf16_f32 v211, v251, v252
    s_nop 3
    s_branch L_ret1A
L_slow0A:
    s_nop 15
    v_max3_f32 v248, v128, v129, v130
    v_max3_f32 v250, v131, v132, v133
    v_max3_f32 v248, v248, v134, v135
    v_max_f32 v248, v248, v250
    v_mov_b32 v250, v248
    s_nop 1
    v_permlane16_swap_b32 v248, v250
    v_max_f32 v248, v248, v250
    v_mov_b32 v250, v248
    s_nop 1
    v_permlane32_swap_b32 v248, v250
    v_max_f32 v248, v248, v250
    v_max_f32 v248, 0, v248
    v_sub_f32 v249, 0, v248
    v_exp_f32 v249, v249
    v_sub_f32 v212, v212, v248
    v_sub_f32 v213, v213, v248
    v_sub_f32 v214, v214, v248
    v_sub_f32 v215, v215, v248
    v_sub_f32 v128, v128, v248
    v_sub_f32 v129, v129, v248
    v_sub_f32 v130, v130, v248
    v_sub_f32 v131, v131, v248
    v_sub_f32 v132, v132, v248
    v_sub_f32 v133, v133, v248
    v_sub_f32 v134, v134, v248
    v_sub_f32 v135, v135, v248
    v_mul_f32 v232, v249, v232
    v_mul_f32 v0, v249, v0
    v_mul_f32 v1, v249, v1
    v_mul_f32 v2, v249, v2
    v_mul_f32 v3, v249, v3
    v_mul_f32 v4, v249, v4
    v_mul_f32 v5, v249, v5
    v_mul_f32 v6, v249, v6
    v_mul_f32 v7, v249, v7
    v_mul_f32 v8, v249, v8
    v_mul_f32 v9, v249, v9
    v_mul_f32 v10, v249, v10
    v_mul_f32 v11, v249, v11
    v_mul_f32 v12, v249, v12
    v_mul_f32 v13, v249, v13
    v_mul_f32 v14, v249, v14
    v_mul_f32 v15, v249, v15
    v_mul_f32 v16, v249, v16
    v_mul_f32 v17, v249, v17
    v_mul_f32 v18, v249, v18
    v_mul_f32 v19, v249, v19
    v_mul_f32 v20, v249, v20
    v_mul_f32 v21, v249, v21
    v_mul_f32 v22, v249, v22
    v_mul_f32 v23, v249, v23
    v_mul_f32 v24, v249, v24
    v_mul_f32 v25, v249, v25
    v_mul_f32 v26, v249, v26
    v_mul_f32 v27, v249, v27
    v_mul_f32 v28, v249, v28
    v_mul_f32 v29, v249, v29
    v_mul_f32 v30, v249, v30
    v_mul_f32 v31, v249, v31
    v_mul_f32 v32, v249, v32
    v_mul_f32 v33, v249, v33
    v_mul_f32 v34, v249, v34
    v_mul_f32 v35, v249, v35
    v_mul_f32 v36, v249, v36
    v_mul_f32 v37, v249, v37
    v_mul_f32 v38, v249, v38
    v_mul_f32 v39, v249, v39
    v_mul_f32 v40, v249, v40
    v_mul_f32 v41, v249, v41
    v_mul_f32 v42, v249, v42
    v_mul_f32 v43, v249, v43
    v_mul_f32 v44, v249, v44
    v_mul_f32 v45, v249, v45
    v_mul_f32 v46, v249, v46
    v_mul_f32 v47, v249, v47
    v_exp_f32 v252, v128
    v_exp_f32 v253, v129
    s_nop 0
    v_add_f32 v254, v252, v253
    v_cvt_pk_bf16_f32 v192, v252, v253
    v_exp_f32 v248, v130
    v_exp_f32 v249, v131
    v_add_f32 v254, v254, v248
    v_add_f32 v254, v254, v249
    v_cvt_pk_bf16_f32 v193, v248, v249
    v_exp_f32 v250, v132
    v_exp_f32 v251, v133
    v_add_f32 v254, v254, v250
    v_add_f32 v254, v254, v251
    v_cvt_pk_bf16_f32 v194, v250, v251
    v_exp_f32 v252, v134
    v_exp_f32 v253, v135
    v_add_f32 v254, v254, v252
    v_add_f32 v254, v254, v253
    v_cvt_pk_bf16_f32 v195, v252, v253
    v_max3_f32 v248, v136, v137, v138
    v_max3_f32 v250, v139, v140, v141
    v_max3_f32 v248, v248, v142, v143
    v_max_f32 v248, v248, v250
    v_mov_b32 v250, v248
    s_nop 1
    v_permlane16_swap_b32 v248, v250
    v_max_f32 v248, v248, v250
    v_mov_b32 v250, v248
    s_nop 1
    v_permlane32_swap_b32 v248, v250
    v_max_f32 v248, v248, v250
    v_max_f32 v248, 0, v248
    v_sub_f32 v249, 0, v248
    v_exp_f32 v249, v249
    v_sub_f32 v216, v216, v248
    v_sub_f32 v217, v217, v248
    v_sub_f32 v218, v218, v248
    v_sub_f32 v219, v219, v248
    v_sub_f32 v136, v136, v248
    v_sub_f32 v137, v137, v248
    v_sub_f32 v138, v138, v248
    v_sub_f32 v139, v139, v248
    v_sub_f32 v140, v140, v248
    v_sub_f32 v141, v141, v248
    v_sub_f32 v142, v142, v248
    v_sub_f32 v143, v143, v248
    v_mul_f32 v233, v249, v233
    v_mul_f32 v48, v249, v48
    v_mul_f32 v49, v249, v49
    v_mul_f32 v50, v249, v50
    v_mul_f32 v51, v249, v51
    v_mul_f32 v52, v249, v52
    v_mul_f32 v53, v249, v53
    v_mul_f32 v54, v249, v54
    v_mul_f32 v55, v249, v55
    v_mul_f32 v56, v249, v56
    v_mul_f32 v57, v249, v57
    v_mul_f32 v58, v249, v58
    v_mul_f32 v59, v249, v59
    v_mul_f32 v60, v249, v60
    v_mul_f32 v61, v249, v61
    v_mul_f32 v62, v249, v62
    v_mul_f32 v63, v249, v63
    v_mul_f32 v64, v249, v64
    v_mul_f32 v65, v249, v65
    v_mul_f32 v66, v249, v66
    v_mul_f32 v67, v249, v67
    v_mul_f32 v68, v249, v68
    v_mul_f32 v69, v249, v69
    v_mul_f32 v70, v249, v70
    v_mul_f32 v71, v249, v71
    v_mul_f32 v72, v249, v72
    v_mul_f32 v73, v249, v73
    v_mul_f32 v74, v249, v74
    v_mul_f32 v75, v249, v75
    v_mul_f32 v76, v249, v76
    v_mul_f32 v77, v249, v77
    v_mul_f32 v78, v249, v78
    v_mul_f32 v79, v249, v79
    v_mul_f32 v80, v249, v80
    v_mul_f32 v81, v249, v81
    v_mul_f32 v82, v249, v82
    v_mul_f32 v83, v249, v83
    v_mul_f32 v84, v249, v84
    v_mul_f32 v85, v249, v85
    v_mul_f32 v86, v249, v86
    v_mul_f32 v87, v249, v87
    v_mul_f32 v88, v249, v88
    v_mul_f32 v89, v249, v89
    v_mul_f32 v90, v249, v90
    v_mul_f32 v91, v249, v91
    v_mul_f32 v92, v249, v92
    v_mul_f32 v93, v249, v93
    v_mul_f32 v94, v249, v94
    v_mul_f32 v95, v249, v95
    v_exp_f32 v248, v136
    v_exp_f32 v249, v137
    s_nop 0
    v_add_f32_e64 v246, v248, v249
    v_cvt_pk_bf16_f32 v196, v248, v249
    v_exp_f32 v250, v138
    v_exp_f32 v251, v139
    v_add_f32 v246, v246, v250
    v_add_f32 v246, v246, v251
    v_cvt_pk_bf16_f32 v197, v250, v251
    v_exp_f32 v252, v140
    v_exp_f32 v253, v141
    v_add_f32 v246, v246, v252
    v_add_f32 v246, v246, v253
    v_cvt_pk_bf16_f32 v198, v252, v253
    v_exp_f32 v248, v142
    v_exp_f32 v249, v143
    v_add_f32 v246, v246, v248
    v_add_f32 v246, v246, v249
    v_cvt_pk_bf16_f32 v199, v248, v249
    s_nop 3
    s_branch L_ret0A
L_slow1B:
    s_nop 15
    v_max3_f32 v248, v152, v153, v154
    v_max3_f32 v250, v155, v156, v157
    v_max3_f32 v248, v248, v158, v159
    v_max_f32 v248, v248, v250
    v_mov_b32 v250, v248
    s_nop 1
    v_permlane16_swap_b32 v248, v250
    v_max_f32 v248, v248, v250
    v_mov_b32 v250, v248
    s_nop 1
    v_permlane32_swap_b32 v248, v250
    v_max_f32 v248, v248, v250
    v_max_f32 v248, 0, v248
    v_sub_f32 v249, 0, v248
    v_exp_f32 v249, v249
    v_sub_f32 v220, v220, v248
    v_sub_f32 v221, v221, v248
    v_sub_f32 v222, v222, v248
    v_sub_f32 v223, v223, v248
    v_sub_f32 v152, v152, v248
    v_sub_f32 v153, v153, v248
    v_sub_f32 v154, v154, v248
    v_sub_f32 v155, v155, v248
    v_sub_f32 v156, v156, v248
    v_sub_f32 v157, v157, v248
    v_sub_f32 v158, v158, v248
    v_sub_f32 v159, v159, v248
    v_sub_f32 v168, v168, v248
    v_sub_f32 v169, v169, v248
    v_sub_f32 v170, v170, v248
    v_sub_f32 v171, v171, v248
    v_sub_f32 v172, v172, v248
    v_sub_f32 v173, v173, v248
    v_sub_f32 v174, v174, v248
    v_sub_f32 v175, v175, v248
    v_mul_f32 v234, v249, v234
    v_mul_f32 v96, v249, v96
    v_mul_f32 v97, v249, v97
    v_mul_f32 v98, v249, v98
    v_mul_f32 v99, v249, v99
    v_mul_f32 v100, v249, v100
    v_mul_f32 v101, v249, v101
    v_mul_f32 v102, v249, v102
    v_mul_f32 v103, v249, v103
    v_mul_f32 v104, v249, v104
    v_mul_f32 v105, v249, v105
    v_mul_f32 v106, v249, v106
    v_mul_f32 v107, v249, v107
    v_mul_f32 v108, v249, v108
    v_mul_f32 v109, v249, v109
    v_mul_f32 v110, v249, v110
    v_mul_f32 v111, v249, v111
    v_mul_f32 v112, v249, v112
    v_mul_f32 v113, v249, v113
    v_mul_f32 v114, v249, v114
    v_mul_f32 v115, v249, v115
    v_mul_f32 v116, v249, v116
    v_mul_f32 v117, v249, v117
    v_mul_f32 v118, v249, v118
    v_mul_f32 v119, v249, v119
    v_mul_f32 v120, v249, v120
    v_mul_f32 v121, v249, v121
    v_mul_f32 v122, v249, v122
    v_mul_f32 v123, v249, v123
    v_mul_f32 v124, v249, v124
    v_mul_f32 v125, v249, v125
    v_mul_f32 v126, v249, v126
    v_mul_f32 v127, v249, v127
    v_accvgpr_read_b32 v250, a216
    v_mul_f32_e64 v250, v249, v250
    v_accvgpr_write_b32 a216, v250
    v_accvgpr_read_b32 v251, a217
    v_mul_f32_e64 v251, v249, v251
    v_accvgpr_write_b32 a217, v251
    v_accvgpr_read_b32 v250, a218
    v_mul_f32_e64 v250, v249, v250
    v_accvgpr_write_b32 a218, v250
    v_accvgpr_read_b32 v251, a219
    v_mul_f32_e64 v251, v249, v251
    v_accvgpr_write_b32 a219, v251
    v_accvgpr_read_b32 v250, a220
    v_mul_f32_e64 v250, v249, v250
    v_accvgpr_write_b32 a220, v250
    v_accvgpr_read_b32 v251, a221
    v_mul_f32_e64 v251, v249, v251
    v_accvgpr_write_b32 a221, v251
    v_accvgpr_read_b32 v250, a222
    v_mul_f32_e64 v250, v249, v250
    v_accvgpr_write_b32 a222, v250
    v_accvgpr_read_b32 v251, a223
    v_mul_f32_e64 v251, v249, v251
    v_accvgpr_write_b32 a223, v251
    v_accvgpr_read_b32 v250, a224
    v_mul_f32_e64 v250, v249, v250
    v_accvgpr_write_b32 a224, v250
    v_accvgpr_read_b32 v251, a225
    v_mul_f32_e64 v251, v249, v251
    v_accvgpr_write_b32 a225, v251
    v_accvgpr_read_b32 v250, a226
    v_mul_f32_e64 v250, v249, v250
    v_accvgpr_write_b32 a226, v250
    v_accvgpr_read_b32 v251, a227
    v_mul_f32_e64 v251, v249, v251
    v_accvgpr_write_b32 a227, v251
    v_accvgpr_read_b32 v250, a228
    v_mul_f32_e64 v250, v249, v250
    v_accvgpr_write_b32 a228, v250
    v_accvgpr_read_b32 v251, a229
    v_mul_f32_e64 v251, v249, v251
    v_accvgpr_write_b32 a229, v251
    v_accvgpr_read_b32 v250, a230
    v_mul_f32_e64 v250, v249, v250
    v_accvgpr_write_b32 a230, v250
    v_accvgpr_read_b32 v251, a231
    v_mul_f32_e64 v251, v249, v251
    v_accvgpr_write_b32 a231, v251
    v_exp_f32 v251, v152
    v_exp_f32 v252, v153
    s_nop 0
    v_add_f32 v245, v251, v252
    v_cvt_pk_bf16_f32 v200, v251, v252
    v_exp_f32 v253, v154
    v_exp_f32 v248, v155
    v_add_f32 v245, v245, v253
    v_add_f32 v245, v245, v248
    v_cvt_pk_bf16_f32 v201, v253, v248
    v_exp_f32 v249, v156
    v_exp_f32 v250, v157
    v_add_f32 v245, v245, v249
    v_add_f32 v245, v245, v250
    v_cvt_pk_bf16_f32 v202, v249, v250
    v_exp_f32 v251, v158
    v_exp_f32 v252, v159
    v_add_f32 v245, v245, v251
    v_add_f32 v245, v245, v252
    v_cvt_pk_bf16_f32 v203, v251, v252
    v_max3_f32 v248, v160, v161, v162
    v_max3_f32 v250, v163, v164, v165
    v_max3_f32 v248, v248, v166, v167
    v_max_f32 v248, v248, v250
    v_mov_b32 v250, v248
    s_nop 1
    v_permlane16_swap_b32 v248, v250
    v_max_f32 v248, v248, v250
    v_mov_b32 v250, v248
    s_nop 1
    v_permlane32_swap_b32 v248, v250
    v_max_f32 v248, v248, v250
    v_max_f32 v248, 0, v248
    v_sub_f32 v249, 0, v248
    v_exp_f32 v249, v249
    v_sub_f32 v224, v224, v248
    v_sub_f32 v225, v225, v248
    v_sub_f32 v226, v226, v248
    v_sub_f32 v227, v227, v248
    v_sub_f32 v160, v160, v248
    v_sub_f32 v161, v161, v248
    v_sub_f32 v162, v162, v248
    v_sub_f32 v163, v163, v248
    v_sub_f32 v164, v164, v248
    v_sub_f32 v165, v165, v248
    v_sub_f32 v166, v166, v248
    v_sub_f32 v167, v167, v248
    v_sub_f32 v176, v176, v248
    v_sub_f32 v177, v177, v248
    v_sub_f32 v178, v178, v248
    v_sub_f32 v179, v179, v248
    v_sub_f32 v180, v180, v248
    v_sub_f32 v181, v181, v248
    v_sub_f32 v182, v182, v248
    v_sub_f32 v183, v183, v248
    v_mul_f32_e64 v235, v249, v235
    v_accvgpr_read_b32 v250, a168
    v_mul_f32_e64 v250, v249, v250
    v_accvgpr_write_b32 a168, v250
    v_accvgpr_read_b32 v251, a169
    v_mul_f32_e64 v251, v249, v251
    v_accvgpr_write_b32 a169, v251
    v_accvgpr_read_b32 v250, a170
    v_mul_f32_e64 v250, v249, v250
    v_accvgpr_write_b32 a170, v250
    v_accvgpr_read_b32 v251, a171
    v_mul_f32_e64 v251, v249, v251
    v_accvgpr_write_b32 a171, v251
    v_accvgpr_read_b32 v250, a172
    v_mul_f32_e64 v250, v249, v250
    v_accvgpr_write_b32 a172, v250
    v_accvgpr_read_b32 v251, a173
    v_mul_f32_e64 v251, v249, v251
    v_accvgpr_write_b32 a173, v251
    v_accvgpr_read_b32 v250, a174
    v_mul_f32_e64 v250, v249, v250
    v_accvgpr_write_b32 a174, v250
    v_accvgpr_read_b32 v251, a175
    v_mul_f32_e64 v251, v249, v251
    v_accvgpr_write_b32 a175, v251
    v_accvgpr_read_b32 v250, a176
    v_mul_f32_e64 v250, v249, v250
    v_accvgpr_write_b32 a176, v250
    v_accvgpr_read_b32 v251, a177
    v_mul_f32_e64 v251, v249, v251
    v_accvgpr_write_b32 a177, v251
    v_accvgpr_read_b32 v250, a178
    v_mul_f32_e64 v250, v249, v250
    v_accvgpr_write_b32 a178, v250
    v_accvgpr_read_b32 v251, a179
    v_mul_f32_e64 v251, v249, v251
    v_accvgpr_write_b32 a179, v251
    v_accvgpr_read_b32 v250, a180
    v_mul_f32_e64 v250, v249, v250
    v_accvgpr_write_b32 a180, v250
    v_accvgpr_read_b32 v251, a181
    v_mul_f32_e64 v251, v249, v251
    v_accvgpr_write_b32 a181, v251
    v_accvgpr_read_b32 v250, a182
    v_mul_f32_e64 v250, v249, v250
    v_accvgpr_write_b32 a182, v250
    v_accvgpr_read_b32 v251, a183
    v_mul_f32_e64 v251, v249, v251
    v_accvgpr_write_b32 a183, v251
    v_accvgpr_read_b32 v250, a184
    v_mul_f32_e64 v250, v249, v250
    v_accvgpr_write_b32 a184, v250
    v_accvgpr_read_b32 v251, a185
    v_mul_f32_e64 v251, v249, v251
    v_accvgpr_write_b32 a185, v251
    v_accvgpr_read_b32 v250, a186
    v_mul_f32_e64 v250, v249, v250
    v_accvgpr_write_b32 a186, v250
    v_accvgpr_read_b32 v251, a187
    v_mul_f32_e64 v251, v249, v251
    v_accvgpr_write_b32 a187, v251
    v_accvgpr_read_b32 v250, a188
    v_mul_f32_e64 v250, v249, v250
    v_accvgpr_write_b32 a188, v250
    v_accvgpr_read_b32 v251, a189
    v_mul_f32_e64 v251, v249, v251
    v_accvgpr_write_b32 a189, v251
    v_accvgpr_read_b32 v250, a190
    v_mul_f32_e64 v250, v249, v250
    v_accvgpr_write_b32 a190, v250
    v_accvgpr_read_b32 v251, a191
    v_mul_f32_e64 v251, v249, v251
    v_accvgpr_write_b32 a191, v251
    v_accvgpr_read_b32 v250, a192
    v_mul_f32_e64 v250, v249, v250
    v_accvgpr_write_b32 a192, v250
    v_accvgpr_read_b32 v251, a193
    v_mul_f32_e64 v251, v249, v251
    v_accvgpr_write_b32 a193, v251
    v_accvgpr_read_b32 v250, a194
    v_mul_f32_e64 v250, v249, v250
    v_accvgpr_write_b32 a194, v250
    v_accvgpr_read_b32 v251, a195
    v_mul_f32_e64 v251, v249, v251
    v_accvgpr_write_b32 a195, v251
    v_accvgpr_read_b32 v250, a196
    v_mul_f32_e64 v250, v249, v250
    v_accvgpr_write_b32 a196, v250
    v_accvgpr_read_b32 v251, a197
    v_mul_f32_e64 v251, v249, v251
    v_accvgpr_write_b32 a197, v251
    v_accvgpr_read_b32 v250, a198
    v_mul_f32_e64 v250, v249, v250
    v_accvgpr_write_b32 a198, v250
    v_accvgpr_read_b32 v251, a199
    v_mul_f32_e64 v251, v249, v251
    v_accvgpr_write_b32 a199, v251
    v_accvgpr_read_b32 v250, a200
    v_mul_f32_e64 v250, v249, v250
    v_accvgpr_write_b32 a200, v250
    v_accvgpr_read_b32 v251, a201
    v_mul_f32_e64 v251, v249, v251
    v_accvgpr_write_b32 a201, v251
    v_accvgpr_read_b32 v250, a202
    v_mul_f32_e64 v250, v249, v250
    v_accvgpr_write_b32 a202, v250
    v_accvgpr_read_b32 v251, a203
    v_mul_f32_e64 v251, v249, v251
    v_accvgpr_write_b32 a203, v251
    v_accvgpr_read_b32 v250, a204
    v_mul_f32_e64 v250, v249, v250
    v_accvgpr_write_b32 a204, v250
    v_accvgpr_read_b32 v251, a205
    v_mul_f32_e64 v251, v249, v251
    v_accvgpr_write_b32 a205, v251
    v_accvgpr_read_b32 v250, a206
    v_mul_f32_e64 v250, v249, v250
    v_accvgpr_write_b32 a206, v250
    v_accvgpr_read_b32 v251, a207
    v_mul_f32_e64 v251, v249, v251
    v_accvgpr_write_b32 a207, v251
    v_accvgpr_read_b32 v250, a208
    v_mul_f32_e64 v250, v249, v250
    v_accvgpr_write_b32 a208, v250
    v_accvgpr_read_b32 v251, a209
    v_mul_f32_e64 v251, v249, v251
    v_accvgpr_write_b32 a209, v251
    v_accvgpr_read_b32 v250, a210
    v_mul_f32_e64 v250, v249, v250
    v_accvgpr_write_b32 a210, v250
    v_accvgpr_read_b32 v251, a211
    v_mul_f32_e64 v251, v249, v251
    v_accvgpr_write_b32 a211, v251
    v_accvgpr_read_b32 v250, a212
    v_mul_f32_e64 v250, v249, v250
    v_accvgpr_write_b32 a212, v250
    v_accvgpr_read_b32 v251, a213
    v_mul_f32_e64 v251, v249, v251
    v_accvgpr_write_b32 a213, v251
    v_accvgpr_read_b32 v250, a214
    v_mul_f32_e64 v250, v249, v250
    v_accvgpr_write_b32 a214, v250
    v_accvgpr_read_b32 v251, a215
    v_mul_f32_e64 v251, v249, v251
    v_accvgpr_write_b32 a215, v251
    v_exp_f32 v253, v160
    v_exp_f32 v248, v161
    s_nop 0
    v_add_f32 v246, v253, v248
    v_cvt_pk_bf16_f32 v204, v253, v248
    v_exp_f32 v249, v162
    v_exp_f32 v250, v163
    v_add_f32 v246, v246, v249
    v_add_f32 v246, v246, v250
    v_cvt_pk_bf16_f32 v205, v249, v250
    v_exp_f32 v251, v164
    v_exp_f32 v252, v165
    v_add_f32 v246, v246, v251
    v_add_f32 v246, v246, v252
    v_cvt_pk_bf16_f32 v206, v251, v252
    v_exp_f32 v253, v166
    v_exp_f32 v248, v167
    v_add_f32 v246, v246, v253
    v_add_f32 v246, v246, v248
    v_cvt_pk_bf16_f32 v207, v253, v248
    s_nop 3
    s_branch L_ret1B
L_slow0B:
    s_nop 15
    v_max3_f32 v248, v128, v129, v130
    v_max3_f32 v250, v131, v132, v133
    v_max3_f32 v248, v248, v134, v135
    v_max_f32 v248, v248, v250
    v_mov_b32 v250, v248
    s_nop 1
    v_permlane16_swap_b32 v248, v250
    v_max_f32 v248, v248, v250
    v_mov_b32 v250, v248
    s_nop 1
    v_permlane32_swap_b32 v248, v250
    v_max_f32 v248, v248, v250
    v_max_f32 v248, 0, v248
    v_sub_f32 v249, 0, v248
    v_exp_f32 v249, v249
    v_sub_f32 v212, v212, v248
    v_sub_f32 v213, v213, v248
    v_sub_f32 v214, v214, v248
    v_sub_f32 v215, v215, v248
    v_sub_f32 v128, v128, v248
    v_sub_f32 v129, v129, v248
    v_sub_f32 v130, v130, v248
    v_sub_f32 v131, v131, v248
    v_sub_f32 v132, v132, v248
    v_sub_f32 v133, v133, v248
    v_sub_f32 v134, v134, v248
    v_sub_f32 v135, v135, v248
    v_mul_f32 v232, v249, v232
    v_mul_f32 v0, v249, v0
    v_mul_f32 v1, v249, v1
    v_mul_f32 v2, v249, v2
    v_mul_f32 v3, v249, v3
    v_mul_f32 v4, v249, v4
    v_mul_f32 v5, v249, v5
    v_mul_f32 v6, v249, v6
    v_mul_f32 v7, v249, v7
    v_mul_f32 v8, v249, v8
    v_mul_f32 v9, v249, v9
    v_mul_f32 v10, v249, v10
    v_mul_f32 v11, v249, v11
    v_mul_f32 v12, v249, v12
    v_mul_f32 v13, v249, v13
    v_mul_f32 v14, v249, v14
    v_mul_f32 v15, v249, v15
    v_mul_f32 v16, v249, v16
    v_mul_f32 v17, v249, v17
    v_mul_f32 v18, v249, v18
    v_mul_f32 v19, v249, v19
    v_mul_f32 v20, v249, v20
    v_mul_f32 v21, v249, v21
    v_mul_f32 v22, v249, v22
    v_mul_f32 v23, v249, v23
    v_mul_f32 v24, v249, v24
    v_mul_f32 v25, v249, v25
    v_mul_f32 v26, v249, v26
    v_mul_f32 v27, v249, v27
    v_mul_f32 v28, v249, v28
    v_mul_f32 v29, v249, v29
    v_mul_f32 v30, v249, v30
    v_mul_f32 v31, v249, v31
    v_mul_f32 v32, v249, v32
    v_mul_f32 v33, v249, v33
    v_mul_f32 v34, v249, v34
    v_mul_f32 v35, v249, v35
    v_mul_f32 v36, v249, v36
    v_mul_f32 v37, v249, v37
    v_mul_f32 v38, v249, v38
    v_mul_f32 v39, v249, v39
    v_mul_f32 v40, v249, v40
    v_mul_f32 v41, v249, v41
    v_mul_f32 v42, v249, v42
    v_mul_f32 v43, v249, v43
    v_mul_f32 v44, v249, v44
    v_mul_f32 v45, v249, v45
    v_mul_f32 v46, v249, v46
    v_mul_f32 v47, v249, v47
    v_exp_f32 v250, v128
    v_exp_f32 v251, v129
    s_nop 0
    v_add_f32 v254, v250, v251
    v_cvt_pk_bf16_f32 v184, v250, v251
    v_exp_f32 v252, v130
    v_exp_f32 v253, v131
    v_add_f32 v254, v254, v252
    v_add_f32 v254, v254, v253
    v_cvt_pk_bf16_f32 v185, v252, v253
    v_exp_f32 v248, v132
    v_exp_f32 v249, v133
    v_add_f32 v254, v254, v248
    v_add_f32 v254, v254, v249
    v_cvt_pk_bf16_f32 v186, v248, v249
    v_exp_f32 v250, v134
    v_exp_f32 v251, v135
    v_add_f32 v254, v254, v250
    v_add_f32 v254, v254, v251
    v_cvt_pk_bf16_f32 v187, v250, v251
    v_max3_f32 v248, v136, v137, v138
    v_max3_f32 v250, v139, v140, v141
    v_max3_f32 v248, v248, v142, v143
    v_max_f32 v248, v248, v250
    v_mov_b32 v250, v248
    s_nop 1
    v_permlane16_swap_b32 v248, v250
    v_max_f32 v248, v248, v250
    v_mov_b32 v250, v248
    s_nop 1
    v_permlane32_swap_b32 v248, v250
    v_max_f32 v248, v248, v250
    v_max_f32 v248, 0, v248
    v_sub_f32 v249, 0, v248
    v_exp_f32 v249, v249
    v_sub_f32 v216, v216, v248
    v_sub_f32 v217, v217, v248
    v_sub_f32 v218, v218, v248
    v_sub_f32 v219, v219, v248
    v_sub_f32 v136, v136, v248
    v_sub_f32 v137, v137, v248
    v_sub_f32 v138, v138, v248
    v_sub_f32 v139, v139, v248
    v_sub_f32 v140, v140, v248
    v_sub_f32 v141, v141, v248
    v_sub_f32 v142, v142, v248
    v_sub_f32 v143, v143, v248
    v_mul_f32 v233, v249, v233
    v_mul_f32 v48, v249, v48
    v_mul_f32 v49, v249, v49
    v_mul_f32 v50, v249, v50
    v_mul_f32 v51, v249, v51
    v_mul_f32 v52, v249, v52
    v_mul_f32 v53, v249, v53
    v_mul_f32 v54, v249, v54
    v_mul_f32 v55, v249, v55
    v_mul_f32 v56, v249, v56
    v_mul_f32 v57, v249, v57
    v_mul_f32 v58, v249, v58
    v_mul_f32 v59, v249, v59
    v_mul_f32 v60, v249, v60
    v_mul_f32 v61, v249, v61
    v_mul_f32 v62, v249, v62
    v_mul_f32 v63, v249, v63
    v_mul_f32 v64, v249, v64
    v_mul_f32 v65, v249, v65
    v_mul_f32 v66, v249, v66
    v_mul_f32 v67, v249, v67
    v_mul_f32 v68, v249, v68
    v_mul_f32 v69, v249, v69
    v_mul_f32 v70, v249, v70
    v_mul_f32 v71, v249, v71
    v_mul_f32 v72, v249, v72
    v_mul_f32 v73, v249, v73
    v_mul_f32 v74, v249, v74
    v_mul_f32 v75, v249, v75
    v_mul_f32 v76, v249, v76
    v_mul_f32 v77, v249, v77
    v_mul_f32 v78, v249, v78
    v_mul_f32 v79, v249, v79
    v_mul_f32 v80, v249, v80
    v_mul_f32 v81, v249, v81
    v_mul_f32 v82, v249, v82
    v_mul_f32 v83, v249, v83
    v_mul_f32 v84, v249, v84
    v_mul_f32 v85, v249, v85
    v_mul_f32 v86, v249, v86
    v_mul_f32 v87, v249, v87
    v_mul_f32 v88, v249, v88
    v_mul_f32 v89, v249, v89
    v_mul_f32 v90, v249, v90
    v_mul_f32 v91, v249, v91
    v_mul_f32 v92, v249, v92
    v_mul_f32 v93, v249, v93
    v_mul_f32 v94, v249, v94
    v_mul_f32 v95, v249, v95
    v_exp_f32 v252, v136
    v_exp_f32 v253, v137
    s_nop 0
    v_add_f32_e64 v246, v252, v253
    v_cvt_pk_bf16_f32 v188, v252, v253
    v_exp_f32 v248, v138
    v_exp_f32 v249, v139
    v_add_f32 v246, v246, v248
    v_add_f32 v246, v246, v249
    v_cvt_pk_bf16_f32 v189, v248, v249
    v_exp_f32 v250, v140
    v_exp_f32 v251, v141
    v_add_f32 v246, v246, v250
    v_add_f32 v246, v246, v251
    v_cvt_pk_bf16_f32 v190, v250, v251
    v_exp_f32 v252, v142
    v_exp_f32 v253, v143
    v_add_f32 v246, v246, v252
    v_add_f32 v246, v246, v253
    v_cvt_pk_bf16_f32 v191, v252, v253
    s_nop 3
    s_branch L_ret0B
L_slow1A0:
    s_nop 15
    v_max3_f32 v248, v168, v169, v170
    v_max3_f32 v250, v171, v172, v173
    v_max3_f32 v248, v248, v174, v175
    v_max_f32 v248, v248, v250
    v_mov_b32 v250, v248
    s_nop 1
    v_permlane16_swap_b32 v248, v250
    v_max_f32 v248, v248, v250
    v_mov_b32 v250, v248
    s_nop 1
    v_permlane32_swap_b32 v248, v250
    v_max_f32 v248, v248, v250
    v_max_f32 v248, 0, v248
    v_sub_f32 v249, 0, v248
    v_exp_f32 v249, v249
    v_sub_f32 v220, v220, v248
    v_sub_f32 v221, v221, v248
    v_sub_f32 v222, v222, v248
    v_sub_f32 v223, v223, v248
    v_sub_f32 v168, v168, v248
    v_sub_f32 v169, v169, v248
    v_sub_f32 v170, v170, v248
    v_sub_f32 v171, v171, v248
    v_sub_f32 v172, v172, v248
    v_sub_f32 v173, v173, v248
    v_sub_f32 v174, v174, v248
    v_sub_f32 v175, v175, v248
    v_sub_f32 v152, v152, v248
    v_sub_f32 v153, v153, v248
    v_sub_f32 v154, v154, v248
    v_sub_f32 v155, v155, v248
    v_sub_f32 v156, v156, v248
    v_sub_f32 v157, v157, v248
    v_sub_f32 v158, v158, v248
    v_sub_f32 v159, v159, v248
    v_mul_f32 v234, v249, v234
    v_mul_f32 v96, v249, v96
    v_mul_f32 v97, v249, v97
    v_mul_f32 v98, v249, v98
    v_mul_f32 v99, v249, v99
    v_mul_f32 v100, v249, v100
    v_mul_f32 v101, v249, v101
    v_mul_f32 v102, v249, v102
    v_mul_f32 v103, v249, v103
    v_mul_f32 v104, v249, v104
    v_mul_f32 v105, v249, v105
    v_mul_f32 v106, v249, v106
    v_mul_f32 v107, v249, v107
    v_mul_f32 v108, v249, v108
    v_mul_f32 v109, v249, v109
    v_mul_f32 v110, v249, v110
    v_mul_f32 v111, v249, v111
    v_mul_f32 v112, v249, v112
    v_mul_f32 v113, v249, v113
    v_mul_f32 v114, v249, v114
    v_mul_f32 v115, v249, v115
    v_mul_f32 v116, v249, v116
    v_mul_f32 v117, v249, v117
    v_mul_f32 v118, v249, v118
    v_mul_f32 v119, v249, v119
    v_mul_f32 v120, v249, v120
    v_mul_f32 v121, v249, v121
    v_mul_f32 v122, v249, v122
    v_mul_f32 v123, v249, v123
    v_mul_f32 v124, v249, v124
    v_mul_f32 v125, v249, v125
    v_mul_f32 v126, v249, v126
    v_mul_f32 v127, v249, v127
    v_accvgpr_read_b32 v250, a216
    v_mul_f32_e64 v250, v249, v250
    v_accvgpr_write_b32 a216, v250
    v_accvgpr_read_b32 v251, a217
    v_mul_f32_e64 v251, v249, v251
    v_accvgpr_write_b32 a217, v251
    v_accvgpr_read_b32 v250, a218
    v_mul_f32_e64 v250, v249, v250
    v_accvgpr_write_b32 a218, v250
    v_accvgpr_read_b32 v251, a219
    v_mul_f32_e64 v251, v249, v251
    v_accvgpr_write_b32 a219, v251
    v_accvgpr_read_b32 v250, a220
    v_mul_f32_e64 v250, v249, v250
    v_accvgpr_write_b32 a220, v250
    v_accvgpr_read_b32 v251, a221
    v_mul_f32_e64 v251, v249, v251
    v_accvgpr_write_b32 a221, v251
    v_accvgpr_read_b32 v250, a222
    v_mul_f32_e64 v250, v249, v250
    v_accvgpr_write_b32 a222, v250
    v_accvgpr_read_b32 v251, a223
    v_mul_f32_e64 v251, v249, v251
    v_accvgpr_write_b32 a223, v251
    v_accvgpr_read_b32 v250, a224
    v_mul_f32_e64 v250, v249, v250
    v_accvgpr_write_b32 a224, v250
    v_accvgpr_read_b32 v251, a225
    v_mul_f32_e64 v251, v249, v251
    v_accvgpr_write_b32 a225, v251
    v_accvgpr_read_b32 v250, a226
    v_mul_f32_e64 v250, v249, v250
    v_accvgpr_write_b32 a226, v250
    v_accvgpr_read_b32 v251, a227
    v_mul_f32_e64 v251, v249, v251
    v_accvgpr_write_b32 a227, v251
    v_accvgpr_read_b32 v250, a228
    v_mul_f32_e64 v250, v249, v250
    v_accvgpr_write_b32 a228, v250
    v_accvgpr_read_b32 v251, a229
    v_mul_f32_e64 v251, v249, v251
    v_accvgpr_write_b32 a229, v251
    v_accvgpr_read_b32 v250, a230
    v_mul_f32_e64 v250, v249, v250
    v_accvgpr_write_b32 a230, v250
    v_accvgpr_read_b32 v251, a231
    v_mul_f32_e64 v251, v249, v251
    v_accvgpr_write_b32 a231, v251
    v_exp_f32 v251, v168
    v_exp_f32 v252, v169
    s_nop 0
    v_add_f32 v245, v251, v252
    v_cvt_pk_bf16_f32 v200, v251, v252
    v_exp_f32 v253, v170
    v_exp_f32 v248, v171
    v_add_f32 v245, v245, v253
    v_add_f32 v245, v245, v248
    v_cvt_pk_bf16_f32 v201, v253, v248
    v_exp_f32 v249, v172
    v_exp_f32 v250, v173
    v_add_f32 v245, v245, v249
    v_add_f32 v245, v245, v250
    v_cvt_pk_bf16_f32 v202, v249, v250
    v_exp_f32 v251, v174
    v_exp_f32 v252, v175
    v_add_f32 v245, v245, v251
    v_add_f32 v245, v245, v252
    v_cvt_pk_bf16_f32 v203, v251, v252
    v_max3_f32 v248, v176, v177, v178
    v_max3_f32 v250, v179, v180, v181
    v_max3_f32 v248, v248, v182, v183
    v_max_f32 v248, v248, v250
    v_mov_b32 v250, v248
    s_nop 1
    v_permlane16_swap_b32 v248, v250
    v_max_f32 v248, v248, v250
    v_mov_b32 v250, v248
    s_nop 1
    v_permlane32_swap_b32 v248, v250
    v_max_f32 v248, v248, v250
    v_max_f32 v248, 0, v248
    v_sub_f32 v249, 0, v248
    v_exp_f32 v249, v249
    v_sub_f32 v224, v224, v248
    v_sub_f32 v225, v225, v248
    v_sub_f32 v226, v226, v248
    v_sub_f32 v227, v227, v248
    v_sub_f32 v176, v176, v248
    v_sub_f32 v177, v177, v248
    v_sub_f32 v178, v178, v248
    v_sub_f32 v179, v179, v248
    v_sub_f32 v180, v180, v248
    v_sub_f32 v181, v181, v248
    v_sub_f32 v182, v182, v248
    v_sub_f32 v183, v183, v248
    v_sub_f32 v160, v160, v248
    v_sub_f32 v161, v161, v248
    v_sub_f32 v162, v162, v248
    v_sub_f32 v163, v163, v248
    v_sub_f32 v164, v164, v248
    v_sub_f32 v165, v165, v248
    v_sub_f32 v166, v166, v248
    v_sub_f32 v167, v167, v248
    v_mul_f32_e64 v235, v249, v235
    v_accvgpr_read_b32 v250, a168
    v_mul_f32_e64 v250, v249, v250
    v_accvgpr_write_b32 a168, v250
    v_accvgpr_read_b32 v251, a169
    v_mul_f32_e64 v251, v249, v251
    v_accvgpr_write_b32 a169, v251
    v_accvgpr_read_b32 v250, a170
    v_mul_f32_e64 v250, v249, v250
    v_accvgpr_write_b32 a170, v250
    v_accvgpr_read_b32 v251, a171
    v_mul_f32_e64 v251, v249, v251
    v_accvgpr_write_b32 a171, v251
    v_accvgpr_read_b32 v250, a172
    v_mul_f32_e64 v250, v249, v250
    v_accvgpr_write_b32 a172, v250
    v_accvgpr_read_b32 v251, a173
    v_mul_f32_e64 v251, v249, v251
    v_accvgpr_write_b32 a173, v251
    v_accvgpr_read_b32 v250, a174
    v_mul_f32_e64 v250, v249, v250
    v_accvgpr_write_b32 a174, v250
    v_accvgpr_read_b32 v251, a175
    v_mul_f32_e64 v251, v249, v251
    v_accvgpr_write_b32 a175, v251
    v_accvgpr_read_b32 v250, a176
    v_mul_f32_e64 v250, v249, v250
    v_accvgpr_write_b32 a176, v250
    v_accvgpr_read_b32 v251, a177
    v_mul_f32_e64 v251, v249, v251
    v_accvgpr_write_b32 a177, v251
    v_accvgpr_read_b32 v250, a178
    v_mul_f32_e64 v250, v249, v250
    v_accvgpr_write_b32 a178, v250
    v_accvgpr_read_b32 v251, a179
    v_mul_f32_e64 v251, v249, v251
    v_accvgpr_write_b32 a179, v251
    v_accvgpr_read_b32 v250, a180
    v_mul_f32_e64 v250, v249, v250
    v_accvgpr_write_b32 a180, v250
    v_accvgpr_read_b32 v251, a181
    v_mul_f32_e64 v251, v249, v251
    v_accvgpr_write_b32 a181, v251
    v_accvgpr_read_b32 v250, a182
    v_mul_f32_e64 v250, v249, v250
    v_accvgpr_write_b32 a182, v250
    v_accvgpr_read_b32 v251, a183
    v_mul_f32_e64 v251, v249, v251
    v_accvgpr_write_b32 a183, v251
    v_accvgpr_read_b32 v250, a184
    v_mul_f32_e64 v250, v249, v250
    v_accvgpr_write_b32 a184, v250
    v_accvgpr_read_b32 v251, a185
    v_mul_f32_e64 v251, v249, v251
    v_accvgpr_write_b32 a185, v251
    v_accvgpr_read_b32 v250, a186
    v_mul_f32_e64 v250, v249, v250
    v_accvgpr_write_b32 a186, v250
    v_accvgpr_read_b32 v251, a187
    v_mul_f32_e64 v251, v249, v251
    v_accvgpr_write_b32 a187, v251
    v_accvgpr_read_b32 v250, a188
    v_mul_f32_e64 v250, v249, v250
    v_accvgpr_write_b32 a188, v250
    v_accvgpr_read_b32 v251, a189
    v_mul_f32_e64 v251, v249, v251
    v_accvgpr_write_b32 a189, v251
    v_accvgpr_read_b32 v250, a190
    v_mul_f32_e64 v250, v249, v250
    v_accvgpr_write_b32 a190, v250
    v_accvgpr_read_b32 v251, a191
    v_mul_f32_e64 v251, v249, v251
    v_accvgpr_write_b32 a191, v251
    v_accvgpr_read_b32 v250, a192
    v_mul_f32_e64 v250, v249, v250
    v_accvgpr_write_b32 a192, v250
    v_accvgpr_read_b32 v251, a193
    v_mul_f32_e64 v251, v249, v251
    v_accvgpr_write_b32 a193, v251
    v_accvgpr_read_b32 v250, a194
    v_mul_f32_e64 v250, v249, v250
    v_accvgpr_write_b32 a194, v250
    v_accvgpr_read_b32 v251, a195
    v_mul_f32_e64 v251, v249, v251
    v_accvgpr_write_b32 a195, v251
    v_accvgpr_read_b32 v250, a196
    v_mul_f32_e64 v250, v249, v250
    v_accvgpr_write_b32 a196, v250
    v_accvgpr_read_b32 v251, a197
    v_mul_f32_e64 v251, v249, v251
    v_accvgpr_write_b32 a197, v251
    v_accvgpr_read_b32 v250, a198
    v_mul_f32_e64 v250, v249, v250
    v_accvgpr_write_b32 a198, v250
    v_accvgpr_read_b32 v251, a199
    v_mul_f32_e64 v251, v249, v251
    v_accvgpr_write_b32 a199, v251
    v_accvgpr_read_b32 v250, a200
    v_mul_f32_e64 v250, v249, v250
    v_accvgpr_write_b32 a200, v250
    v_accvgpr_read_b32 v251, a201
    v_mul_f32_e64 v251, v249, v251
    v_accvgpr_write_b32 a201, v251
    v_accvgpr_read_b32 v250, a202
    v_mul_f32_e64 v250, v249, v250
    v_accvgpr_write_b32 a202, v250
    v_accvgpr_read_b32 v251, a203
    v_mul_f32_e64 v251, v249, v251
    v_accvgpr_write_b32 a203, v251
    v_accvgpr_read_b32 v250, a204
    v_mul_f32_e64 v250, v249, v250
    v_accvgpr_write_b32 a204, v250
    v_accvgpr_read_b32 v251, a205
    v_mul_f32_e64 v251, v249, v251
    v_accvgpr_write_b32 a205, v251
    v_accvgpr_read_b32 v250, a206
    v_mul_f32_e64 v250, v249, v250
    v_accvgpr_write_b32 a206, v250
    v_accvgpr_read_b32 v251, a207
    v_mul_f32_e64 v251, v249, v251
    v_accvgpr_write_b32 a207, v251
    v_accvgpr_read_b32 v250, a208
    v_mul_f32_e64 v250, v249, v250
    v_accvgpr_write_b32 a208, v250
    v_accvgpr_read_b32 v251, a209
    v_mul_f32_e64 v251, v249, v251
    v_accvgpr_write_b32 a209, v251
    v_accvgpr_read_b32 v250, a210
    v_mul_f32_e64 v250, v249, v250
    v_accvgpr_write_b32 a210, v250
    v_accvgpr_read_b32 v251, a211
    v_mul_f32_e64 v251, v249, v251
    v_accvgpr_write_b32 a211, v251
    v_accvgpr_read_b32 v250, a212
    v_mul_f32_e64 v250, v249, v250
    v_accvgpr_write_b32 a212, v250
    v_accvgpr_read_b32 v251, a213
    v_mul_f32_e64 v251, v249, v251
    v_accvgpr_write_b32 a213, v251
    v_accvgpr_read_b32 v250, a214
    v_mul_f32_e64 v250, v249, v250
    v_accvgpr_write_b32 a214, v250
    v_accvgpr_read_b32 v251, a215
    v_mul_f32_e64 v251, v249, v251
    v_accvgpr_write_b32 a215, v251
    v_exp_f32 v253, v176
    v_exp_f32 v248, v177
    s_nop 0
    v_add_f32 v246, v253, v248
    v_cvt_pk_bf16_f32 v204, v253, v248
    v_exp_f32 v249, v178
    v_exp_f32 v250, v179
    v_add_f32 v246, v246, v249
    v_add_f32 v246, v246, v250
    v_cvt_pk_bf16_f32 v205, v249, v250
    v_exp_f32 v251, v180
    v_exp_f32 v252, v181
    v_add_f32 v246, v246, v251
    v_add_f32 v246, v246, v252
    v_cvt_pk_bf16_f32 v206, v251, v252
    v_exp_f32 v253, v182
    v_exp_f32 v248, v183
    v_add_f32 v246, v246, v253
    v_add_f32 v246, v246, v248
    v_cvt_pk_bf16_f32 v207, v253, v248
    v_max3_f32 v248, v144, v145, v146
    v_max3_f32 v250, v147, v148, v149
    v_max3_f32 v248, v248, v150, v151
    v_max_f32 v248, v248, v250
    v_mov_b32 v250, v248
    s_nop 1
    v_permlane16_swap_b32 v248, v250
    v_max_f32 v248, v248, v250
    v_mov_b32 v250, v248
    s_nop 1
    v_permlane32_swap_b32 v248, v250
    v_max_f32 v248, v248, v250
    v_max_f32 v248, 0, v248
    v_sub_f32 v249, 0, v248
    v_exp_f32 v249, v249
    v_sub_f32 v228, v228, v248
    v_sub_f32 v229, v229, v248
    v_sub_f32 v230, v230, v248
    v_sub_f32 v231, v231, v248
    v_sub_f32 v144, v144, v248
    v_sub_f32 v145, v145, v248
    v_sub_f32 v146, v146, v248
    v_sub_f32 v147, v147, v248
    v_sub_f32 v148, v148, v248
    v_sub_f32 v149, v149, v248
    v_sub_f32 v150, v150, v248
    v_sub_f32 v151, v151, v248
    v_mul_f32_e64 v236, v249, v236
    v_accvgpr_read_b32 v250, a120
    v_mul_f32_e64 v250, v249, v250
    v_accvgpr_write_b32 a120, v250
    v_accvgpr_read_b32 v251, a121
    v_mul_f32_e64 v251, v249, v251
    v_accvgpr_write_b32 a121, v251
    v_accvgpr_read_b32 v250, a122
    v_mul_f32_e64 v250, v249, v250
    v_accvgpr_write_b32 a122, v250
    v_accvgpr_read_b32 v251, a123
    v_mul_f32_e64 v251, v249, v251
    v_accvgpr_write_b32 a123, v251
    v_accvgpr_read_b32 v250, a124
    v_mul_f32_e64 v250, v249, v250
    v_accvgpr_write_b32 a124, v250
    v_accvgpr_read_b32 v251, a125
    v_mul_f32_e64 v251, v249, v251
    v_accvgpr_write_b32 a125, v251
    v_accvgpr_read_b32 v250, a126
    v_mul_f32_e64 v250, v249, v250
    v_accvgpr_write_b32 a126, v250
    v_accvgpr_read_b32 v251, a127
    v_mul_f32_e64 v251, v249, v251
    v_accvgpr_write_b32 a127, v251
    v_accvgpr_read_b32 v250, a128
    v_mul_f32_e64 v250, v249, v250
    v_accvgpr_write_b32 a128, v250
    v_accvgpr_read_b32 v251, a129
    v_mul_f32_e64 v251, v249, v251
    v_accvgpr_write_b32 a129, v251
    v_accvgpr_read_b32 v250, a130
    v_mul_f32_e64 v250, v249, v250
    v_accvgpr_write_b32 a130, v250
    v_accvgpr_read_b32 v251, a131
    v_mul_f32_e64 v251, v249, v251
    v_accvgpr_write_b32 a131, v251
    v_accvgpr_read_b32 v250, a132
    v_mul_f32_e64 v250, v249, v250
    v_accvgpr_write_b32 a132, v250
    v_accvgpr_read_b32 v251, a133
    v_mul_f32_e64 v251, v249, v251
    v_accvgpr_write_b32 a133, v251
    v_accvgpr_read_b32 v250, a134
    v_mul_f32_e64 v250, v249, v250
    v_accvgpr_write_b32 a134, v250
    v_accvgpr_read_b32 v251, a135
    v_mul_f32_e64 v251, v249, v251
    v_accvgpr_write_b32 a135, v251
    v_accvgpr_read_b32 v250, a136
    v_mul_f32_e64 v250, v249, v250
    v_accvgpr_write_b32 a136, v250
    v_accvgpr_read_b32 v251, a137
    v_mul_f32_e64 v251, v249, v251
    v_accvgpr_write_b32 a137, v251
    v_accvgpr_read_b32 v250, a138
    v_mul_f32_e64 v250, v249, v250
    v_accvgpr_write_b32 a138, v250
    v_accvgpr_read_b32 v251, a139
    v_mul_f32_e64 v251, v249, v251
    v_accvgpr_write_b32 a139, v251
    v_accvgpr_read_b32 v250, a140
    v_mul_f32_e64 v250, v249, v250
    v_accvgpr_write_b32 a140, v250
    v_accvgpr_read_b32 v251, a141
    v_mul_f32_e64 v251, v249, v251
    v_accvgpr_write_b32 a141, v251
    v_accvgpr_read_b32 v250, a142
    v_mul_f32_e64 v250, v249, v250
    v_accvgpr_write_b32 a142, v250
    v_accvgpr_read_b32 v251, a143
    v_mul_f32_e64 v251, v249, v251
    v_accvgpr_write_b32 a143, v251
    v_accvgpr_read_b32 v250, a144
    v_mul_f32_e64 v250, v249, v250
    v_accvgpr_write_b32 a144, v250
    v_accvgpr_read_b32 v251, a145
    v_mul_f32_e64 v251, v249, v251
    v_accvgpr_write_b32 a145, v251
    v_accvgpr_read_b32 v250, a146
    v_mul_f32_e64 v250, v249, v250
    v_accvgpr_write_b32 a146, v250
    v_accvgpr_read_b32 v251, a147
    v_mul_f32_e64 v251, v249, v251
    v_accvgpr_write_b32 a147, v251
    v_accvgpr_read_b32 v250, a148
    v_mul_f32_e64 v250, v249, v250
    v_accvgpr_write_b32 a148, v250
    v_accvgpr_read_b32 v251, a149
    v_mul_f32_e64 v251, v249, v251
    v_accvgpr_write_b32 a149, v251
    v_accvgpr_read_b32 v250, a150
    v_mul_f32_e64 v250, v249, v250
    v_accvgpr_write_b32 a150, v250
    v_accvgpr_read_b32 v251, a151
    v_mul_f32_e64 v251, v249, v251
    v_accvgpr_write_b32 a151, v251
    v_accvgpr_read_b32 v250, a152
    v_mul_f32_e64 v250, v249, v250
    v_accvgpr_write_b32 a152, v250
    v_accvgpr_read_b32 v251, a153
    v_mul_f32_e64 v251, v249, v251
    v_accvgpr_write_b32 a153, v251
    v_accvgpr_read_b32 v250, a154
    v_mul_f32_e64 v250, v249, v250
    v_accvgpr_write_b32 a154, v250
    v_accvgpr_read_b32 v251, a155
    v_mul_f32_e64 v251, v249, v251
    v_accvgpr_write_b32 a155, v251
    v_accvgpr_read_b32 v250, a156
    v_mul_f32_e64 v250, v249, v250
    v_accvgpr_write_b32 a156, v250
    v_accvgpr_read_b32 v251, a157
    v_mul_f32_e64 v251, v249, v251
    v_accvgpr_write_b32 a157, v251
    v_accvgpr_read_b32 v250, a158
    v_mul_f32_e64 v250, v249, v250
    v_accvgpr_write_b32 a158, v250
    v_accvgpr_read_b32 v251, a159
    v_mul_f32_e64 v251, v249, v251
    v_accvgpr_write_b32 a159, v251
    v_accvgpr_read_b32 v250, a160
    v_mul_f32_e64 v250, v249, v250
    v_accvgpr_write_b32 a160, v250
    v_accvgpr_read_b32 v251, a161
    v_mul_f32_e64 v251, v249, v251
    v_accvgpr_write_b32 a161, v251
    v_accvgpr_read_b32 v250, a162
    v_mul_f32_e64 v250, v249, v250
    v_accvgpr_write_b32 a162, v250
    v_accvgpr_read_b32 v251, a163
    v_mul_f32_e64 v251, v249, v251
    v_accvgpr_write_b32 a163, v251
    v_accvgpr_read_b32 v250, a164
    v_mul_f32_e64 v250, v249, v250
    v_accvgpr_write_b32 a164, v250
    v_accvgpr_read_b32 v251, a165
    v_mul_f32_e64 v251, v249, v251
    v_accvgpr_write_b32 a165, v251
    v_accvgpr_read_b32 v250, a166
    v_mul_f32_e64 v250, v249, v250
    v_accvgpr_write_b32 a166, v250
    v_accvgpr_read_b32 v251, a167
    v_mul_f32_e64 v251, v249, v251
    v_accvgpr_write_b32 a167, v251
    v_exp_f32 v249, v144
    v_exp_f32 v250, v145
    s_nop 0
    v_add_f32 v247, v249, v250
    v_cvt_pk_bf16_f32 v208, v249, v250
    v_exp_f32 v251, v146
    v_exp_f32 v252, v147
    v_add_f32 v247, v247, v251
    v_add_f32 v247, v247, v252
    v_cvt_pk_bf16_f32 v209, v251, v252
    v_exp_f32 v253, v148
    v_exp_f32 v248, v149
    v_add_f32 v247, v247, v253
    v_add_f32 v247, v247, v248
    v_cvt_pk_bf16_f32 v210, v253, v248
    v_exp_f32 v249, v150
    v_exp_f32 v250, v151
    v_add_f32 v247, v247, v249
    v_add_f32 v247, v247, v250
    v_cvt_pk_bf16_f32 v211, v249, v250
    s_nop 3
    s_branch L_ret1A0
L_slow0A0:
    s_nop 15
    v_max3_f32 v248, v128, v129, v130
    v_max3_f32 v250, v131, v132, v133
    v_max3_f32 v248, v248, v134, v135
    v_max_f32 v248, v248, v250
    v_mov_b32 v250, v248
    s_nop 1
    v_permlane16_swap_b32 v248, v250
    v_max_f32 v248, v248, v250
    v_mov_b32 v250, v248
    s_nop 1
    v_permlane32_swap_b32 v248, v250
    v_max_f32 v248, v248, v250
    v_max_f32 v248, 0, v248
    v_sub_f32 v249, 0, v248
    v_exp_f32 v249, v249
    v_sub_f32 v212, v212, v248
    v_sub_f32 v213, v213, v248
    v_sub_f32 v214, v214, v248
    v_sub_f32 v215, v215, v248
    v_sub_f32 v128, v128, v248
    v_sub_f32 v129, v129, v248
    v_sub_f32 v130, v130, v248
    v_sub_f32 v131, v131, v248
    v_sub_f32 v132, v132, v248
    v_sub_f32 v133, v133, v248
    v_sub_f32 v134, v134, v248
    v_sub_f32 v135, v135, v248
    v_mul_f32 v232, v249, v232
    v_mul_f32 v0, v249, v0
    v_mul_f32 v1, v249, v1
    v_mul_f32 v2, v249, v2
    v_mul_f32 v3, v249, v3
    v_mul_f32 v4, v249, v4
    v_mul_f32 v5, v249, v5
    v_mul_f32 v6, v249, v6
    v_mul_f32 v7, v249, v7
    v_mul_f32 v8, v249, v8
    v_mul_f32 v9, v249, v9
    v_mul_f32 v10, v249, v10
    v_mul_f32 v11, v249, v11
    v_mul_f32 v12, v249, v12
    v_mul_f32 v13, v249, v13
    v_mul_f32 v14, v249, v14
    v_mul_f32 v15, v249, v15
    v_mul_f32 v16, v249, v16
    v_mul_f32 v17, v249, v17
    v_mul_f32 v18, v249, v18
    v_mul_f32 v19, v249, v19
    v_mul_f32 v20, v249, v20
    v_mul_f32 v21, v249, v21
    v_mul_f32 v22, v249, v22
    v_mul_f32 v23, v249, v23
    v_mul_f32 v24, v249, v24
    v_mul_f32 v25, v249, v25
    v_mul_f32 v26, v249, v26
    v_mul_f32 v27, v249, v27
    v_mul_f32 v28, v249, v28
    v_mul_f32 v29, v249, v29
    v_mul_f32 v30, v249, v30
    v_mul_f32 v31, v249, v31
    v_mul_f32 v32, v249, v32
    v_mul_f32 v33, v249, v33
    v_mul_f32 v34, v249, v34
    v_mul_f32 v35, v249, v35
    v_mul_f32 v36, v249, v36
    v_mul_f32 v37, v249, v37
    v_mul_f32 v38, v249, v38
    v_mul_f32 v39, v249, v39
    v_mul_f32 v40, v249, v40
    v_mul_f32 v41, v249, v41
    v_mul_f32 v42, v249, v42
    v_mul_f32 v43, v249, v43
    v_mul_f32 v44, v249, v44
    v_mul_f32 v45, v249, v45
    v_mul_f32 v46, v249, v46
    v_mul_f32 v47, v249, v47
    v_exp_f32 v250, v128
    v_exp_f32 v251, v129
    s_nop 0
    v_add_f32 v254, v250, v251
    v_cvt_pk_bf16_f32 v192, v250, v251
    v_exp_f32 v252, v130
    v_exp_f32 v253, v131
    v_add_f32 v254, v254, v252
    v_add_f32 v254, v254, v253
    v_cvt_pk_bf16_f32 v193, v252, v253
    v_exp_f32 v248, v132
    v_exp_f32 v249, v133
    v_add_f32 v254, v254, v248
    v_add_f32 v254, v254, v249
    v_cvt_pk_bf16_f32 v194, v248, v249
    v_exp_f32 v250, v134
    v_exp_f32 v251, v135
    v_add_f32 v254, v254, v250
    v_add_f32 v254, v254, v251
    v_cvt_pk_bf16_f32 v195, v250, v251
    v_max3_f32 v248, v136, v137, v138
    v_max3_f32 v250, v139, v140, v141
    v_max3_f32 v248, v248, v142, v143
    v_max_f32 v248, v248, v250
    v_mov_b32 v250, v248
    s_nop 1
    v_permlane16_swap_b32 v248, v250
    v_max_f32 v248, v248, v250
    v_mov_b32 v250, v248
    s_nop 1
    v_permlane32_swap_b32 v248, v250
    v_max_f32 v248, v248, v250
    v_max_f32 v248, 0, v248
    v_sub_f32 v249, 0, v248
    v_exp_f32 v249, v249
    v_sub_f32 v216, v216, v248
    v_sub_f32 v217, v217, v248
    v_sub_f32 v218, v218, v248
    v_sub_f32 v219, v219, v248
    v_sub_f32 v136, v136, v248
    v_sub_f32 v137, v137, v248
    v_sub_f32 v138, v138, v248
    v_sub_f32 v139, v139, v248
    v_sub_f32 v140, v140, v248
    v_sub_f32 v141, v141, v248
    v_sub_f32 v142, v142, v248
    v_sub_f32 v143, v143, v248
    v_mul_f32 v233, v249, v233
    v_mul_f32 v48, v249, v48
    v_mul_f32 v49, v249, v49
    v_mul_f32 v50, v249, v50
    v_mul_f32 v51, v249, v51
    v_mul_f32 v52, v249, v52
    v_mul_f32 v53, v249, v53
    v_mul_f32 v54, v249, v54
    v_mul_f32 v55, v249, v55
    v_mul_f32 v56, v249, v56
    v_mul_f32 v57, v249, v57
    v_mul_f32 v58, v249, v58
    v_mul_f32 v59, v249, v59
    v_mul_f32 v60, v249, v60
    v_mul_f32 v61, v249, v61
    v_mul_f32 v62, v249, v62
    v_mul_f32 v63, v249, v63
    v_mul_f32 v64, v249, v64
    v_mul_f32 v65, v249, v65
    v_mul_f32 v66, v249, v66
    v_mul_f32 v67, v249, v67
    v_mul_f32 v68, v249, v68
    v_mul_f32 v69, v249, v69
    v_mul_f32 v70, v249, v70
    v_mul_f32 v71, v249, v71
    v_mul_f32 v72, v249, v72
    v_mul_f32 v73, v249, v73
    v_mul_f32 v74, v249, v74
    v_mul_f32 v75, v249, v75
    v_mul_f32 v76, v249, v76
    v_mul_f32 v77, v249, v77
    v_mul_f32 v78, v249, v78
    v_mul_f32 v79, v249, v79
    v_mul_f32 v80, v249, v80
    v_mul_f32 v81, v249, v81
    v_mul_f32 v82, v249, v82
    v_mul_f32 v83, v249, v83
    v_mul_f32 v84, v249, v84
    v_mul_f32 v85, v249, v85
    v_mul_f32 v86, v249, v86
    v_mul_f32 v87, v249, v87
    v_mul_f32 v88, v249, v88
    v_mul_f32 v89, v249, v89
    v_mul_f32 v90, v249, v90
    v_mul_f32 v91, v249, v91
    v_mul_f32 v92, v249, v92
    v_mul_f32 v93, v249, v93
    v_mul_f32 v94, v249, v94
    v_mul_f32 v95, v249, v95
    v_exp_f32 v252, v136
    v_exp_f32 v253, v137
    s_nop 0
    v_add_f32_e64 v246, v252, v253
    v_cvt_pk_bf16_f32 v196, v252, v253
    v_exp_f32 v248, v138
    v_exp_f32 v249, v139
    v_add_f32 v246, v246, v248
    v_add_f32 v246, v246, v249
    v_cvt_pk_bf16_f32 v197, v248, v249
    v_exp_f32 v250, v140
    v_exp_f32 v251, v141
    v_add_f32 v246, v246, v250
    v_add_f32 v246, v246, v251
    v_cvt_pk_bf16_f32 v198, v250, v251
    v_exp_f32 v252, v142
    v_exp_f32 v253, v143
    v_add_f32 v246, v246, v252
    v_add_f32 v246, v246, v253
    v_cvt_pk_bf16_f32 v199, v252, v253
    s_nop 3
    s_branch L_ret0A0
L_slow1B0:
    s_nop 15
    v_max3_f32 v248, v152, v153, v154
    v_max3_f32 v250, v155, v156, v157
    v_max3_f32 v248, v248, v158, v159
    v_max_f32 v248, v248, v250
    v_mov_b32 v250, v248
    s_nop 1
    v_permlane16_swap_b32 v248, v250
    v_max_f32 v248, v248, v250
    v_mov_b32 v250, v248
    s_nop 1
    v_permlane32_swap_b32 v248, v250
    v_max_f32 v248, v248, v250
    v_max_f32 v248, 0, v248
    v_sub_f32 v249, 0, v248
    v_exp_f32 v249, v249
    v_sub_f32 v220, v220, v248
    v_sub_f32 v221, v221, v248
    v_sub_f32 v222, v222, v248
    v_sub_f32 v223, v223, v248
    v_sub_f32 v152, v152, v248
    v_sub_f32 v153, v153, v248
    v_sub_f32 v154, v154, v248
    v_sub_f32 v155, v155, v248
    v_sub_f32 v156, v156, v248
    v_sub_f32 v157, v157, v248
    v_sub_f32 v158, v158, v248
    v_sub_f32 v159, v159, v248
    v_sub_f32 v168, v168, v248
    v_sub_f32 v169, v169, v248
    v_sub_f32 v170, v170, v248
    v_sub_f32 v171, v171, v248
    v_sub_f32 v172, v172, v248
    v_sub_f32 v173, v173, v248
    v_sub_f32 v174, v174, v248
    v_sub_f32 v175, v175, v248
    v_mul_f32 v234, v249, v234
    v_mul_f32 v96, v249, v96
    v_mul_f32 v97, v249, v97
    v_mul_f32 v98, v249, v98
    v_mul_f32 v99, v249, v99
    v_mul_f32 v100, v249, v100
    v_mul_f32 v101, v249, v101
    v_mul_f32 v102, v249, v102
    v_mul_f32 v103, v249, v103
    v_mul_f32 v104, v249, v104
    v_mul_f32 v105, v249, v105
    v_mul_f32 v106, v249, v106
    v_mul_f32 v107, v249, v107
    v_mul_f32 v108, v249, v108
    v_mul_f32 v109, v249, v109
    v_mul_f32 v110, v249, v110
    v_mul_f32 v111, v249, v111
    v_mul_f32 v112, v249, v112
    v_mul_f32 v113, v249, v113
    v_mul_f32 v114, v249, v114
    v_mul_f32 v115, v249, v115
    v_mul_f32 v116, v249, v116
    v_mul_f32 v117, v249, v117
    v_mul_f32 v118, v249, v118
    v_mul_f32 v119, v249, v119
    v_mul_f32 v120, v249, v120
    v_mul_f32 v121, v249, v121
    v_mul_f32 v122, v249, v122
    v_mul_f32 v123, v249, v123
    v_mul_f32 v124, v249, v124
    v_mul_f32 v125, v249, v125
    v_mul_f32 v126, v249, v126
    v_mul_f32 v127, v249, v127
    v_accvgpr_read_b32 v250, a216
    v_mul_f32_e64 v250, v249, v250
    v_accvgpr_write_b32 a216, v250
    v_accvgpr_read_b32 v251, a217
    v_mul_f32_e64 v251, v249, v251
    v_accvgpr_write_b32 a217, v251
    v_accvgpr_read_b32 v250, a218
    v_mul_f32_e64 v250, v249, v250
    v_accvgpr_write_b32 a218, v250
    v_accvgpr_read_b32 v251, a219
    v_mul_f32_e64 v251, v249, v251
    v_accvgpr_write_b32 a219, v251
    v_accvgpr_read_b32 v250, a220
    v_mul_f32_e64 v250, v249, v250
    v_accvgpr_write_b32 a220, v250
    v_accvgpr_read_b32 v251, a221
    v_mul_f32_e64 v251, v249, v251
    v_accvgpr_write_b32 a221, v251
    v_accvgpr_read_b32 v250, a222
    v_mul_f32_e64 v250, v249, v250
    v_accvgpr_write_b32 a222, v250
    v_accvgpr_read_b32 v251, a223
    v_mul_f32_e64 v251, v249, v251
    v_accvgpr_write_b32 a223, v251
    v_accvgpr_read_b32 v250, a224
    v_mul_f32_e64 v250, v249, v250
    v_accvgpr_write_b32 a224, v250
    v_accvgpr_read_b32 v251, a225
    v_mul_f32_e64 v251, v249, v251
    v_accvgpr_write_b32 a225, v251
    v_accvgpr_read_b32 v250, a226
    v_mul_f32_e64 v250, v249, v250
    v_accvgpr_write_b32 a226, v250
    v_accvgpr_read_b32 v251, a227
    v_mul_f32_e64 v251, v249, v251
    v_accvgpr_write_b32 a227, v251
    v_accvgpr_read_b32 v250, a228
    v_mul_f32_e64 v250, v249, v250
    v_accvgpr_write_b32 a228, v250
    v_accvgpr_read_b32 v251, a229
    v_mul_f32_e64 v251, v249, v251
    v_accvgpr_write_b32 a229, v251
    v_accvgpr_read_b32 v250, a230
    v_mul_f32_e64 v250, v249, v250
    v_accvgpr_write_b32 a230, v250
    v_accvgpr_read_b32 v251, a231
    v_mul_f32_e64 v251, v249, v251
    v_accvgpr_write_b32 a231, v251
    v_exp_f32 v249, v152
    v_exp_f32 v250, v153
    s_nop 0
    v_add_f32 v245, v249, v250
    v_cvt_pk_bf16_f32 v200, v249, v250
    v_exp_f32 v251, v154
    v_exp_f32 v252, v155
    v_add_f32 v245, v245, v251
    v_add_f32 v245, v245, v252
    v_cvt_pk_bf16_f32 v201, v251, v252
    v_exp_f32 v253, v156
    v_exp_f32 v248, v157
    v_add_f32 v245, v245, v253
    v_add_f32 v245, v245, v248
    v_cvt_pk_bf16_f32 v202, v253, v248
    v_exp_f32 v249, v158
    v_exp_f32 v250, v159
    v_add_f32 v245, v245, v249
    v_add_f32 v245, v245, v250
    v_cvt_pk_bf16_f32 v203, v249, v250
    v_max3_f32 v248, v160, v161, v162
    v_max3_f32 v250, v163, v164, v165
    v_max3_f32 v248, v248, v166, v167
    v_max_f32 v248, v248, v250
    v_mov_b32 v250, v248
    s_nop 1
    v_permlane16_swap_b32 v248, v250
    v_max_f32 v248, v248, v250
    v_mov_b32 v250, v248
    s_nop 1
    v_permlane32_swap_b32 v248, v250
    v_max_f32 v248, v248, v250
    v_max_f32 v248, 0, v248
    v_sub_f32 v249, 0, v248
    v_exp_f32 v249, v249
    v_sub_f32 v224, v224, v248
    v_sub_f32 v225, v225, v248
    v_sub_f32 v226, v226, v248
    v_sub_f32 v227, v227, v248
    v_sub_f32 v160, v160, v248
    v_sub_f32 v161, v161, v248
    v_sub_f32 v162, v162, v248
    v_sub_f32 v163, v163, v248
    v_sub_f32 v164, v164, v248
    v_sub_f32 v165, v165, v248
    v_sub_f32 v166, v166, v248
    v_sub_f32 v167, v167, v248
    v_sub_f32 v176, v176, v248
    v_sub_f32 v177, v177, v248
    v_sub_f32 v178, v178, v248
    v_sub_f32 v179, v179, v248
    v_sub_f32 v180, v180, v248
    v_sub_f32 v181, v181, v248
    v_sub_f32 v182, v182, v248
    v_sub_f32 v183, v183, v248
    v_mul_f32_e64 v235, v249, v235
    v_accvgpr_read_b32 v250, a168
    v_mul_f32_e64 v250, v249, v250
    v_accvgpr_write_b32 a168, v250
    v_accvgpr_read_b32 v251, a169
    v_mul_f32_e64 v251, v249, v251
    v_accvgpr_write_b32 a169, v251
    v_accvgpr_read_b32 v250, a170
    v_mul_f32_e64 v250, v249, v250
    v_accvgpr_write_b32 a170, v250
    v_accvgpr_read_b32 v251, a171
    v_mul_f32_e64 v251, v249, v251
    v_accvgpr_write_b32 a171, v251
    v_accvgpr_read_b32 v250, a172
    v_mul_f32_e64 v250, v249, v250
    v_accvgpr_write_b32 a172, v250
    v_accvgpr_read_b32 v251, a173
    v_mul_f32_e64 v251, v249, v251
    v_accvgpr_write_b32 a173, v251
    v_accvgpr_read_b32 v250, a174
    v_mul_f32_e64 v250, v249, v250
    v_accvgpr_write_b32 a174, v250
    v_accvgpr_read_b32 v251, a175
    v_mul_f32_e64 v251, v249, v251
    v_accvgpr_write_b32 a175, v251
    v_accvgpr_read_b32 v250, a176
    v_mul_f32_e64 v250, v249, v250
    v_accvgpr_write_b32 a176, v250
    v_accvgpr_read_b32 v251, a177
    v_mul_f32_e64 v251, v249, v251
    v_accvgpr_write_b32 a177, v251
    v_accvgpr_read_b32 v250, a178
    v_mul_f32_e64 v250, v249, v250
    v_accvgpr_write_b32 a178, v250
    v_accvgpr_read_b32 v251, a179
    v_mul_f32_e64 v251, v249, v251
    v_accvgpr_write_b32 a179, v251
    v_accvgpr_read_b32 v250, a180
    v_mul_f32_e64 v250, v249, v250
    v_accvgpr_write_b32 a180, v250
    v_accvgpr_read_b32 v251, a181
    v_mul_f32_e64 v251, v249, v251
    v_accvgpr_write_b32 a181, v251
    v_accvgpr_read_b32 v250, a182
    v_mul_f32_e64 v250, v249, v250
    v_accvgpr_write_b32 a182, v250
    v_accvgpr_read_b32 v251, a183
    v_mul_f32_e64 v251, v249, v251
    v_accvgpr_write_b32 a183, v251
    v_accvgpr_read_b32 v250, a184
    v_mul_f32_e64 v250, v249, v250
    v_accvgpr_write_b32 a184, v250
    v_accvgpr_read_b32 v251, a185
    v_mul_f32_e64 v251, v249, v251
    v_accvgpr_write_b32 a185, v251
    v_accvgpr_read_b32 v250, a186
    v_mul_f32_e64 v250, v249, v250
    v_accvgpr_write_b32 a186, v250
    v_accvgpr_read_b32 v251, a187
    v_mul_f32_e64 v251, v249, v251
    v_accvgpr_write_b32 a187, v251
    v_accvgpr_read_b32 v250, a188
    v_mul_f32_e64 v250, v249, v250
    v_accvgpr_write_b32 a188, v250
    v_accvgpr_read_b32 v251, a189
    v_mul_f32_e64 v251, v249, v251
    v_accvgpr_write_b32 a189, v251
    v_accvgpr_read_b32 v250, a190
    v_mul_f32_e64 v250, v249, v250
    v_accvgpr_write_b32 a190, v250
    v_accvgpr_read_b32 v251, a191
    v_mul_f32_e64 v251, v249, v251
    v_accvgpr_write_b32 a191, v251
    v_accvgpr_read_b32 v250, a192
    v_mul_f32_e64 v250, v249, v250
    v_accvgpr_write_b32 a192, v250
    v_accvgpr_read_b32 v251, a193
    v_mul_f32_e64 v251, v249, v251
    v_accvgpr_write_b32 a193, v251
    v_accvgpr_read_b32 v250, a194
    v_mul_f32_e64 v250, v249, v250
    v_accvgpr_write_b32 a194, v250
    v_accvgpr_read_b32 v251, a195
    v_mul_f32_e64 v251, v249, v251
    v_accvgpr_write_b32 a195, v251
    v_accvgpr_read_b32 v250, a196
    v_mul_f32_e64 v250, v249, v250
    v_accvgpr_write_b32 a196, v250
    v_accvgpr_read_b32 v251, a197
    v_mul_f32_e64 v251, v249, v251
    v_accvgpr_write_b32 a197, v251
    v_accvgpr_read_b32 v250, a198
    v_mul_f32_e64 v250, v249, v250
    v_accvgpr_write_b32 a198, v250
    v_accvgpr_read_b32 v251, a199
    v_mul_f32_e64 v251, v249, v251
    v_accvgpr_write_b32 a199, v251
    v_accvgpr_read_b32 v250, a200
    v_mul_f32_e64 v250, v249, v250
    v_accvgpr_write_b32 a200, v250
    v_accvgpr_read_b32 v251, a201
    v_mul_f32_e64 v251, v249, v251
    v_accvgpr_write_b32 a201, v251
    v_accvgpr_read_b32 v250, a202
    v_mul_f32_e64 v250, v249, v250
    v_accvgpr_write_b32 a202, v250
    v_accvgpr_read_b32 v251, a203
    v_mul_f32_e64 v251, v249, v251
    v_accvgpr_write_b32 a203, v251
    v_accvgpr_read_b32 v250, a204
    v_mul_f32_e64 v250, v249, v250
    v_accvgpr_write_b32 a204, v250
    v_accvgpr_read_b32 v251, a205
    v_mul_f32_e64 v251, v249, v251
    v_accvgpr_write_b32 a205, v251
    v_accvgpr_read_b32 v250, a206
    v_mul_f32_e64 v250, v249, v250
    v_accvgpr_write_b32 a206, v250
    v_accvgpr_read_b32 v251, a207
    v_mul_f32_e64 v251, v249, v251
    v_accvgpr_write_b32 a207, v251
    v_accvgpr_read_b32 v250, a208
    v_mul_f32_e64 v250, v249, v250
    v_accvgpr_write_b32 a208, v250
    v_accvgpr_read_b32 v251, a209
    v_mul_f32_e64 v251, v249, v251
    v_accvgpr_write_b32 a209, v251
    v_accvgpr_read_b32 v250, a210
    v_mul_f32_e64 v250, v249, v250
    v_accvgpr_write_b32 a210, v250
    v_accvgpr_read_b32 v251, a211
    v_mul_f32_e64 v251, v249, v251
    v_accvgpr_write_b32 a211, v251
    v_accvgpr_read_b32 v250, a212
    v_mul_f32_e64 v250, v249, v250
    v_accvgpr_write_b32 a212, v250
    v_accvgpr_read_b32 v251, a213
    v_mul_f32_e64 v251, v249, v251
    v_accvgpr_write_b32 a213, v251
    v_accvgpr_read_b32 v250, a214
    v_mul_f32_e64 v250, v249, v250
    v_accvgpr_write_b32 a214, v250
    v_accvgpr_read_b32 v251, a215
    v_mul_f32_e64 v251, v249, v251
    v_accvgpr_write_b32 a215, v251
    v_exp_f32 v251, v160
    v_exp_f32 v252, v161
    s_nop 0
    v_add_f32 v246, v251, v252
    v_cvt_pk_bf16_f32 v204, v251, v252
    v_exp_f32 v253, v162
    v_exp_f32 v248, v163
    v_add_f32 v246, v246, v253
    v_add_f32 v246, v246, v248
    v_cvt_pk_bf16_f32 v205, v253, v248
    v_exp_f32 v249, v164
    v_exp_f32 v250, v165
    v_add_f32 v246, v246, v249
    v_add_f32 v246, v246, v250
    v_cvt_pk_bf16_f32 v206, v249, v250
    v_exp_f32 v251, v166
    v_exp_f32 v252, v167
    v_add_f32 v246, v246, v251
    v_add_f32 v246, v246, v252
    v_cvt_pk_bf16_f32 v207, v251, v252
    s_nop 3
    s_branch L_ret1B0
L_slow0B0:
    s_nop 15
    v_max3_f32 v248, v128, v129, v130
    v_max3_f32 v250, v131, v132, v133
    v_max3_f32 v248, v248, v134, v135
    v_max_f32 v248, v248, v250
    v_mov_b32 v250, v248
    s_nop 1
    v_permlane16_swap_b32 v248, v250
    v_max_f32 v248, v248, v250
    v_mov_b32 v250, v248
    s_nop 1
    v_permlane32_swap_b32 v248, v250
    v_max_f32 v248, v248, v250
    v_max_f32 v248, 0, v248
    v_sub_f32 v249, 0, v248
    v_exp_f32 v249, v249
    v_sub_f32 v212, v212, v248
    v_sub_f32 v213, v213, v248
    v_sub_f32 v214, v214, v248
    v_sub_f32 v215, v215, v248
    v_sub_f32 v128, v128, v248
    v_sub_f32 v129, v129, v248
    v_sub_f32 v130, v130, v248
    v_sub_f32 v131, v131, v248
    v_sub_f32 v132, v132, v248
    v_sub_f32 v133, v133, v248
    v_sub_f32 v134, v134, v248
    v_sub_f32 v135, v135, v248
    v_mul_f32 v232, v249, v232
    v_mul_f32 v0, v249, v0
    v_mul_f32 v1, v249, v1
    v_mul_f32 v2, v249, v2
    v_mul_f32 v3, v249, v3
    v_mul_f32 v4, v249, v4
    v_mul_f32 v5, v249, v5
    v_mul_f32 v6, v249, v6
    v_mul_f32 v7, v249, v7
    v_mul_f32 v8, v249, v8
    v_mul_f32 v9, v249, v9
    v_mul_f32 v10, v249, v10
    v_mul_f32 v11, v249, v11
    v_mul_f32 v12, v249, v12
    v_mul_f32 v13, v249, v13
    v_mul_f32 v14, v249, v14
    v_mul_f32 v15, v249, v15
    v_mul_f32 v16, v249, v16
    v_mul_f32 v17, v249, v17
    v_mul_f32 v18, v249, v18
    v_mul_f32 v19, v249, v19
    v_mul_f32 v20, v249, v20
    v_mul_f32 v21, v249, v21
    v_mul_f32 v22, v249, v22
    v_mul_f32 v23, v249, v23
    v_mul_f32 v24, v249, v24
    v_mul_f32 v25, v249, v25
    v_mul_f32 v26, v249, v26
    v_mul_f32 v27, v249, v27
    v_mul_f32 v28, v249, v28
    v_mul_f32 v29, v249, v29
    v_mul_f32 v30, v249, v30
    v_mul_f32 v31, v249, v31
    v_mul_f32 v32, v249, v32
    v_mul_f32 v33, v249, v33
    v_mul_f32 v34, v249, v34
    v_mul_f32 v35, v249, v35
    v_mul_f32 v36, v249, v36
    v_mul_f32 v37, v249, v37
    v_mul_f32 v38, v249, v38
    v_mul_f32 v39, v249, v39
    v_mul_f32 v40, v249, v40
    v_mul_f32 v41, v249, v41
    v_mul_f32 v42, v249, v42
    v_mul_f32 v43, v249, v43
    v_mul_f32 v44, v249, v44
    v_mul_f32 v45, v249, v45
    v_mul_f32 v46, v249, v46
    v_mul_f32 v47, v249, v47
    v_exp_f32 v248, v128
    v_exp_f32 v249, v129
    s_nop 0
    v_add_f32 v254, v248, v249
    v_cvt_pk_bf16_f32 v184, v248, v249
    v_exp_f32 v250, v130
    v_exp_f32 v251, v131
    v_add_f32 v254, v254, v250
    v_add_f32 v254, v254, v251
    v_cvt_pk_bf16_f32 v185, v250, v251
    v_exp_f32 v252, v132
    v_exp_f32 v253, v133
    v_add_f32 v254, v254, v252
    v_add_f32 v254, v254, v253
    v_cvt_pk_bf16_f32 v186, v252, v253
    v_exp_f32 v248, v134
    v_exp_f32 v249, v135
    v_add_f32 v254, v254, v248
    v_add_f32 v254, v254, v249
    v_cvt_pk_bf16_f32 v187, v248, v249
    v_max3_f32 v248, v136, v137, v138
    v_max3_f32 v250, v139, v140, v141
    v_max3_f32 v248, v248, v142, v143
    v_max_f32 v248, v248, v250
    v_mov_b32 v250, v248
    s_nop 1
    v_permlane16_swap_b32 v248, v250
    v_max_f32 v248, v248, v250
    v_mov_b32 v250, v248
    s_nop 1
    v_permlane32_swap_b32 v248, v250
    v_max_f32 v248, v248, v250
    v_max_f32 v248, 0, v248
    v_sub_f32 v249, 0, v248
    v_exp_f32 v249, v249
    v_sub_f32 v216, v216, v248
    v_sub_f32 v217, v217, v248
    v_sub_f32 v218, v218, v248
    v_sub_f32 v219, v219, v248
    v_sub_f32 v136, v136, v248
    v_sub_f32 v137, v137, v248
    v_sub_f32 v138, v138, v248
    v_sub_f32 v139, v139, v248
    v_sub_f32 v140, v140, v248
    v_sub_f32 v141, v141, v248
    v_sub_f32 v142, v142, v248
    v_sub_f32 v143, v143, v248
    v_mul_f32 v233, v249, v233
    v_mul_f32 v48, v249, v48
    v_mul_f32 v49, v249, v49
    v_mul_f32 v50, v249, v50
    v_mul_f32 v51, v249, v51
    v_mul_f32 v52, v249, v52
    v_mul_f32 v53, v249, v53
    v_mul_f32 v54, v249, v54
    v_mul_f32 v55, v249, v55
    v_mul_f32 v56, v249, v56
    v_mul_f32 v57, v249, v57
    v_mul_f32 v58, v249, v58
    v_mul_f32 v59, v249, v59
    v_mul_f32 v60, v249, v60
    v_mul_f32 v61, v249, v61
    v_mul_f32 v62, v249, v62
    v_mul_f32 v63, v249, v63
    v_mul_f32 v64, v249, v64
    v_mul_f32 v65, v249, v65
    v_mul_f32 v66, v249, v66
    v_mul_f32 v67, v249, v67
    v_mul_f32 v68, v249, v68
    v_mul_f32 v69, v249, v69
    v_mul_f32 v70, v249, v70
    v_mul_f32 v71, v249, v71
    v_mul_f32 v72, v249, v72
    v_mul_f32 v73, v249, v73
    v_mul_f32 v74, v249, v74
    v_mul_f32 v75, v249, v75
    v_mul_f32 v76, v249, v76
    v_mul_f32 v77, v249, v77
    v_mul_f32 v78, v249, v78
    v_mul_f32 v79, v249, v79
    v_mul_f32 v80, v249, v80
    v_mul_f32 v81, v249, v81
    v_mul_f32 v82, v249, v82
    v_mul_f32 v83, v249, v83
    v_mul_f32 v84, v249, v84
    v_mul_f32 v85, v249, v85
    v_mul_f32 v86, v249, v86
    v_mul_f32 v87, v249, v87
    v_mul_f32 v88, v249, v88
    v_mul_f32 v89, v249, v89
    v_mul_f32 v90, v249, v90
    v_mul_f32 v91, v249, v91
    v_mul_f32 v92, v249, v92
    v_mul_f32 v93, v249, v93
    v_mul_f32 v94, v249, v94
    v_mul_f32 v95, v249, v95
    v_exp_f32 v250, v136
    v_exp_f32 v251, v137
    s_nop 0
    v_add_f32_e64 v246, v250, v251
    v_cvt_pk_bf16_f32 v188, v250, v251
    v_exp_f32 v252, v138
    v_exp_f32 v253, v139
    v_add_f32 v246, v246, v252
    v_add_f32 v246, v246, v253
    v_cvt_pk_bf16_f32 v189, v252, v253
    v_exp_f32 v248, v140
    v_exp_f32 v249, v141
    v_add_f32 v246, v246, v248
    v_add_f32 v246, v246, v249
    v_cvt_pk_bf16_f32 v190, v248, v249
    v_exp_f32 v250, v142
    v_exp_f32 v251, v143
    v_add_f32 v246, v246, v250
    v_add_f32 v246, v246, v251
    v_cvt_pk_bf16_f32 v191, v250, v251
    s_nop 3
    s_branch L_ret0B0
L_slow1A1:
    s_nop 15
    v_max3_f32 v248, v168, v169, v170
    v_max3_f32 v250, v171, v172, v173
    v_max3_f32 v248, v248, v174, v175
    v_max_f32 v248, v248, v250
    v_mov_b32 v250, v248
    s_nop 1
    v_permlane16_swap_b32 v248, v250
    v_max_f32 v248, v248, v250
    v_mov_b32 v250, v248
    s_nop 1
    v_permlane32_swap_b32 v248, v250
    v_max_f32 v248, v248, v250
    v_max_f32 v248, 0, v248
    v_sub_f32 v249, 0, v248
    v_exp_f32 v249, v249
    v_sub_f32 v220, v220, v248
    v_sub_f32 v221, v221, v248
    v_sub_f32 v222, v222, v248
    v_sub_f32 v223, v223, v248
    v_sub_f32 v168, v168, v248
    v_sub_f32 v169, v169, v248
    v_sub_f32 v170, v170, v248
    v_sub_f32 v171, v171, v248
    v_sub_f32 v172, v172, v248
    v_sub_f32 v173, v173, v248
    v_sub_f32 v174, v174, v248
    v_sub_f32 v175, v175, v248
    v_sub_f32 v152, v152, v248
    v_sub_f32 v153, v153, v248
    v_sub_f32 v154, v154, v248
    v_sub_f32 v155, v155, v248
    v_sub_f32 v156, v156, v248
    v_sub_f32 v157, v157, v248
    v_sub_f32 v158, v158, v248
    v_sub_f32 v159, v159, v248
    v_mul_f32 v234, v249, v234
    v_mul_f32 v96, v249, v96
    v_mul_f32 v97, v249, v97
    v_mul_f32 v98, v249, v98
    v_mul_f32 v99, v249, v99
    v_mul_f32 v100, v249, v100
    v_mul_f32 v101, v249, v101
    v_mul_f32 v102, v249, v102
    v_mul_f32 v103, v249, v103
    v_mul_f32 v104, v249, v104
    v_mul_f32 v105, v249, v105
    v_mul_f32 v106, v249, v106
    v_mul_f32 v107, v249, v107
    v_mul_f32 v108, v249, v108
    v_mul_f32 v109, v249, v109
    v_mul_f32 v110, v249, v110
    v_mul_f32 v111, v249, v111
    v_mul_f32 v112, v249, v112
    v_mul_f32 v113, v249, v113
    v_mul_f32 v114, v249, v114
    v_mul_f32 v115, v249, v115
    v_mul_f32 v116, v249, v116
    v_mul_f32 v117, v249, v117
    v_mul_f32 v118, v249, v118
    v_mul_f32 v119, v249, v119
    v_mul_f32 v120, v249, v120
    v_mul_f32 v121, v249, v121
    v_mul_f32 v122, v249, v122
    v_mul_f32 v123, v249, v123
    v_mul_f32 v124, v249, v124
    v_mul_f32 v125, v249, v125
    v_mul_f32 v126, v249, v126
    v_mul_f32 v127, v249, v127
    v_accvgpr_read_b32 v250, a216
    v_mul_f32_e64 v250, v249, v250
    v_accvgpr_write_b32 a216, v250
    v_accvgpr_read_b32 v251, a217
    v_mul_f32_e64 v251, v249, v251
    v_accvgpr_write_b32 a217, v251
    v_accvgpr_read_b32 v250, a218
    v_mul_f32_e64 v250, v249, v250
    v_accvgpr_write_b32 a218, v250
    v_accvgpr_read_b32 v251, a219
    v_mul_f32_e64 v251, v249, v251
    v_accvgpr_write_b32 a219, v251
    v_accvgpr_read_b32 v250, a220
    v_mul_f32_e64 v250, v249, v250
    v_accvgpr_write_b32 a220, v250
    v_accvgpr_read_b32 v251, a221
    v_mul_f32_e64 v251, v249, v251
    v_accvgpr_write_b32 a221, v251
    v_accvgpr_read_b32 v250, a222
    v_mul_f32_e64 v250, v249, v250
    v_accvgpr_write_b32 a222, v250
    v_accvgpr_read_b32 v251, a223
    v_mul_f32_e64 v251, v249, v251
    v_accvgpr_write_b32 a223, v251
    v_accvgpr_read_b32 v250, a224
    v_mul_f32_e64 v250, v249, v250
    v_accvgpr_write_b32 a224, v250
    v_accvgpr_read_b32 v251, a225
    v_mul_f32_e64 v251, v249, v251
    v_accvgpr_write_b32 a225, v251
    v_accvgpr_read_b32 v250, a226
    v_mul_f32_e64 v250, v249, v250
    v_accvgpr_write_b32 a226, v250
    v_accvgpr_read_b32 v251, a227
    v_mul_f32_e64 v251, v249, v251
    v_accvgpr_write_b32 a227, v251
    v_accvgpr_read_b32 v250, a228
    v_mul_f32_e64 v250, v249, v250
    v_accvgpr_write_b32 a228, v250
    v_accvgpr_read_b32 v251, a229
    v_mul_f32_e64 v251, v249, v251
    v_accvgpr_write_b32 a229, v251
    v_accvgpr_read_b32 v250, a230
    v_mul_f32_e64 v250, v249, v250
    v_accvgpr_write_b32 a230, v250
    v_accvgpr_read_b32 v251, a231
    v_mul_f32_e64 v251, v249, v251
    v_accvgpr_write_b32 a231, v251
    v_exp_f32 v249, v168
    v_exp_f32 v250, v169
    s_nop 0
    v_add_f32 v245, v249, v250
    v_cvt_pk_bf16_f32 v200, v249, v250
    v_exp_f32 v251, v170
    v_exp_f32 v252, v171
    v_add_f32 v245, v245, v251
    v_add_f32 v245, v245, v252
    v_cvt_pk_bf16_f32 v201, v251, v252
    v_exp_f32 v253, v172
    v_exp_f32 v248, v173
    v_add_f32 v245, v245, v253
    v_add_f32 v245, v245, v248
    v_cvt_pk_bf16_f32 v202, v253, v248
    v_exp_f32 v249, v174
    v_exp_f32 v250, v175
    v_add_f32 v245, v245, v249
    v_add_f32 v245, v245, v250
    v_cvt_pk_bf16_f32 v203, v249, v250
    v_max3_f32 v248, v176, v177, v178
    v_max3_f32 v250, v179, v180, v181
    v_max3_f32 v248, v248, v182, v183
    v_max_f32 v248, v248, v250
    v_mov_b32 v250, v248
    s_nop 1
    v_permlane16_swap_b32 v248, v250
    v_max_f32 v248, v248, v250
    v_mov_b32 v250, v248
    s_nop 1
    v_permlane32_swap_b32 v248, v250
    v_max_f32 v248, v248, v250
    v_max_f32 v248, 0, v248
    v_sub_f32 v249, 0, v248
    v_exp_f32 v249, v249
    v_sub_f32 v224, v224, v248
    v_sub_f32 v225, v225, v248
    v_sub_f32 v226, v226, v248
    v_sub_f32 v227, v227, v248
    v_sub_f32 v176, v176, v248
    v_sub_f32 v177, v177, v248
    v_sub_f32 v178, v178, v248
    v_sub_f32 v179, v179, v248
    v_sub_f32 v180, v180, v248
    v_sub_f32 v181, v181, v248
    v_sub_f32 v182, v182, v248
    v_sub_f32 v183, v183, v248
    v_sub_f32 v160, v160, v248
    v_sub_f32 v161, v161, v248
    v_sub_f32 v162, v162, v248
    v_sub_f32 v163, v163, v248
    v_sub_f32 v164, v164, v248
    v_sub_f32 v165, v165, v248
    v_sub_f32 v166, v166, v248
    v_sub_f32 v167, v167, v248
    v_mul_f32_e64 v235, v249, v235
    v_accvgpr_read_b32 v250, a168
    v_mul_f32_e64 v250, v249, v250
    v_accvgpr_write_b32 a168, v250
    v_accvgpr_read_b32 v251, a169
    v_mul_f32_e64 v251, v249, v251
    v_accvgpr_write_b32 a169, v251
    v_accvgpr_read_b32 v250, a170
    v_mul_f32_e64 v250, v249, v250
    v_accvgpr_write_b32 a170, v250
    v_accvgpr_read_b32 v251, a171
    v_mul_f32_e64 v251, v249, v251
    v_accvgpr_write_b32 a171, v251
    v_accvgpr_read_b32 v250, a172
    v_mul_f32_e64 v250, v249, v250
    v_accvgpr_write_b32 a172, v250
    v_accvgpr_read_b32 v251, a173
    v_mul_f32_e64 v251, v249, v251
    v_accvgpr_write_b32 a173, v251
    v_accvgpr_read_b32 v250, a174
    v_mul_f32_e64 v250, v249, v250
    v_accvgpr_write_b32 a174, v250
    v_accvgpr_read_b32 v251, a175
    v_mul_f32_e64 v251, v249, v251
    v_accvgpr_write_b32 a175, v251
    v_accvgpr_read_b32 v250, a176
    v_mul_f32_e64 v250, v249, v250
    v_accvgpr_write_b32 a176, v250
    v_accvgpr_read_b32 v251, a177
    v_mul_f32_e64 v251, v249, v251
    v_accvgpr_write_b32 a177, v251
    v_accvgpr_read_b32 v250, a178
    v_mul_f32_e64 v250, v249, v250
    v_accvgpr_write_b32 a178, v250
    v_accvgpr_read_b32 v251, a179
    v_mul_f32_e64 v251, v249, v251
    v_accvgpr_write_b32 a179, v251
    v_accvgpr_read_b32 v250, a180
    v_mul_f32_e64 v250, v249, v250
    v_accvgpr_write_b32 a180, v250
    v_accvgpr_read_b32 v251, a181
    v_mul_f32_e64 v251, v249, v251
    v_accvgpr_write_b32 a181, v251
    v_accvgpr_read_b32 v250, a182
    v_mul_f32_e64 v250, v249, v250
    v_accvgpr_write_b32 a182, v250
    v_accvgpr_read_b32 v251, a183
    v_mul_f32_e64 v251, v249, v251
    v_accvgpr_write_b32 a183, v251
    v_accvgpr_read_b32 v250, a184
    v_mul_f32_e64 v250, v249, v250
    v_accvgpr_write_b32 a184, v250
    v_accvgpr_read_b32 v251, a185
    v_mul_f32_e64 v251, v249, v251
    v_accvgpr_write_b32 a185, v251
    v_accvgpr_read_b32 v250, a186
    v_mul_f32_e64 v250, v249, v250
    v_accvgpr_write_b32 a186, v250
    v_accvgpr_read_b32 v251, a187
    v_mul_f32_e64 v251, v249, v251
    v_accvgpr_write_b32 a187, v251
    v_accvgpr_read_b32 v250, a188
    v_mul_f32_e64 v250, v249, v250
    v_accvgpr_write_b32 a188, v250
    v_accvgpr_read_b32 v251, a189
    v_mul_f32_e64 v251, v249, v251
    v_accvgpr_write_b32 a189, v251
    v_accvgpr_read_b32 v250, a190
    v_mul_f32_e64 v250, v249, v250
    v_accvgpr_write_b32 a190, v250
    v_accvgpr_read_b32 v251, a191
    v_mul_f32_e64 v251, v249, v251
    v_accvgpr_write_b32 a191, v251
    v_accvgpr_read_b32 v250, a192
    v_mul_f32_e64 v250, v249, v250
    v_accvgpr_write_b32 a192, v250
    v_accvgpr_read_b32 v251, a193
    v_mul_f32_e64 v251, v249, v251
    v_accvgpr_write_b32 a193, v251
    v_accvgpr_read_b32 v250, a194
    v_mul_f32_e64 v250, v249, v250
    v_accvgpr_write_b32 a194, v250
    v_accvgpr_read_b32 v251, a195
    v_mul_f32_e64 v251, v249, v251
    v_accvgpr_write_b32 a195, v251
    v_accvgpr_read_b32 v250, a196
    v_mul_f32_e64 v250, v249, v250
    v_accvgpr_write_b32 a196, v250
    v_accvgpr_read_b32 v251, a197
    v_mul_f32_e64 v251, v249, v251
    v_accvgpr_write_b32 a197, v251
    v_accvgpr_read_b32 v250, a198
    v_mul_f32_e64 v250, v249, v250
    v_accvgpr_write_b32 a198, v250
    v_accvgpr_read_b32 v251, a199
    v_mul_f32_e64 v251, v249, v251
    v_accvgpr_write_b32 a199, v251
    v_accvgpr_read_b32 v250, a200
    v_mul_f32_e64 v250, v249, v250
    v_accvgpr_write_b32 a200, v250
    v_accvgpr_read_b32 v251, a201
    v_mul_f32_e64 v251, v249, v251
    v_accvgpr_write_b32 a201, v251
    v_accvgpr_read_b32 v250, a202
    v_mul_f32_e64 v250, v249, v250
    v_accvgpr_write_b32 a202, v250
    v_accvgpr_read_b32 v251, a203
    v_mul_f32_e64 v251, v249, v251
    v_accvgpr_write_b32 a203, v251
    v_accvgpr_read_b32 v250, a204
    v_mul_f32_e64 v250, v249, v250
    v_accvgpr_write_b32 a204, v250
    v_accvgpr_read_b32 v251, a205
    v_mul_f32_e64 v251, v249, v251
    v_accvgpr_write_b32 a205, v251
    v_accvgpr_read_b32 v250, a206
    v_mul_f32_e64 v250, v249, v250
    v_accvgpr_write_b32 a206, v250
    v_accvgpr_read_b32 v251, a207
    v_mul_f32_e64 v251, v249, v251
    v_accvgpr_write_b32 a207, v251
    v_accvgpr_read_b32 v250, a208
    v_mul_f32_e64 v250, v249, v250
    v_accvgpr_write_b32 a208, v250
    v_accvgpr_read_b32 v251, a209
    v_mul_f32_e64 v251, v249, v251
    v_accvgpr_write_b32 a209, v251
    v_accvgpr_read_b32 v250, a210
    v_mul_f32_e64 v250, v249, v250
    v_accvgpr_write_b32 a210, v250
    v_accvgpr_read_b32 v251, a211
    v_mul_f32_e64 v251, v249, v251
    v_accvgpr_write_b32 a211, v251
    v_accvgpr_read_b32 v250, a212
    v_mul_f32_e64 v250, v249, v250
    v_accvgpr_write_b32 a212, v250
    v_accvgpr_read_b32 v251, a213
    v_mul_f32_e64 v251, v249, v251
    v_accvgpr_write_b32 a213, v251
    v_accvgpr_read_b32 v250, a214
    v_mul_f32_e64 v250, v249, v250
    v_accvgpr_write_b32 a214, v250
    v_accvgpr_read_b32 v251, a215
    v_mul_f32_e64 v251, v249, v251
    v_accvgpr_write_b32 a215, v251
    v_exp_f32 v251, v176
    v_exp_f32 v252, v177
    s_nop 0
    v_add_f32 v246, v251, v252
    v_cvt_pk_bf16_f32 v204, v251, v252
    v_exp_f32 v253, v178
    v_exp_f32 v248, v179
    v_add_f32 v246, v246, v253
    v_add_f32 v246, v246, v248
    v_cvt_pk_bf16_f32 v205, v253, v248
    v_exp_f32 v249, v180
    v_exp_f32 v250, v181
    v_add_f32 v246, v246, v249
    v_add_f32 v246, v246, v250
    v_cvt_pk_bf16_f32 v206, v249, v250
    v_exp_f32 v251, v182
    v_exp_f32 v252, v183
    v_add_f32 v246, v246, v251
    v_add_f32 v246, v246, v252
    v_cvt_pk_bf16_f32 v207, v251, v252
    v_max3_f32 v248, v144, v145, v146
    v_max3_f32 v250, v147, v148, v149
    v_max3_f32 v248, v248, v150, v151
    v_max_f32 v248, v248, v250
    v_mov_b32 v250, v248
    s_nop 1
    v_permlane16_swap_b32 v248, v250
    v_max_f32 v248, v248, v250
    v_mov_b32 v250, v248
    s_nop 1
    v_permlane32_swap_b32 v248, v250
    v_max_f32 v248, v248, v250
    v_max_f32 v248, 0, v248
    v_sub_f32 v249, 0, v248
    v_exp_f32 v249, v249
    v_sub_f32 v228, v228, v248
    v_sub_f32 v229, v229, v248
    v_sub_f32 v230, v230, v248
    v_sub_f32 v231, v231, v248
    v_sub_f32 v144, v144, v248
    v_sub_f32 v145, v145, v248
    v_sub_f32 v146, v146, v248
    v_sub_f32 v147, v147, v248
    v_sub_f32 v148, v148, v248
    v_sub_f32 v149, v149, v248
    v_sub_f32 v150, v150, v248
    v_sub_f32 v151, v151, v248
    v_mul_f32_e64 v236, v249, v236
    v_accvgpr_read_b32 v250, a120
    v_mul_f32_e64 v250, v249, v250
    v_accvgpr_write_b32 a120, v250
    v_accvgpr_read_b32 v251, a121
    v_mul_f32_e64 v251, v249, v251
    v_accvgpr_write_b32 a121, v251
    v_accvgpr_read_b32 v250, a122
    v_mul_f32_e64 v250, v249, v250
    v_accvgpr_write_b32 a122, v250
    v_accvgpr_read_b32 v251, a123
    v_mul_f32_e64 v251, v249, v251
    v_accvgpr_write_b32 a123, v251
    v_accvgpr_read_b32 v250, a124
    v_mul_f32_e64 v250, v249, v250
    v_accvgpr_write_b32 a124, v250
    v_accvgpr_read_b32 v251, a125
    v_mul_f32_e64 v251, v249, v251
    v_accvgpr_write_b32 a125, v251
    v_accvgpr_read_b32 v250, a126
    v_mul_f32_e64 v250, v249, v250
    v_accvgpr_write_b32 a126, v250
    v_accvgpr_read_b32 v251, a127
    v_mul_f32_e64 v251, v249, v251
    v_accvgpr_write_b32 a127, v251
    v_accvgpr_read_b32 v250, a128
    v_mul_f32_e64 v250, v249, v250
    v_accvgpr_write_b32 a128, v250
    v_accvgpr_read_b32 v251, a129
    v_mul_f32_e64 v251, v249, v251
    v_accvgpr_write_b32 a129, v251
    v_accvgpr_read_b32 v250, a130
    v_mul_f32_e64 v250, v249, v250
    v_accvgpr_write_b32 a130, v250
    v_accvgpr_read_b32 v251, a131
    v_mul_f32_e64 v251, v249, v251
    v_accvgpr_write_b32 a131, v251
    v_accvgpr_read_b32 v250, a132
    v_mul_f32_e64 v250, v249, v250
    v_accvgpr_write_b32 a132, v250
    v_accvgpr_read_b32 v251, a133
    v_mul_f32_e64 v251, v249, v251
    v_accvgpr_write_b32 a133, v251
    v_accvgpr_read_b32 v250, a134
    v_mul_f32_e64 v250, v249, v250
    v_accvgpr_write_b32 a134, v250
    v_accvgpr_read_b32 v251, a135
    v_mul_f32_e64 v251, v249, v251
    v_accvgpr_write_b32 a135, v251
    v_accvgpr_read_b32 v250, a136
    v_mul_f32_e64 v250, v249, v250
    v_accvgpr_write_b32 a136, v250
    v_accvgpr_read_b32 v251, a137
    v_mul_f32_e64 v251, v249, v251
    v_accvgpr_write_b32 a137, v251
    v_accvgpr_read_b32 v250, a138
    v_mul_f32_e64 v250, v249, v250
    v_accvgpr_write_b32 a138, v250
    v_accvgpr_read_b32 v251, a139
    v_mul_f32_e64 v251, v249, v251
    v_accvgpr_write_b32 a139, v251
    v_accvgpr_read_b32 v250, a140
    v_mul_f32_e64 v250, v249, v250
    v_accvgpr_write_b32 a140, v250
    v_accvgpr_read_b32 v251, a141
    v_mul_f32_e64 v251, v249, v251
    v_accvgpr_write_b32 a141, v251
    v_accvgpr_read_b32 v250, a142
    v_mul_f32_e64 v250, v249, v250
    v_accvgpr_write_b32 a142, v250
    v_accvgpr_read_b32 v251, a143
    v_mul_f32_e64 v251, v249, v251
    v_accvgpr_write_b32 a143, v251
    v_accvgpr_read_b32 v250, a144
    v_mul_f32_e64 v250, v249, v250
    v_accvgpr_write_b32 a144, v250
    v_accvgpr_read_b32 v251, a145
    v_mul_f32_e64 v251, v249, v251
    v_accvgpr_write_b32 a145, v251
    v_accvgpr_read_b32 v250, a146
    v_mul_f32_e64 v250, v249, v250
    v_accvgpr_write_b32 a146, v250
    v_accvgpr_read_b32 v251, a147
    v_mul_f32_e64 v251, v249, v251
    v_accvgpr_write_b32 a147, v251
    v_accvgpr_read_b32 v250, a148
    v_mul_f32_e64 v250, v249, v250
    v_accvgpr_write_b32 a148, v250
    v_accvgpr_read_b32 v251, a149
    v_mul_f32_e64 v251, v249, v251
    v_accvgpr_write_b32 a149, v251
    v_accvgpr_read_b32 v250, a150
    v_mul_f32_e64 v250, v249, v250
    v_accvgpr_write_b32 a150, v250
    v_accvgpr_read_b32 v251, a151
    v_mul_f32_e64 v251, v249, v251
    v_accvgpr_write_b32 a151, v251
    v_accvgpr_read_b32 v250, a152
    v_mul_f32_e64 v250, v249, v250
    v_accvgpr_write_b32 a152, v250
    v_accvgpr_read_b32 v251, a153
    v_mul_f32_e64 v251, v249, v251
    v_accvgpr_write_b32 a153, v251
    v_accvgpr_read_b32 v250, a154
    v_mul_f32_e64 v250, v249, v250
    v_accvgpr_write_b32 a154, v250
    v_accvgpr_read_b32 v251, a155
    v_mul_f32_e64 v251, v249, v251
    v_accvgpr_write_b32 a155, v251
    v_accvgpr_read_b32 v250, a156
    v_mul_f32_e64 v250, v249, v250
    v_accvgpr_write_b32 a156, v250
    v_accvgpr_read_b32 v251, a157
    v_mul_f32_e64 v251, v249, v251
    v_accvgpr_write_b32 a157, v251
    v_accvgpr_read_b32 v250, a158
    v_mul_f32_e64 v250, v249, v250
    v_accvgpr_write_b32 a158, v250
    v_accvgpr_read_b32 v251, a159
    v_mul_f32_e64 v251, v249, v251
    v_accvgpr_write_b32 a159, v251
    v_accvgpr_read_b32 v250, a160
    v_mul_f32_e64 v250, v249, v250
    v_accvgpr_write_b32 a160, v250
    v_accvgpr_read_b32 v251, a161
    v_mul_f32_e64 v251, v249, v251
    v_accvgpr_write_b32 a161, v251
    v_accvgpr_read_b32 v250, a162
    v_mul_f32_e64 v250, v249, v250
    v_accvgpr_write_b32 a162, v250
    v_accvgpr_read_b32 v251, a163
    v_mul_f32_e64 v251, v249, v251
    v_accvgpr_write_b32 a163, v251
    v_accvgpr_read_b32 v250, a164
    v_mul_f32_e64 v250, v249, v250
    v_accvgpr_write_b32 a164, v250
    v_accvgpr_read_b32 v251, a165
    v_mul_f32_e64 v251, v249, v251
    v_accvgpr_write_b32 a165, v251
    v_accvgpr_read_b32 v250, a166
    v_mul_f32_e64 v250, v249, v250
    v_accvgpr_write_b32 a166, v250
    v_accvgpr_read_b32 v251, a167
    v_mul_f32_e64 v251, v249, v251
    v_accvgpr_write_b32 a167, v251
    v_exp_f32 v253, v144
    v_exp_f32 v248, v145
    s_nop 0
    v_add_f32 v247, v253, v248
    v_cvt_pk_bf16_f32 v208, v253, v248
    v_exp_f32 v249, v146
    v_exp_f32 v250, v147
    v_add_f32 v247, v247, v249
    v_add_f32 v247, v247, v250
    v_cvt_pk_bf16_f32 v209, v249, v250
    v_exp_f32 v251, v148
    v_exp_f32 v252, v149
    v_add_f32 v247, v247, v251
    v_add_f32 v247, v247, v252
    v_cvt_pk_bf16_f32 v210, v251, v252
    v_exp_f32 v253, v150
    v_exp_f32 v248, v151
    v_add_f32 v247, v247, v253
    v_add_f32 v247, v247, v248
    v_cvt_pk_bf16_f32 v211, v253, v248
    s_nop 3
    s_branch L_ret1A1
L_slow0A1:
    s_nop 15
    v_max3_f32 v248, v128, v129, v130
    v_max3_f32 v250, v131, v132, v133
    v_max3_f32 v248, v248, v134, v135
    v_max_f32 v248, v248, v250
    v_mov_b32 v250, v248
    s_nop 1
    v_permlane16_swap_b32 v248, v250
    v_max_f32 v248, v248, v250
    v_mov_b32 v250, v248
    s_nop 1
    v_permlane32_swap_b32 v248, v250
    v_max_f32 v248, v248, v250
    v_max_f32 v248, 0, v248
    v_sub_f32 v249, 0, v248
    v_exp_f32 v249, v249
    v_sub_f32 v212, v212, v248
    v_sub_f32 v213, v213, v248
    v_sub_f32 v214, v214, v248
    v_sub_f32 v215, v215, v248
    v_sub_f32 v128, v128, v248
    v_sub_f32 v129, v129, v248
    v_sub_f32 v130, v130, v248
    v_sub_f32 v131, v131, v248
    v_sub_f32 v132, v132, v248
    v_sub_f32 v133, v133, v248
    v_sub_f32 v134, v134, v248
    v_sub_f32 v135, v135, v248
    v_mul_f32 v232, v249, v232
    v_mul_f32 v0, v249, v0
    v_mul_f32 v1, v249, v1
    v_mul_f32 v2, v249, v2
    v_mul_f32 v3, v249, v3
    v_mul_f32 v4, v249, v4
    v_mul_f32 v5, v249, v5
    v_mul_f32 v6, v249, v6
    v_mul_f32 v7, v249, v7
    v_mul_f32 v8, v249, v8
    v_mul_f32 v9, v249, v9
    v_mul_f32 v10, v249, v10
    v_mul_f32 v11, v249, v11
    v_mul_f32 v12, v249, v12
    v_mul_f32 v13, v249, v13
    v_mul_f32 v14, v249, v14
    v_mul_f32 v15, v249, v15
    v_mul_f32 v16, v249, v16
    v_mul_f32 v17, v249, v17
    v_mul_f32 v18, v249, v18
    v_mul_f32 v19, v249, v19
    v_mul_f32 v20, v249, v20
    v_mul_f32 v21, v249, v21
    v_mul_f32 v22, v249, v22
    v_mul_f32 v23, v249, v23
    v_mul_f32 v24, v249, v24
    v_mul_f32 v25, v249, v25
    v_mul_f32 v26, v249, v26
    v_mul_f32 v27, v249, v27
    v_mul_f32 v28, v249, v28
    v_mul_f32 v29, v249, v29
    v_mul_f32 v30, v249, v30
    v_mul_f32 v31, v249, v31
    v_mul_f32 v32, v249, v32
    v_mul_f32 v33, v249, v33
    v_mul_f32 v34, v249, v34
    v_mul_f32 v35, v249, v35
    v_mul_f32 v36, v249, v36
    v_mul_f32 v37, v249, v37
    v_mul_f32 v38, v249, v38
    v_mul_f32 v39, v249, v39
    v_mul_f32 v40, v249, v40
    v_mul_f32 v41, v249, v41
    v_mul_f32 v42, v249, v42
    v_mul_f32 v43, v249, v43
    v_mul_f32 v44, v249, v44
    v_mul_f32 v45, v249, v45
    v_mul_f32 v46, v249, v46
    v_mul_f32 v47, v249, v47
    v_exp_f32 v248, v128
    v_exp_f32 v249, v129
    s_nop 0
    v_add_f32 v254, v248, v249
    v_cvt_pk_bf16_f32 v192, v248, v249
    v_exp_f32 v250, v130
    v_exp_f32 v251, v131
    v_add_f32 v254, v254, v250
    v_add_f32 v254, v254, v251
    v_cvt_pk_bf16_f32 v193, v250, v251
    v_exp_f32 v252, v132
    v_exp_f32 v253, v133
    v_add_f32 v254, v254, v252
    v_add_f32 v254, v254, v253
    v_cvt_pk_bf16_f32 v194, v252, v253
    v_exp_f32 v248, v134
    v_exp_f32 v249, v135
    v_add_f32 v254, v254, v248
    v_add_f32 v254, v254, v249
    v_cvt_pk_bf16_f32 v195, v248, v249
    v_max3_f32 v248, v136, v137, v138
    v_max3_f32 v250, v139, v140, v141
    v_max3_f32 v248, v248, v142, v143
    v_max_f32 v248, v248, v250
    v_mov_b32 v250, v248
    s_nop 1
    v_permlane16_swap_b32 v248, v250
    v_max_f32 v248, v248, v250
    v_mov_b32 v250, v248
    s_nop 1
    v_permlane32_swap_b32 v248, v250
    v_max_f32 v248, v248, v250
    v_max_f32 v248, 0, v248
    v_sub_f32 v249, 0, v248
    v_exp_f32 v249, v249
    v_sub_f32 v216, v216, v248
    v_sub_f32 v217, v217, v248
    v_sub_f32 v218, v218, v248
    v_sub_f32 v219, v219, v248
    v_sub_f32 v136, v136, v248
    v_sub_f32 v137, v137, v248
    v_sub_f32 v138, v138, v248
    v_sub_f32 v139, v139, v248
    v_sub_f32 v140, v140, v248
    v_sub_f32 v141, v141, v248
    v_sub_f32 v142, v142, v248
    v_sub_f32 v143, v143, v248
    v_mul_f32 v233, v249, v233
    v_mul_f32 v48, v249, v48
    v_mul_f32 v49, v249, v49
    v_mul_f32 v50, v249, v50
    v_mul_f32 v51, v249, v51
    v_mul_f32 v52, v249, v52
    v_mul_f32 v53, v249, v53
    v_mul_f32 v54, v249, v54
    v_mul_f32 v55, v249, v55
    v_mul_f32 v56, v249, v56
    v_mul_f32 v57, v249, v57
    v_mul_f32 v58, v249, v58
    v_mul_f32 v59, v249, v59
    v_mul_f32 v60, v249, v60
    v_mul_f32 v61, v249, v61
    v_mul_f32 v62, v249, v62
    v_mul_f32 v63, v249, v63
    v_mul_f32 v64, v249, v64
    v_mul_f32 v65, v249, v65
    v_mul_f32 v66, v249, v66
    v_mul_f32 v67, v249, v67
    v_mul_f32 v68, v249, v68
    v_mul_f32 v69, v249, v69
    v_mul_f32 v70, v249, v70
    v_mul_f32 v71, v249, v71
    v_mul_f32 v72, v249, v72
    v_mul_f32 v73, v249, v73
    v_mul_f32 v74, v249, v74
    v_mul_f32 v75, v249, v75
    v_mul_f32 v76, v249, v76
    v_mul_f32 v77, v249, v77
    v_mul_f32 v78, v249, v78
    v_mul_f32 v79, v249, v79
    v_mul_f32 v80, v249, v80
    v_mul_f32 v81, v249, v81
    v_mul_f32 v82, v249, v82
    v_mul_f32 v83, v249, v83
    v_mul_f32 v84, v249, v84
    v_mul_f32 v85, v249, v85
    v_mul_f32 v86, v249, v86
    v_mul_f32 v87, v249, v87
    v_mul_f32 v88, v249, v88
    v_mul_f32 v89, v249, v89
    v_mul_f32 v90, v249, v90
    v_mul_f32 v91, v249, v91
    v_mul_f32 v92, v249, v92
    v_mul_f32 v93, v249, v93
    v_mul_f32 v94, v249, v94
    v_mul_f32 v95, v249, v95
    v_exp_f32 v250, v136
    v_exp_f32 v251, v137
    s_nop 0
    v_add_f32_e64 v246, v250, v251
    v_cvt_pk_bf16_f32 v196, v250, v251
    v_exp_f32 v252, v138
    v_exp_f32 v253, v139
    v_add_f32 v246, v246, v252
    v_add_f32 v246, v246, v253
    v_cvt_pk_bf16_f32 v197, v252, v253
    v_exp_f32 v248, v140
    v_exp_f32 v249, v141
    v_add_f32 v246, v246, v248
    v_add_f32 v246, v246, v249
    v_cvt_pk_bf16_f32 v198, v248, v249
    v_exp_f32 v250, v142
    v_exp_f32 v251, v143
    v_add_f32 v246, v246, v250
    v_add_f32 v246, v246, v251
    v_cvt_pk_bf16_f32 v199, v250, v251
    s_nop 3
    s_branch L_ret0A1
L_slowTB:
    s_nop 15
    v_max3_f32 v248, v152, v153, v154
    v_max3_f32 v250, v155, v156, v157
    v_max3_f32 v248, v248, v158, v159
    v_max_f32 v248, v248, v250
    v_mov_b32 v250, v248
    s_nop 1
    v_permlane16_swap_b32 v248, v250
    v_max_f32 v248, v248, v250
    v_mov_b32 v250, v248
    s_nop 1
    v_permlane32_swap_b32 v248, v250
    v_max_f32 v248, v248, v250
    v_max_f32 v248, 0, v248
    v_sub_f32 v249, 0, v248
    v_exp_f32 v249, v249
    v_sub_f32 v220, v220, v248
    v_sub_f32 v221, v221, v248
    v_sub_f32 v222, v222, v248
    v_sub_f32 v223, v223, v248
    v_sub_f32 v152, v152, v248
    v_sub_f32 v153, v153, v248
    v_sub_f32 v154, v154, v248
    v_sub_f32 v155, v155, v248
    v_sub_f32 v156, v156, v248
    v_sub_f32 v157, v157, v248
    v_sub_f32 v158, v158, v248
    v_sub_f32 v159, v159, v248
    v_mul_f32 v234, v249, v234
    v_mul_f32 v96, v249, v96
    v_mul_f32 v97, v249, v97
    v_mul_f32 v98, v249, v98
    v_mul_f32 v99, v249, v99
    v_mul_f32 v100, v249, v100
    v_mul_f32 v101, v249, v101
    v_mul_f32 v102, v249, v102
    v_mul_f32 v103, v249, v103
    v_mul_f32 v104, v249, v104
    v_mul_f32 v105, v249, v105
    v_mul_f32 v106, v249, v106
    v_mul_f32 v107, v249, v107
    v_mul_f32 v108, v249, v108
    v_mul_f32 v109, v249, v109
    v_mul_f32 v110, v249, v110
    v_mul_f32 v111, v249, v111
    v_mul_f32 v112, v249, v112
    v_mul_f32 v113, v249, v113
    v_mul_f32 v114, v249, v114
    v_mul_f32 v115, v249, v115
    v_mul_f32 v116, v249, v116
    v_mul_f32 v117, v249, v117
    v_mul_f32 v118, v249, v118
    v_mul_f32 v119, v249, v119
    v_mul_f32 v120, v249, v120
    v_mul_f32 v121, v249, v121
    v_mul_f32 v122, v249, v122
    v_mul_f32 v123, v249, v123
    v_mul_f32 v124, v249, v124
    v_mul_f32 v125, v249, v125
    v_mul_f32 v126, v249, v126
    v_mul_f32 v127, v249, v127
    v_accvgpr_read_b32 v250, a216
    v_mul_f32_e64 v250, v249, v250
    v_accvgpr_write_b32 a216, v250
    v_accvgpr_read_b32 v251, a217
    v_mul_f32_e64 v251, v249, v251
    v_accvgpr_write_b32 a217, v251
    v_accvgpr_read_b32 v250, a218
    v_mul_f32_e64 v250, v249, v250
    v_accvgpr_write_b32 a218, v250
    v_accvgpr_read_b32 v251, a219
    v_mul_f32_e64 v251, v249, v251
    v_accvgpr_write_b32 a219, v251
    v_accvgpr_read_b32 v250, a220
    v_mul_f32_e64 v250, v249, v250
    v_accvgpr_write_b32 a220, v250
    v_accvgpr_read_b32 v251, a221
    v_mul_f32_e64 v251, v249, v251
    v_accvgpr_write_b32 a221, v251
    v_accvgpr_read_b32 v250, a222
    v_mul_f32_e64 v250, v249, v250
    v_accvgpr_write_b32 a222, v250
    v_accvgpr_read_b32 v251, a223
    v_mul_f32_e64 v251, v249, v251
    v_accvgpr_write_b32 a223, v251
    v_accvgpr_read_b32 v250, a224
    v_mul_f32_e64 v250, v249, v250
    v_accvgpr_write_b32 a224, v250
    v_accvgpr_read_b32 v251, a225
    v_mul_f32_e64 v251, v249, v251
    v_accvgpr_write_b32 a225, v251
    v_accvgpr_read_b32 v250, a226
    v_mul_f32_e64 v250, v249, v250
    v_accvgpr_write_b32 a226, v250
    v_accvgpr_read_b32 v251, a227
    v_mul_f32_e64 v251, v249, v251
    v_accvgpr_write_b32 a227, v251
    v_accvgpr_read_b32 v250, a228
    v_mul_f32_e64 v250, v249, v250
    v_accvgpr_write_b32 a228, v250
    v_accvgpr_read_b32 v251, a229
    v_mul_f32_e64 v251, v249, v251
    v_accvgpr_write_b32 a229, v251
    v_accvgpr_read_b32 v250, a230
    v_mul_f32_e64 v250, v249, v250
    v_accvgpr_write_b32 a230, v250
    v_accvgpr_read_b32 v251, a231
    v_mul_f32_e64 v251, v249, v251
    v_accvgpr_write_b32 a231, v251
    v_exp_f32 v251, v152
    v_exp_f32 v252, v153
    s_nop 0
    v_add_f32 v245, v251, v252
    v_cvt_pk_bf16_f32 v200, v251, v252
    v_exp_f32 v253, v154
    v_exp_f32 v248, v155
    v_add_f32 v245, v245, v253
    v_add_f32 v245, v245, v248
    v_cvt_pk_bf16_f32 v201, v253, v248
    v_exp_f32 v249, v156
    v_exp_f32 v250, v157
    v_add_f32 v245, v245, v249
    v_add_f32 v245, v245, v250
    v_cvt_pk_bf16_f32 v202, v249, v250
    v_exp_f32 v251, v158
    v_exp_f32 v252, v159
    v_add_f32 v245, v245, v251
    v_add_f32 v245, v245, v252
    v_cvt_pk_bf16_f32 v203, v251, v252
    v_max3_f32 v248, v160, v161, v162
    v_max3_f32 v250, v163, v164, v165
    v_max3_f32 v248, v248, v166, v167
    v_max_f32 v248, v248, v250
    v_mov_b32 v250, v248
    s_nop 1
    v_permlane16_swap_b32 v248, v250
    v_max_f32 v248, v248, v250
    v_mov_b32 v250, v248
    s_nop 1
    v_permlane32_swap_b32 v248, v250
    v_max_f32 v248, v248, v250
    v_max_f32 v248, 0, v248
    v_sub_f32 v249, 0, v248
    v_exp_f32 v249, v249
    v_sub_f32 v224, v224, v248
    v_sub_f32 v225, v225, v248
    v_sub_f32 v226, v226, v248
    v_sub_f32 v227, v227, v248
    v_sub_f32 v160, v160, v248
    v_sub_f32 v161, v161, v248
    v_sub_f32 v162, v162, v248
    v_sub_f32 v163, v163, v248
    v_sub_f32 v164, v164, v248
    v_sub_f32 v165, v165, v248
    v_sub_f32 v166, v166, v248
    v_sub_f32 v167, v167, v248
    v_mul_f32_e64 v235, v249, v235
    v_accvgpr_read_b32 v250, a168
    v_mul_f32_e64 v250, v249, v250
    v_accvgpr_write_b32 a168, v250
    v_accvgpr_read_b32 v251, a169
    v_mul_f32_e64 v251, v249, v251
    v_accvgpr_write_b32 a169, v251
    v_accvgpr_read_b32 v250, a170
    v_mul_f32_e64 v250, v249, v250
    v_accvgpr_write_b32 a170, v250
    v_accvgpr_read_b32 v251, a171
    v_mul_f32_e64 v251, v249, v251
    v_accvgpr_write_b32 a171, v251
    v_accvgpr_read_b32 v250, a172
    v_mul_f32_e64 v250, v249, v250
    v_accvgpr_write_b32 a172, v250
    v_accvgpr_read_b32 v251, a173
    v_mul_f32_e64 v251, v249, v251
    v_accvgpr_write_b32 a173, v251
    v_accvgpr_read_b32 v250, a174
    v_mul_f32_e64 v250, v249, v250
    v_accvgpr_write_b32 a174, v250
    v_accvgpr_read_b32 v251, a175
    v_mul_f32_e64 v251, v249, v251
    v_accvgpr_write_b32 a175, v251
    v_accvgpr_read_b32 v250, a176
    v_mul_f32_e64 v250, v249, v250
    v_accvgpr_write_b32 a176, v250
    v_accvgpr_read_b32 v251, a177
    v_mul_f32_e64 v251, v249, v251
    v_accvgpr_write_b32 a177, v251
    v_accvgpr_read_b32 v250, a178
    v_mul_f32_e64 v250, v249, v250
    v_accvgpr_write_b32 a178, v250
    v_accvgpr_read_b32 v251, a179
    v_mul_f32_e64 v251, v249, v251
    v_accvgpr_write_b32 a179, v251
    v_accvgpr_read_b32 v250, a180
    v_mul_f32_e64 v250, v249, v250
    v_accvgpr_write_b32 a180, v250
    v_accvgpr_read_b32 v251, a181
    v_mul_f32_e64 v251, v249, v251
    v_accvgpr_write_b32 a181, v251
    v_accvgpr_read_b32 v250, a182
    v_mul_f32_e64 v250, v249, v250
    v_accvgpr_write_b32 a182, v250
    v_accvgpr_read_b32 v251, a183
    v_mul_f32_e64 v251, v249, v251
    v_accvgpr_write_b32 a183, v251
    v_accvgpr_read_b32 v250, a184
    v_mul_f32_e64 v250, v249, v250
    v_accvgpr_write_b32 a184, v250
    v_accvgpr_read_b32 v251, a185
    v_mul_f32_e64 v251, v249, v251
    v_accvgpr_write_b32 a185, v251
    v_accvgpr_read_b32 v250, a186
    v_mul_f32_e64 v250, v249, v250
    v_accvgpr_write_b32 a186, v250
    v_accvgpr_read_b32 v251, a187
    v_mul_f32_e64 v251, v249, v251
    v_accvgpr_write_b32 a187, v251
    v_accvgpr_read_b32 v250, a188
    v_mul_f32_e64 v250, v249, v250
    v_accvgpr_write_b32 a188, v250
    v_accvgpr_read_b32 v251, a189
    v_mul_f32_e64 v251, v249, v251
    v_accvgpr_write_b32 a189, v251
    v_accvgpr_read_b32 v250, a190
    v_mul_f32_e64 v250, v249, v250
    v_accvgpr_write_b32 a190, v250
    v_accvgpr_read_b32 v251, a191
    v_mul_f32_e64 v251, v249, v251
    v_accvgpr_write_b32 a191, v251
    v_accvgpr_read_b32 v250, a192
    v_mul_f32_e64 v250, v249, v250
    v_accvgpr_write_b32 a192, v250
    v_accvgpr_read_b32 v251, a193
    v_mul_f32_e64 v251, v249, v251
    v_accvgpr_write_b32 a193, v251
    v_accvgpr_read_b32 v250, a194
    v_mul_f32_e64 v250, v249, v250
    v_accvgpr_write_b32 a194, v250
    v_accvgpr_read_b32 v251, a195
    v_mul_f32_e64 v251, v249, v251
    v_accvgpr_write_b32 a195, v251
    v_accvgpr_read_b32 v250, a196
    v_mul_f32_e64 v250, v249, v250
    v_accvgpr_write_b32 a196, v250
    v_accvgpr_read_b32 v251, a197
    v_mul_f32_e64 v251, v249, v251
    v_accvgpr_write_b32 a197, v251
    v_accvgpr_read_b32 v250, a198
    v_mul_f32_e64 v250, v249, v250
    v_accvgpr_write_b32 a198, v250
    v_accvgpr_read_b32 v251, a199
    v_mul_f32_e64 v251, v249, v251
    v_accvgpr_write_b32 a199, v251
    v_accvgpr_read_b32 v250, a200
    v_mul_f32_e64 v250, v249, v250
    v_accvgpr_write_b32 a200, v250
    v_accvgpr_read_b32 v251, a201
    v_mul_f32_e64 v251, v249, v251
    v_accvgpr_write_b32 a201, v251
    v_accvgpr_read_b32 v250, a202
    v_mul_f32_e64 v250, v249, v250
    v_accvgpr_write_b32 a202, v250
    v_accvgpr_read_b32 v251, a203
    v_mul_f32_e64 v251, v249, v251
    v_accvgpr_write_b32 a203, v251
    v_accvgpr_read_b32 v250, a204
    v_mul_f32_e64 v250, v249, v250
    v_accvgpr_write_b32 a204, v250
    v_accvgpr_read_b32 v251, a205
    v_mul_f32_e64 v251, v249, v251
    v_accvgpr_write_b32 a205, v251
    v_accvgpr_read_b32 v250, a206
    v_mul_f32_e64 v250, v249, v250
    v_accvgpr_write_b32 a206, v250
    v_accvgpr_read_b32 v251, a207
    v_mul_f32_e64 v251, v249, v251
    v_accvgpr_write_b32 a207, v251
    v_accvgpr_read_b32 v250, a208
    v_mul_f32_e64 v250, v249, v250
    v_accvgpr_write_b32 a208, v250
    v_accvgpr_read_b32 v251, a209
    v_mul_f32_e64 v251, v249, v251
    v_accvgpr_write_b32 a209, v251
    v_accvgpr_read_b32 v250, a210
    v_mul_f32_e64 v250, v249, v250
    v_accvgpr_write_b32 a210, v250
    v_accvgpr_read_b32 v251, a211
    v_mul_f32_e64 v251, v249, v251
    v_accvgpr_write_b32 a211, v251
    v_accvgpr_read_b32 v250, a212
    v_mul_f32_e64 v250, v249, v250
    v_accvgpr_write_b32 a212, v250
    v_accvgpr_read_b32 v251, a213
    v_mul_f32_e64 v251, v249, v251
    v_accvgpr_write_b32 a213, v251
    v_accvgpr_read_b32 v250, a214
    v_mul_f32_e64 v250, v249, v250
    v_accvgpr_write_b32 a214, v250
    v_accvgpr_read_b32 v251, a215
    v_mul_f32_e64 v251, v249, v251
    v_accvgpr_write_b32 a215, v251
    v_exp_f32 v253, v160
    v_exp_f32 v248, v161
    s_nop 0
    v_add_f32 v246, v253, v248
    v_cvt_pk_bf16_f32 v204, v253, v248
    v_exp_f32 v249, v162
    v_exp_f32 v250, v163
    v_add_f32 v246, v246, v249
    v_add_f32 v246, v246, v250
    v_cvt_pk_bf16_f32 v205, v249, v250
    v_exp_f32 v251, v164
    v_exp_f32 v252, v165
    v_add_f32 v246, v246, v251
    v_add_f32 v246, v246, v252
    v_cvt_pk_bf16_f32 v206, v251, v252
    v_exp_f32 v253, v166
    v_exp_f32 v248, v167
    v_add_f32 v246, v246, v253
    v_add_f32 v246, v246, v248
    v_cvt_pk_bf16_f32 v207, v253, v248
    s_nop 3
    s_branch L_retTB
L_slowTA:
    s_nop 15
    v_max3_f32 v248, v168, v169, v170
    v_max3_f32 v250, v171, v172, v173
    v_max3_f32 v248, v248, v174, v175
    v_max_f32 v248, v248, v250
    v_mov_b32 v250, v248
    s_nop 1
    v_permlane16_swap_b32 v248, v250
    v_max_f32 v248, v248, v250
    v_mov_b32 v250, v248
    s_nop 1
    v_permlane32_swap_b32 v248, v250
    v_max_f32 v248, v248, v250
    v_max_f32 v248, 0, v248
    v_sub_f32 v249, 0, v248
    v_exp_f32 v249, v249
    v_sub_f32 v220, v220, v248
    v_sub_f32 v221, v221, v248
    v_sub_f32 v222, v222, v248
    v_sub_f32 v223, v223, v248
    v_sub_f32 v168, v168, v248
    v_sub_f32 v169, v169, v248
    v_sub_f32 v170, v170, v248
    v_sub_f32 v171, v171, v248
    v_sub_f32 v172, v172, v248
    v_sub_f32 v173, v173, v248
    v_sub_f32 v174, v174, v248
    v_sub_f32 v175, v175, v248
    v_mul_f32 v234, v249, v234
    v_mul_f32 v96, v249, v96
    v_mul_f32 v97, v249, v97
    v_mul_f32 v98, v249, v98
    v_mul_f32 v99, v249, v99
    v_mul_f32 v100, v249, v100
    v_mul_f32 v101, v249, v101
    v_mul_f32 v102, v249, v102
    v_mul_f32 v103, v249, v103
    v_mul_f32 v104, v249, v104
    v_mul_f32 v105, v249, v105
    v_mul_f32 v106, v249, v106
    v_mul_f32 v107, v249, v107
    v_mul_f32 v108, v249, v108
    v_mul_f32 v109, v249, v109
    v_mul_f32 v110, v249, v110
    v_mul_f32 v111, v249, v111
    v_mul_f32 v112, v249, v112
    v_mul_f32 v113, v249, v113
    v_mul_f32 v114, v249, v114
    v_mul_f32 v115, v249, v115
    v_mul_f32 v116, v249, v116
    v_mul_f32 v117, v249, v117
    v_mul_f32 v118, v249, v118
    v_mul_f32 v119, v249, v119
    v_mul_f32 v120, v249, v120
    v_mul_f32 v121, v249, v121
    v_mul_f32 v122, v249, v122
    v_mul_f32 v123, v249, v123
    v_mul_f32 v124, v249, v124
    v_mul_f32 v125, v249, v125
    v_mul_f32 v126, v249, v126
    v_mul_f32 v127, v249, v127
    v_accvgpr_read_b32 v250, a216
    v_mul_f32_e64 v250, v249, v250
    v_accvgpr_write_b32 a216, v250
    v_accvgpr_read_b32 v251, a217
    v_mul_f32_e64 v251, v249, v251
    v_accvgpr_write_b32 a217, v251
    v_accvgpr_read_b32 v250, a218
    v_mul_f32_e64 v250, v249, v250
    v_accvgpr_write_b32 a218, v250
    v_accvgpr_read_b32 v251, a219
    v_mul_f32_e64 v251, v249, v251
    v_accvgpr_write_b32 a219, v251
    v_accvgpr_read_b32 v250, a220
    v_mul_f32_e64 v250, v249, v250
    v_accvgpr_write_b32 a220, v250
    v_accvgpr_read_b32 v251, a221
    v_mul_f32_e64 v251, v249, v251
    v_accvgpr_write_b32 a221, v251
    v_accvgpr_read_b32 v250, a222
    v_mul_f32_e64 v250, v249, v250
    v_accvgpr_write_b32 a222, v250
    v_accvgpr_read_b32 v251, a223
    v_mul_f32_e64 v251, v249, v251
    v_accvgpr_write_b32 a223, v251
    v_accvgpr_read_b32 v250, a224
    v_mul_f32_e64 v250, v249, v250
    v_accvgpr_write_b32 a224, v250
    v_accvgpr_read_b32 v251, a225
    v_mul_f32_e64 v251, v249, v251
    v_accvgpr_write_b32 a225, v251
    v_accvgpr_read_b32 v250, a226
    v_mul_f32_e64 v250, v249, v250
    v_accvgpr_write_b32 a226, v250
    v_accvgpr_read_b32 v251, a227
    v_mul_f32_e64 v251, v249, v251
    v_accvgpr_write_b32 a227, v251
    v_accvgpr_read_b32 v250, a228
    v_mul_f32_e64 v250, v249, v250
    v_accvgpr_write_b32 a228, v250
    v_accvgpr_read_b32 v251, a229
    v_mul_f32_e64 v251, v249, v251
    v_accvgpr_write_b32 a229, v251
    v_accvgpr_read_b32 v250, a230
    v_mul_f32_e64 v250, v249, v250
    v_accvgpr_write_b32 a230, v250
    v_accvgpr_read_b32 v251, a231
    v_mul_f32_e64 v251, v249, v251
    v_accvgpr_write_b32 a231, v251
    v_exp_f32 v252, v168
    v_exp_f32 v253, v169
    s_nop 0
    v_add_f32 v245, v252, v253
    v_cvt_pk_bf16_f32 v200, v252, v253
    v_exp_f32 v248, v170
    v_exp_f32 v249, v171
    v_add_f32 v245, v245, v248
    v_add_f32 v245, v245, v249
    v_cvt_pk_bf16_f32 v201, v248, v249
    v_exp_f32 v250, v172
    v_exp_f32 v251, v173
    v_add_f32 v245, v245, v250
    v_add_f32 v245, v245, v251
    v_cvt_pk_bf16_f32 v202, v250, v251
    v_exp_f32 v252, v174
    v_exp_f32 v253, v175
    v_add_f32 v245, v245, v252
    v_add_f32 v245, v245, v253
    v_cvt_pk_bf16_f32 v203, v252, v253
    v_max3_f32 v248, v176, v177, v178
    v_max3_f32 v250, v179, v180, v181
    v_max3_f32 v248, v248, v182, v183
    v_max_f32 v248, v248, v250
    v_mov_b32 v250, v248
    s_nop 1
    v_permlane16_swap_b32 v248, v250
    v_max_f32 v248, v248, v250
    v_mov_b32 v250, v248
    s_nop 1
    v_permlane32_swap_b32 v248, v250
    v_max_f32 v248, v248, v250
    v_max_f32 v248, 0, v248
    v_sub_f32 v249, 0, v248
    v_exp_f32 v249, v249
    v_sub_f32 v224, v224, v248
    v_sub_f32 v225, v225, v248
    v_sub_f32 v226, v226, v248
    v_sub_f32 v227, v227, v248
    v_sub_f32 v176, v176, v248
    v_sub_f32 v177, v177, v248
    v_sub_f32 v178, v178, v248
    v_sub_f32 v179, v179, v248
    v_sub_f32 v180, v180, v248
    v_sub_f32 v181, v181, v248
    v_sub_f32 v182, v182, v248
    v_sub_f32 v183, v183, v248
    v_mul_f32_e64 v235, v249, v235
    v_accvgpr_read_b32 v250, a168
    v_mul_f32_e64 v250, v249, v250
    v_accvgpr_write_b32 a168, v250
    v_accvgpr_read_b32 v251, a169
    v_mul_f32_e64 v251, v249, v251
    v_accvgpr_write_b32 a169, v251
    v_accvgpr_read_b32 v250, a170
    v_mul_f32_e64 v250, v249, v250
    v_accvgpr_write_b32 a170, v250
    v_accvgpr_read_b32 v251, a171
    v_mul_f32_e64 v251, v249, v251
    v_accvgpr_write_b32 a171, v251
    v_accvgpr_read_b32 v250, a172
    v_mul_f32_e64 v250, v249, v250
    v_accvgpr_write_b32 a172, v250
    v_accvgpr_read_b32 v251, a173
    v_mul_f32_e64 v251, v249, v251
    v_accvgpr_write_b32 a173, v251
    v_accvgpr_read_b32 v250, a174
    v_mul_f32_e64 v250, v249, v250
    v_accvgpr_write_b32 a174, v250
    v_accvgpr_read_b32 v251, a175
    v_mul_f32_e64 v251, v249, v251
    v_accvgpr_write_b32 a175, v251
    v_accvgpr_read_b32 v250, a176
    v_mul_f32_e64 v250, v249, v250
    v_accvgpr_write_b32 a176, v250
    v_accvgpr_read_b32 v251, a177
    v_mul_f32_e64 v251, v249, v251
    v_accvgpr_write_b32 a177, v251
    v_accvgpr_read_b32 v250, a178
    v_mul_f32_e64 v250, v249, v250
    v_accvgpr_write_b32 a178, v250
    v_accvgpr_read_b32 v251, a179
    v_mul_f32_e64 v251, v249, v251
    v_accvgpr_write_b32 a179, v251
    v_accvgpr_read_b32 v250, a180
    v_mul_f32_e64 v250, v249, v250
    v_accvgpr_write_b32 a180, v250
    v_accvgpr_read_b32 v251, a181
    v_mul_f32_e64 v251, v249, v251
    v_accvgpr_write_b32 a181, v251
    v_accvgpr_read_b32 v250, a182
    v_mul_f32_e64 v250, v249, v250
    v_accvgpr_write_b32 a182, v250
    v_accvgpr_read_b32 v251, a183
    v_mul_f32_e64 v251, v249, v251
    v_accvgpr_write_b32 a183, v251
    v_accvgpr_read_b32 v250, a184
    v_mul_f32_e64 v250, v249, v250
    v_accvgpr_write_b32 a184, v250
    v_accvgpr_read_b32 v251, a185
    v_mul_f32_e64 v251, v249, v251
    v_accvgpr_write_b32 a185, v251
    v_accvgpr_read_b32 v250, a186
    v_mul_f32_e64 v250, v249, v250
    v_accvgpr_write_b32 a186, v250
    v_accvgpr_read_b32 v251, a187
    v_mul_f32_e64 v251, v249, v251
    v_accvgpr_write_b32 a187, v251
    v_accvgpr_read_b32 v250, a188
    v_mul_f32_e64 v250, v249, v250
    v_accvgpr_write_b32 a188, v250
    v_accvgpr_read_b32 v251, a189
    v_mul_f32_e64 v251, v249, v251
    v_accvgpr_write_b32 a189, v251
    v_accvgpr_read_b32 v250, a190
    v_mul_f32_e64 v250, v249, v250
    v_accvgpr_write_b32 a190, v250
    v_accvgpr_read_b32 v251, a191
    v_mul_f32_e64 v251, v249, v251
    v_accvgpr_write_b32 a191, v251
    v_accvgpr_read_b32 v250, a192
    v_mul_f32_e64 v250, v249, v250
    v_accvgpr_write_b32 a192, v250
    v_accvgpr_read_b32 v251, a193
    v_mul_f32_e64 v251, v249, v251
    v_accvgpr_write_b32 a193, v251
    v_accvgpr_read_b32 v250, a194
    v_mul_f32_e64 v250, v249, v250
    v_accvgpr_write_b32 a194, v250
    v_accvgpr_read_b32 v251, a195
    v_mul_f32_e64 v251, v249, v251
    v_accvgpr_write_b32 a195, v251
    v_accvgpr_read_b32 v250, a196
    v_mul_f32_e64 v250, v249, v250
    v_accvgpr_write_b32 a196, v250
    v_accvgpr_read_b32 v251, a197
    v_mul_f32_e64 v251, v249, v251
    v_accvgpr_write_b32 a197, v251
    v_accvgpr_read_b32 v250, a198
    v_mul_f32_e64 v250, v249, v250
    v_accvgpr_write_b32 a198, v250
    v_accvgpr_read_b32 v251, a199
    v_mul_f32_e64 v251, v249, v251
    v_accvgpr_write_b32 a199, v251
    v_accvgpr_read_b32 v250, a200
    v_mul_f32_e64 v250, v249, v250
    v_accvgpr_write_b32 a200, v250
    v_accvgpr_read_b32 v251, a201
    v_mul_f32_e64 v251, v249, v251
    v_accvgpr_write_b32 a201, v251
    v_accvgpr_read_b32 v250, a202
    v_mul_f32_e64 v250, v249, v250
    v_accvgpr_write_b32 a202, v250
    v_accvgpr_read_b32 v251, a203
    v_mul_f32_e64 v251, v249, v251
    v_accvgpr_write_b32 a203, v251
    v_accvgpr_read_b32 v250, a204
    v_mul_f32_e64 v250, v249, v250
    v_accvgpr_write_b32 a204, v250
    v_accvgpr_read_b32 v251, a205
    v_mul_f32_e64 v251, v249, v251
    v_accvgpr_write_b32 a205, v251
    v_accvgpr_read_b32 v250, a206
    v_mul_f32_e64 v250, v249, v250
    v_accvgpr_write_b32 a206, v250
    v_accvgpr_read_b32 v251, a207
    v_mul_f32_e64 v251, v249, v251
    v_accvgpr_write_b32 a207, v251
    v_accvgpr_read_b32 v250, a208
    v_mul_f32_e64 v250, v249, v250
    v_accvgpr_write_b32 a208, v250
    v_accvgpr_read_b32 v251, a209
    v_mul_f32_e64 v251, v249, v251
    v_accvgpr_write_b32 a209, v251
    v_accvgpr_read_b32 v250, a210
    v_mul_f32_e64 v250, v249, v250
    v_accvgpr_write_b32 a210, v250
    v_accvgpr_read_b32 v251, a211
    v_mul_f32_e64 v251, v249, v251
    v_accvgpr_write_b32 a211, v251
    v_accvgpr_read_b32 v250, a212
    v_mul_f32_e64 v250, v249, v250
    v_accvgpr_write_b32 a212, v250
    v_accvgpr_read_b32 v251, a213
    v_mul_f32_e64 v251, v249, v251
    v_accvgpr_write_b32 a213, v251
    v_accvgpr_read_b32 v250, a214
    v_mul_f32_e64 v250, v249, v250
    v_accvgpr_write_b32 a214, v250
    v_accvgpr_read_b32 v251, a215
    v_mul_f32_e64 v251, v249, v251
    v_accvgpr_write_b32 a215, v251
    v_exp_f32 v248, v176
    v_exp_f32 v249, v177
    s_nop 0
    v_add_f32 v246, v248, v249
    v_cvt_pk_bf16_f32 v204, v248, v249
    v_exp_f32 v250, v178
    v_exp_f32 v251, v179
    v_add_f32 v246, v246, v250
    v_add_f32 v246, v246, v251
    v_cvt_pk_bf16_f32 v205, v250, v251
    v_exp_f32 v252, v180
    v_exp_f32 v253, v181
    v_add_f32 v246, v246, v252
    v_add_f32 v246, v246, v253
    v_cvt_pk_bf16_f32 v206, v252, v253
    v_exp_f32 v248, v182
    v_exp_f32 v249, v183
    v_add_f32 v246, v246, v248
    v_add_f32 v246, v246, v249
    v_cvt_pk_bf16_f32 v207, v248, v249
    v_max3_f32 v248, v144, v145, v146
    v_max3_f32 v250, v147, v148, v149
    v_max3_f32 v248, v248, v150, v151
    v_max_f32 v248, v248, v250
    v_mov_b32 v250, v248
    s_nop 1
    v_permlane16_swap_b32 v248, v250
    v_max_f32 v248, v248, v250
    v_mov_b32 v250, v248
    s_nop 1
    v_permlane32_swap_b32 v248, v250
    v_max_f32 v248, v248, v250
    v_max_f32 v248, 0, v248
    v_sub_f32 v249, 0, v248
    v_exp_f32 v249, v249
    v_sub_f32 v228, v228, v248
    v_sub_f32 v229, v229, v248
    v_sub_f32 v230, v230, v248
    v_sub_f32 v231, v231, v248
    v_sub_f32 v144, v144, v248
    v_sub_f32 v145, v145, v248
    v_sub_f32 v146, v146, v248
    v_sub_f32 v147, v147, v248
    v_sub_f32 v148, v148, v248
    v_sub_f32 v149, v149, v248
    v_sub_f32 v150, v150, v248
    v_sub_f32 v151, v151, v248
    v_mul_f32_e64 v236, v249, v236
    v_accvgpr_read_b32 v250, a120
    v_mul_f32_e64 v250, v249, v250
    v_accvgpr_write_b32 a120, v250
    v_accvgpr_read_b32 v251, a121
    v_mul_f32_e64 v251, v249, v251
    v_accvgpr_write_b32 a121, v251
    v_accvgpr_read_b32 v250, a122
    v_mul_f32_e64 v250, v249, v250
    v_accvgpr_write_b32 a122, v250
    v_accvgpr_read_b32 v251, a123
    v_mul_f32_e64 v251, v249, v251
    v_accvgpr_write_b32 a123, v251
    v_accvgpr_read_b32 v250, a124
    v_mul_f32_e64 v250, v249, v250
    v_accvgpr_write_b32 a124, v250
    v_accvgpr_read_b32 v251, a125
    v_mul_f32_e64 v251, v249, v251
    v_accvgpr_write_b32 a125, v251
    v_accvgpr_read_b32 v250, a126
    v_mul_f32_e64 v250, v249, v250
    v_accvgpr_write_b32 a126, v250
    v_accvgpr_read_b32 v251, a127
    v_mul_f32_e64 v251, v249, v251
    v_accvgpr_write_b32 a127, v251
    v_accvgpr_read_b32 v250, a128
    v_mul_f32_e64 v250, v249, v250
    v_accvgpr_write_b32 a128, v250
    v_accvgpr_read_b32 v251, a129
    v_mul_f32_e64 v251, v249, v251
    v_accvgpr_write_b32 a129, v251
    v_accvgpr_read_b32 v250, a130
    v_mul_f32_e64 v250, v249, v250
    v_accvgpr_write_b32 a130, v250
    v_accvgpr_read_b32 v251, a131
    v_mul_f32_e64 v251, v249, v251
    v_accvgpr_write_b32 a131, v251
    v_accvgpr_read_b32 v250, a132
    v_mul_f32_e64 v250, v249, v250
    v_accvgpr_write_b32 a132, v250
    v_accvgpr_read_b32 v251, a133
    v_mul_f32_e64 v251, v249, v251
    v_accvgpr_write_b32 a133, v251
    v_accvgpr_read_b32 v250, a134
    v_mul_f32_e64 v250, v249, v250
    v_accvgpr_write_b32 a134, v250
    v_accvgpr_read_b32 v251, a135
    v_mul_f32_e64 v251, v249, v251
    v_accvgpr_write_b32 a135, v251
    v_accvgpr_read_b32 v250, a136
    v_mul_f32_e64 v250, v249, v250
    v_accvgpr_write_b32 a136, v250
    v_accvgpr_read_b32 v251, a137
    v_mul_f32_e64 v251, v249, v251
    v_accvgpr_write_b32 a137, v251
    v_accvgpr_read_b32 v250, a138
    v_mul_f32_e64 v250, v249, v250
    v_accvgpr_write_b32 a138, v250
    v_accvgpr_read_b32 v251, a139
    v_mul_f32_e64 v251, v249, v251
    v_accvgpr_write_b32 a139, v251
    v_accvgpr_read_b32 v250, a140
    v_mul_f32_e64 v250, v249, v250
    v_accvgpr_write_b32 a140, v250
    v_accvgpr_read_b32 v251, a141
    v_mul_f32_e64 v251, v249, v251
    v_accvgpr_write_b32 a141, v251
    v_accvgpr_read_b32 v250, a142
    v_mul_f32_e64 v250, v249, v250
    v_accvgpr_write_b32 a142, v250
    v_accvgpr_read_b32 v251, a143
    v_mul_f32_e64 v251, v249, v251
    v_accvgpr_write_b32 a143, v251
    v_accvgpr_read_b32 v250, a144
    v_mul_f32_e64 v250, v249, v250
    v_accvgpr_write_b32 a144, v250
    v_accvgpr_read_b32 v251, a145
    v_mul_f32_e64 v251, v249, v251
    v_accvgpr_write_b32 a145, v251
    v_accvgpr_read_b32 v250, a146
    v_mul_f32_e64 v250, v249, v250
    v_accvgpr_write_b32 a146, v250
    v_accvgpr_read_b32 v251, a147
    v_mul_f32_e64 v251, v249, v251
    v_accvgpr_write_b32 a147, v251
    v_accvgpr_read_b32 v250, a148
    v_mul_f32_e64 v250, v249, v250
    v_accvgpr_write_b32 a148, v250
    v_accvgpr_read_b32 v251, a149
    v_mul_f32_e64 v251, v249, v251
    v_accvgpr_write_b32 a149, v251
    v_accvgpr_read_b32 v250, a150
    v_mul_f32_e64 v250, v249, v250
    v_accvgpr_write_b32 a150, v250
    v_accvgpr_read_b32 v251, a151
    v_mul_f32_e64 v251, v249, v251
    v_accvgpr_write_b32 a151, v251
    v_accvgpr_read_b32 v250, a152
    v_mul_f32_e64 v250, v249, v250
    v_accvgpr_write_b32 a152, v250
    v_accvgpr_read_b32 v251, a153
    v_mul_f32_e64 v251, v249, v251
    v_accvgpr_write_b32 a153, v251
    v_accvgpr_read_b32 v250, a154
    v_mul_f32_e64 v250, v249, v250
    v_accvgpr_write_b32 a154, v250
    v_accvgpr_read_b32 v251, a155
    v_mul_f32_e64 v251, v249, v251
    v_accvgpr_write_b32 a155, v251
    v_accvgpr_read_b32 v250, a156
    v_mul_f32_e64 v250, v249, v250
    v_accvgpr_write_b32 a156, v250
    v_accvgpr_read_b32 v251, a157
    v_mul_f32_e64 v251, v249, v251
    v_accvgpr_write_b32 a157, v251
    v_accvgpr_read_b32 v250, a158
    v_mul_f32_e64 v250, v249, v250
    v_accvgpr_write_b32 a158, v250
    v_accvgpr_read_b32 v251, a159
    v_mul_f32_e64 v251, v249, v251
    v_accvgpr_write_b32 a159, v251
    v_accvgpr_read_b32 v250, a160
    v_mul_f32_e64 v250, v249, v250
    v_accvgpr_write_b32 a160, v250
    v_accvgpr_read_b32 v251, a161
    v_mul_f32_e64 v251, v249, v251
    v_accvgpr_write_b32 a161, v251
    v_accvgpr_read_b32 v250, a162
    v_mul_f32_e64 v250, v249, v250
    v_accvgpr_write_b32 a162, v250
    v_accvgpr_read_b32 v251, a163
    v_mul_f32_e64 v251, v249, v251
    v_accvgpr_write_b32 a163, v251
    v_accvgpr_read_b32 v250, a164
    v_mul_f32_e64 v250, v249, v250
    v_accvgpr_write_b32 a164, v250
    v_accvgpr_read_b32 v251, a165
    v_mul_f32_e64 v251, v249, v251
    v_accvgpr_write_b32 a165, v251
    v_accvgpr_read_b32 v250, a166
    v_mul_f32_e64 v250, v249, v250
    v_accvgpr_write_b32 a166, v250
    v_accvgpr_read_b32 v251, a167
    v_mul_f32_e64 v251, v249, v251
    v_accvgpr_write_b32 a167, v251
    v_exp_f32 v250, v144
    v_exp_f32 v251, v145
    s_nop 0
    v_add_f32 v247, v250, v251
    v_cvt_pk_bf16_f32 v208, v250, v251
    v_exp_f32 v252, v146
    v_exp_f32 v253, v147
    v_add_f32 v247, v247, v252
    v_add_f32 v247, v247, v253
    v_cvt_pk_bf16_f32 v209, v252, v253
    v_exp_f32 v248, v148
    v_exp_f32 v249, v149
    v_add_f32 v247, v247, v248
    v_add_f32 v247, v247, v249
    v_cvt_pk_bf16_f32 v210, v248, v249
    v_exp_f32 v250, v150
    v_exp_f32 v251, v151
    v_add_f32 v247, v247, v250
    v_add_f32 v247, v247, v251
    v_cvt_pk_bf16_f32 v211, v250, v251
    s_nop 3
    s_branch L_retTA
.section .rodata,"a"
.p2align 6
.amdhsa_kernel standalone__gqa_softmax__near_ridge_kernel
  .amdhsa_next_free_vgpr 512
  .amdhsa_next_free_sgpr 64
  .amdhsa_accum_offset 256
  .amdhsa_group_segment_fixed_size 0
  .amdhsa_kernarg_size 48
  .amdhsa_user_sgpr_count 2
  .amdhsa_user_sgpr_kernarg_segment_ptr 1
  .amdhsa_system_sgpr_workgroup_id_x 1
  .amdhsa_float_denorm_mode_32 3
.end_amdhsa_kernel
```
